```python
import torch

def _softmax(x, axis=-1):
    return torch.softmax(x, dim=axis)
def _gelu(x):
    return torch.nn.functional.gelu(x, approximate="tanh")
def _silu(x):
    return torch.nn.functional.silu(x)
def _sigmoid(x):
    return torch.sigmoid(x)
def _layernorm(x, axis=-1, eps=1e-5):
    m = x.mean(dim=axis, keepdim=True)
    v = x.var(dim=axis, keepdim=True, unbiased=False)
    return (x - m) / torch.sqrt(v + eps)
def _scatter_add(tgt, idx, src, axis=0):
    return tgt.clone().index_add_(axis, idx, src)
def _segment_sum(src, seg, n):
    out = torch.zeros((n,) + src.shape[1:], dtype=src.dtype)
    return out.index_add_(0, seg, src)
def _pad(x, pw):
    flat = tuple(v for pair in reversed(pw) for v in pair)
    return torch.nn.functional.pad(x, flat)

kernel_name = 'standalone__mha_block_cached__near_ridge'

def setup_inputs():

    _w = (lambda a: (lambda t: t.to(torch.bfloat16) if t.is_floating_point() else t)(torch.as_tensor(a)))
    B, Sq, D = 8, 160, 512
    H, Sk, Dh = 32, 512, 128
    return {
        "x": _w((lambda *s: torch.randn(*s, dtype=torch.bfloat16) * 0.8)(B, Sq, D)),
        "k_cache": _w((lambda *s: torch.randn(*s, dtype=torch.bfloat16) * 0.8)(B, H, Sk, Dh)),
        "v_cache": _w((lambda *s: torch.randn(*s, dtype=torch.bfloat16) * 0.05)(B, H, Sk, Dh)),
        "wq": _w((lambda *s: torch.randn(*s, dtype=torch.bfloat16) * 0.8)(D, H * Dh) * (D ** -0.5)),
        "wo": _w((lambda *s: torch.randn(*s, dtype=torch.bfloat16) * 0.05)(H * Dh, D) * ((H * Dh) ** -0.5)),
    }

def reference(x, k_cache, v_cache, wq, wo):
    B, Sq, D = x.shape
    H, Dh = 32, 128
    q = (lambda x, *d: x.permute(*d))((x @ wq).reshape(B, Sq, H, Dh), 0, 2, 1, 3)
    scores = torch.einsum("bhqd,bhkd->bhqk", q, k_cache) * (Dh ** -0.5)
    p = _softmax(scores, axis=-1)
    o = torch.einsum("bhqk,bhkd->bhqd", p, v_cache)
    return (lambda x, *d: x.permute(*d))(o, 0, 2, 1, 3).reshape(B, Sq, H * Dh) @ wo
```

```asm
; @launch grid=(256,1,1) block=(512,1,1) lds=163840
.amdgcn_target "amdgcn-amd-amdhsa--gfx950"
.text
.globl standalone__mha_block_cached__near_ridge_kernel
.p2align 8
.type standalone__mha_block_cached__near_ridge_kernel,@function
standalone__mha_block_cached__near_ridge_kernel:
    s_cmp_ge_u32 s2, 256
    s_cbranch_scc1 L_end
    s_load_dwordx8 s[8:15], s[0:1], 0
    s_load_dwordx8 s[16:23], s[0:1], 32
    v_lshrrev_b32 v1, 6, v0
    v_and_b32 v0, 63, v0
    v_readfirstlane_b32 s3, v1
    s_and_b32 s60, s2, 7
    s_lshr_b32 s61, s2, 5
    s_lshr_b32 s62, s2, 3
    s_and_b32 s62, s62, 3
    s_lshl_b32 s63, s60, 2
    s_add_u32 s63, s63, s62
    s_add_u32 s57, s62, 1
    s_and_b32 s57, s57, 3
    s_add_u32 s58, s62, 0
    s_and_b32 s58, s58, 3
    s_and_b32 s4, s3, 3
    s_lshl_b32 s65, s4, 10
    s_mov_b64 s[66:67], 0
    s_mov_b64 s[68:69], 0
    s_cmp_lt_u32 s3, 4
    s_cbranch_scc1 L_main
    s_setprio 3
L_restart_helper:
    v_lshrrev_b32 v64, 3, v0
    v_lshrrev_b32 v65, 4, v0
    v_and_b32 v66, 7, v0
    v_and_b32 v67, 15, v0
    s_and_b32 s5, s4, 1
    s_lshr_b32 s6, s4, 1
    s_lshl_b32 s7, s5, 2
    v_or_b32 v68, s7, v65
    v_xor_b32 v68, v66, v68
    s_lshl_b32 s7, s4, 3
    v_add_u32 v69, s7, v64
    v_lshlrev_b32 v1, 10, v69
    v_lshl_add_u32 v1, v68, 4, v1
    s_mul_i32 s59, s6, 8200
    s_lshl_b32 s7, s5, 10
    s_add_u32 s59, s59, s7
    v_lshlrev_b32 v68, 2, v65
    v_xor_b32 v68, v67, v68
    s_lshl_b32 s7, s4, 2
    v_add_u32 v70, s7, v65
    v_lshlrev_b32 v2, 13, v70
    v_lshl_add_u32 v2, v68, 4, v2
    s_add_u32 s64, s62, s61
    s_and_b32 s64, s64, 1
    s_waitcnt lgkmcnt(0)
    s_mul_i32 s5, s61, 163840
    s_add_u32 s24, s8, s5
    s_addc_u32 s25, s9, 0
    s_mov_b32 s26, 163840
    s_mov_b32 s27, 0x20000
    s_lshl_b32 s5, s63, 8
    s_sub_u32 s30, 0x400000, s5
    s_add_u32 s28, s14, s5
    s_addc_u32 s29, s15, 0
    s_mov_b32 s31, 0x20000
    s_mov_b32 s100, 0
    s_lshl_b32 s101, s100, 19
    s_lshl_b32 s100, s100, 7
    s_add_u32 m0, s65, 0
    s_add_u32 s7, s100, 0
    buffer_load_dwordx4 v1, s[24:27], s7 offen lds
    s_add_u32 m0, s59, 20480
    s_add_u32 s7, s101, 0
    buffer_load_dwordx4 v2, s[28:31], s7 offen lds
    s_add_u32 m0, s65, 4096
    s_add_u32 s7, s100, 32768
    buffer_load_dwordx4 v1, s[24:27], s7 offen lds
    s_add_u32 m0, s59, 22528
    s_add_u32 s7, s101, 131072
    buffer_load_dwordx4 v2, s[28:31], s7 offen lds
    s_add_u32 m0, s65, 8192
    s_add_u32 s7, s100, 65536
    buffer_load_dwordx4 v1, s[24:27], s7 offen lds
    s_add_u32 m0, s59, 24576
    s_add_u32 s7, s101, 262144
    buffer_load_dwordx4 v2, s[28:31], s7 offen lds
    s_add_u32 m0, s65, 12288
    s_add_u32 s7, s100, 98304
    buffer_load_dwordx4 v1, s[24:27], s7 offen lds
    s_add_u32 m0, s59, 26624
    s_add_u32 s7, s101, 393216
    buffer_load_dwordx4 v2, s[28:31], s7 offen lds
    s_add_u32 m0, s65, 16384
    s_add_u32 s7, s100, 131072
    buffer_load_dwordx4 v1, s[24:27], s7 offen lds
    s_lshr_b32 s56, s2, 4
    s_add_u32 s56, s56, s2
    s_and_b32 s56, s56, 15
    s_lshl_b32 s56, s56, 13
    s_lshl_b32 s5, s61, 5
    s_add_u32 s5, s5, s63
    s_lshl_b32 s5, s5, 17
    s_add_u32 s32, s10, s5
    s_addc_u32 s33, s11, 0
    s_mov_b32 s34, 131072
    s_mov_b32 s35, 0x20000
    s_lshl_b32 s5, s61, 5
    s_add_u32 s5, s5, s63
    s_lshl_b32 s5, s5, 17
    s_add_u32 s36, s12, s5
    s_addc_u32 s37, s13, 0
    s_mov_b32 s38, 131072
    s_mov_b32 s39, 0x20000
    s_lshl_b32 s5, s60, 19
    s_lshl_b32 s6, s57, 8
    s_sub_u32 s42, 0x80000, s6
    s_add_u32 s5, s5, s6
    s_add_u32 s40, s16, s5
    s_addc_u32 s41, s17, 0
    s_mov_b32 s43, 0x20000
    s_lshl_b32 s5, s61, 3
    s_add_u32 s5, s5, s60
    s_mul_i32 s5, s5, 163840
    s_add_u32 s5, s5, 2097152
    s_add_u32 s44, s22, s5
    s_addc_u32 s45, s23, 0
    s_mov_b32 s46, 163840
    s_mov_b32 s47, 0x20000
    s_lshl_b32 s5, s61, 2
    s_add_u32 s5, s5, s57
    s_mul_i32 s5, s5, 327680
    s_add_u32 s5, s5, 14680064
    s_add_u32 s48, s22, s5
    s_addc_u32 s49, s23, 0
    s_mov_b32 s50, 327680
    s_mov_b32 s51, 0x20000
    s_mul_i32 s5, s61, 163840
    s_add_u32 s52, s18, s5
    s_addc_u32 s53, s19, 0
    s_mov_b32 s54, 163840
    s_mov_b32 s55, 0x20000
    s_and_b32 s5, s4, 1
    s_lshr_b32 s6, s4, 1
    v_xor_b32 v68, v67, v70
    v_lshlrev_b32 v3, 8, v70
    v_lshl_add_u32 v3, v68, 4, v3
    v_bfe_u32 v68, v64, 1, 1
    v_lshlrev_b32 v68, 2, v68
    v_bfe_u32 v71, v64, 2, 1
    v_lshl_or_b32 v68, v71, 1, v68
    v_xor_b32 v68, v66, v68
    v_lshlrev_b32 v4, 8, v69
    v_lshl_add_u32 v4, v68, 4, v4
    s_lshl_b32 s7, s5, 1
    v_lshl_or_b32 v68, v65, 2, s7
    v_xor_b32 v68, v67, v68
    v_lshlrev_b32 v5, 10, v70
    v_lshl_add_u32 v5, v68, 4, v5
    v_bfe_u32 v72, v0, 2, 2
    v_and_b32 v73, 3, v0
    v_and_b32 v74, 1, v65
    s_lshl_b32 s7, s5, 13
    s_add_u32 s7, s7, 98304
    v_xor_b32 v68, v65, v67
    v_lshlrev_b32 v71, 8, v67
    v_add_u32 v71, s7, v71
    v_lshl_add_u32 v10, v68, 4, v71
    v_xor_b32 v11, 64, v10
    v_xor_b32 v12, 128, v10
    v_xor_b32 v13, 192, v10
    s_lshl_b32 s7, s5, 5
    v_lshl_add_u32 v68, v65, 2, v72
    v_add_u32 v68, s7, v68
    v_lshlrev_b32 v75, 3, v73
    v_lshl_add_u32 v75, v74, 5, v75
    v_lshrrev_b32 v71, 1, v72
    v_xor_b32 v71, s5, v71
    v_lshl_add_u32 v71, v71, 6, v75
    v_lshl_add_u32 v14, v68, 7, v71
    v_xor_b32 v15, 32, v14
    v_xor_b32 v16, 64, v14
    v_xor_b32 v17, 96, v14
    s_lshl_b32 s7, s5, 1
    v_xor_b32 v71, s7, v72
    v_lshl_add_u32 v71, v71, 6, v75
    v_lshl_add_u32 v18, v68, 8, v71
    v_xor_b32 v19, 32, v18
    v_xor_b32 v20, 64, v18
    v_xor_b32 v21, 96, v18
    v_xor_b32 v22, 128, v18
    v_xor_b32 v23, 160, v18
    v_xor_b32 v24, 192, v18
    v_xor_b32 v25, 224, v18
    v_lshlrev_b32 v26, 4, v0
    v_mov_b32 v44, 0x3f803f80
    v_mov_b32 v45, 0x3f803f80
    v_mov_b32 v46, 0x3f803f80
    v_mov_b32 v47, 0x3f803f80
    s_mov_b32 s100, 1
    s_lshl_b32 s101, s100, 19
    s_lshl_b32 s100, s100, 7
    s_add_u32 m0, s65, 37120
    s_add_u32 s7, s100, 0
    buffer_load_dwordx4 v1, s[24:27], s7 offen lds
    s_add_u32 m0, s59, 57600
    s_add_u32 s7, s101, 0
    buffer_load_dwordx4 v2, s[28:31], s7 offen lds
    s_add_u32 m0, s65, 41216
    s_add_u32 s7, s100, 32768
    buffer_load_dwordx4 v1, s[24:27], s7 offen lds
    s_add_u32 m0, s59, 59648
    s_add_u32 s7, s101, 131072
    buffer_load_dwordx4 v2, s[28:31], s7 offen lds
    s_add_u32 m0, s65, 45312
    s_add_u32 s7, s100, 65536
    buffer_load_dwordx4 v1, s[24:27], s7 offen lds
    s_add_u32 m0, s59, 61696
    s_add_u32 s7, s101, 262144
    buffer_load_dwordx4 v2, s[28:31], s7 offen lds
    s_add_u32 m0, s65, 49408
    s_add_u32 s7, s100, 98304
    buffer_load_dwordx4 v1, s[24:27], s7 offen lds
    s_add_u32 m0, s59, 63744
    s_add_u32 s7, s101, 393216
    buffer_load_dwordx4 v2, s[28:31], s7 offen lds
    s_add_u32 m0, s65, 53504
    s_add_u32 s7, s100, 131072
    buffer_load_dwordx4 v1, s[24:27], s7 offen lds
    s_lshr_b32 s6, s4, 1
    s_lshl_b32 s6, s6, 10
    v_add_u32 v38, s6, v26
    s_waitcnt vmcnt(9)
    s_barrier
    s_lshl_b32 s7, s61, 2
    s_add_u32 s7, s7, s57
    s_lshl_b32 s7, s7, 6
    s_sub_u32 s7, s7, s57
    s_lshl_b32 s7, s7, 8
    s_add_u32 s7, s7, 0
    buffer_load_dwordx4 v[176:179], v3, s[40:43], s7 offen
    s_xor_b32 s100, s64, 2
    s_lshl_b32 s101, s100, 19
    s_lshl_b32 s100, s100, 7
    s_add_u32 m0, s65, 74240
    s_add_u32 s7, s100, 0
    buffer_load_dwordx4 v1, s[24:27], s7 offen lds
    s_add_u32 m0, s59, 94720
    s_add_u32 s7, s101, 0
    buffer_load_dwordx4 v2, s[28:31], s7 offen lds
    s_add_u32 m0, s65, 78336
    s_add_u32 s7, s100, 32768
    buffer_load_dwordx4 v1, s[24:27], s7 offen lds
    s_add_u32 m0, s59, 96768
    s_add_u32 s7, s101, 131072
    buffer_load_dwordx4 v2, s[28:31], s7 offen lds
    s_add_u32 m0, s65, 82432
    s_add_u32 s7, s100, 65536
    buffer_load_dwordx4 v1, s[24:27], s7 offen lds
    s_add_u32 m0, s59, 98816
    s_add_u32 s7, s101, 262144
    buffer_load_dwordx4 v2, s[28:31], s7 offen lds
    s_add_u32 m0, s65, 86528
    s_add_u32 s7, s100, 98304
    buffer_load_dwordx4 v1, s[24:27], s7 offen lds
    s_add_u32 m0, s59, 100864
    s_add_u32 s7, s101, 393216
    buffer_load_dwordx4 v2, s[28:31], s7 offen lds
    s_waitcnt vmcnt(9)
    s_barrier
    s_add_u32 m0, s65, 90624
    s_add_u32 s7, s100, 131072
    buffer_load_dwordx4 v1, s[24:27], s7 offen lds
    s_lshl_b32 s7, s61, 2
    s_add_u32 s7, s7, s57
    s_lshl_b32 s7, s7, 6
    s_sub_u32 s7, s7, s57
    s_lshl_b32 s7, s7, 8
    s_add_u32 s7, s7, 4096
    buffer_load_dwordx4 v[180:183], v3, s[40:43], s7 offen
    s_xor_b32 s100, s64, 4
    s_lshl_b32 s101, s100, 19
    s_lshl_b32 s100, s100, 7
    s_add_u32 m0, s65, 0
    s_add_u32 s7, s100, 0
    buffer_load_dwordx4 v1, s[24:27], s7 offen lds
    s_add_u32 m0, s59, 20480
    s_add_u32 s7, s101, 0
    buffer_load_dwordx4 v2, s[28:31], s7 offen lds
    s_add_u32 m0, s65, 4096
    s_add_u32 s7, s100, 32768
    buffer_load_dwordx4 v1, s[24:27], s7 offen lds
    s_add_u32 m0, s59, 22528
    s_add_u32 s7, s101, 131072
    buffer_load_dwordx4 v2, s[28:31], s7 offen lds
    s_add_u32 m0, s65, 8192
    s_add_u32 s7, s100, 65536
    buffer_load_dwordx4 v1, s[24:27], s7 offen lds
    s_add_u32 m0, s59, 24576
    s_add_u32 s7, s101, 262144
    buffer_load_dwordx4 v2, s[28:31], s7 offen lds
    s_add_u32 m0, s65, 12288
    s_add_u32 s7, s100, 98304
    buffer_load_dwordx4 v1, s[24:27], s7 offen lds
    s_add_u32 m0, s59, 26624
    s_add_u32 s7, s101, 393216
    buffer_load_dwordx4 v2, s[28:31], s7 offen lds
    s_waitcnt vmcnt(9)
    s_barrier
    s_add_u32 m0, s65, 16384
    s_add_u32 s7, s100, 131072
    buffer_load_dwordx4 v1, s[24:27], s7 offen lds
    s_lshl_b32 s7, s61, 2
    s_add_u32 s7, s7, s57
    s_lshl_b32 s7, s7, 6
    s_sub_u32 s7, s7, s57
    s_lshl_b32 s7, s7, 8
    s_add_u32 s7, s7, 8192
    buffer_load_dwordx4 v[184:187], v3, s[40:43], s7 offen
    s_xor_b32 s100, s64, 6
    s_lshl_b32 s101, s100, 19
    s_lshl_b32 s100, s100, 7
    s_add_u32 m0, s65, 37120
    s_add_u32 s7, s100, 0
    buffer_load_dwordx4 v1, s[24:27], s7 offen lds
    s_add_u32 m0, s59, 57600
    s_add_u32 s7, s101, 0
    buffer_load_dwordx4 v2, s[28:31], s7 offen lds
    s_add_u32 m0, s65, 41216
    s_add_u32 s7, s100, 32768
    buffer_load_dwordx4 v1, s[24:27], s7 offen lds
    s_add_u32 m0, s59, 59648
    s_add_u32 s7, s101, 131072
    buffer_load_dwordx4 v2, s[28:31], s7 offen lds
    s_add_u32 m0, s65, 45312
    s_add_u32 s7, s100, 65536
    buffer_load_dwordx4 v1, s[24:27], s7 offen lds
    s_add_u32 m0, s59, 61696
    s_add_u32 s7, s101, 262144
    buffer_load_dwordx4 v2, s[28:31], s7 offen lds
    s_add_u32 m0, s65, 49408
    s_add_u32 s7, s100, 98304
    buffer_load_dwordx4 v1, s[24:27], s7 offen lds
    s_add_u32 m0, s59, 63744
    s_add_u32 s7, s101, 393216
    buffer_load_dwordx4 v2, s[28:31], s7 offen lds
    s_waitcnt vmcnt(9)
    s_barrier
    s_add_u32 m0, s65, 53504
    s_add_u32 s7, s100, 131072
    buffer_load_dwordx4 v1, s[24:27], s7 offen lds
    s_lshl_b32 s7, s61, 2
    s_add_u32 s7, s7, s57
    s_lshl_b32 s7, s7, 6
    s_sub_u32 s7, s7, s57
    s_lshl_b32 s7, s7, 8
    s_add_u32 s7, s7, 12288
    buffer_load_dwordx4 v[188:191], v3, s[40:43], s7 offen
    s_xor_b32 s100, s64, 3
    s_lshl_b32 s101, s100, 19
    s_lshl_b32 s100, s100, 7
    s_add_u32 m0, s65, 74240
    s_add_u32 s7, s100, 0
    buffer_load_dwordx4 v1, s[24:27], s7 offen lds
    s_add_u32 m0, s59, 94720
    s_add_u32 s7, s101, 0
    buffer_load_dwordx4 v2, s[28:31], s7 offen lds
    s_add_u32 m0, s65, 78336
    s_add_u32 s7, s100, 32768
    buffer_load_dwordx4 v1, s[24:27], s7 offen lds
    s_add_u32 m0, s59, 96768
    s_add_u32 s7, s101, 131072
    buffer_load_dwordx4 v2, s[28:31], s7 offen lds
    s_add_u32 m0, s65, 82432
    s_add_u32 s7, s100, 65536
    buffer_load_dwordx4 v1, s[24:27], s7 offen lds
    s_add_u32 m0, s59, 98816
    s_add_u32 s7, s101, 262144
    buffer_load_dwordx4 v2, s[28:31], s7 offen lds
    s_add_u32 m0, s65, 86528
    s_add_u32 s7, s100, 98304
    buffer_load_dwordx4 v1, s[24:27], s7 offen lds
    s_add_u32 m0, s59, 100864
    s_add_u32 s7, s101, 393216
    buffer_load_dwordx4 v2, s[28:31], s7 offen lds
    s_waitcnt vmcnt(9)
    s_barrier
    s_add_u32 m0, s65, 90624
    s_add_u32 s7, s100, 131072
    buffer_load_dwordx4 v1, s[24:27], s7 offen lds
    s_xor_b32 s100, s64, 5
    s_lshl_b32 s101, s100, 19
    s_lshl_b32 s100, s100, 7
    s_add_u32 m0, s65, 0
    s_add_u32 s7, s100, 0
    buffer_load_dwordx4 v1, s[24:27], s7 offen lds
    s_add_u32 m0, s59, 20480
    s_add_u32 s7, s101, 0
    buffer_load_dwordx4 v2, s[28:31], s7 offen lds
    s_add_u32 m0, s65, 4096
    s_add_u32 s7, s100, 32768
    buffer_load_dwordx4 v1, s[24:27], s7 offen lds
    s_add_u32 m0, s59, 22528
    s_add_u32 s7, s101, 131072
    buffer_load_dwordx4 v2, s[28:31], s7 offen lds
    s_add_u32 m0, s65, 8192
    s_add_u32 s7, s100, 65536
    buffer_load_dwordx4 v1, s[24:27], s7 offen lds
    s_add_u32 m0, s59, 24576
    s_add_u32 s7, s101, 262144
    buffer_load_dwordx4 v2, s[28:31], s7 offen lds
    s_add_u32 m0, s65, 12288
    s_add_u32 s7, s100, 98304
    buffer_load_dwordx4 v1, s[24:27], s7 offen lds
    s_add_u32 m0, s59, 26624
    s_add_u32 s7, s101, 393216
    buffer_load_dwordx4 v2, s[28:31], s7 offen lds
    s_add_u32 m0, s65, 16384
    s_add_u32 s7, s100, 131072
    buffer_load_dwordx4 v1, s[24:27], s7 offen lds
    s_waitcnt vmcnt(9)
    s_barrier
    s_xor_b32 s100, s64, 7
    s_lshl_b32 s101, s100, 19
    s_lshl_b32 s100, s100, 7
    s_add_u32 m0, s65, 37120
    s_add_u32 s7, s100, 0
    buffer_load_dwordx4 v1, s[24:27], s7 offen lds
    s_add_u32 m0, s59, 57600
    s_add_u32 s7, s101, 0
    buffer_load_dwordx4 v2, s[28:31], s7 offen lds
    s_add_u32 m0, s65, 41216
    s_add_u32 s7, s100, 32768
    buffer_load_dwordx4 v1, s[24:27], s7 offen lds
    s_add_u32 m0, s59, 59648
    s_add_u32 s7, s101, 131072
    buffer_load_dwordx4 v2, s[28:31], s7 offen lds
    s_add_u32 m0, s65, 45312
    s_add_u32 s7, s100, 65536
    buffer_load_dwordx4 v1, s[24:27], s7 offen lds
    s_add_u32 m0, s59, 61696
    s_add_u32 s7, s101, 262144
    buffer_load_dwordx4 v2, s[28:31], s7 offen lds
    s_add_u32 m0, s65, 49408
    s_add_u32 s7, s100, 98304
    buffer_load_dwordx4 v1, s[24:27], s7 offen lds
    s_add_u32 m0, s59, 63744
    s_add_u32 s7, s101, 393216
    buffer_load_dwordx4 v2, s[28:31], s7 offen lds
    s_add_u32 m0, s65, 53504
    s_add_u32 s7, s100, 131072
    buffer_load_dwordx4 v1, s[24:27], s7 offen lds
    s_waitcnt vmcnt(9)
    s_barrier
    s_add_u32 m0, s65, 114688
    s_add_u32 s7, s56, 0
    s_and_b32 s7, s7, 0x1ffff
    buffer_load_dwordx4 v3, s[32:35], s7 offen nt lds
    s_add_u32 m0, s65, 118784
    s_add_u32 s7, s56, 4096
    s_and_b32 s7, s7, 0x1ffff
    buffer_load_dwordx4 v3, s[32:35], s7 offen nt lds
    s_add_u32 m0, s65, 122880
    s_add_u32 s7, s56, 8192
    s_and_b32 s7, s7, 0x1ffff
    buffer_load_dwordx4 v3, s[32:35], s7 offen nt lds
    s_add_u32 m0, s65, 126976
    s_add_u32 s7, s56, 12288
    s_and_b32 s7, s7, 0x1ffff
    buffer_load_dwordx4 v3, s[32:35], s7 offen nt lds
    s_add_u32 m0, s65, 131072
    s_add_u32 s7, s56, 16384
    s_and_b32 s7, s7, 0x1ffff
    buffer_load_dwordx4 v3, s[32:35], s7 offen nt lds
    s_add_u32 m0, s65, 135168
    s_add_u32 s7, s56, 20480
    s_and_b32 s7, s7, 0x1ffff
    buffer_load_dwordx4 v3, s[32:35], s7 offen nt lds
    s_add_u32 m0, s65, 139264
    s_add_u32 s7, s56, 24576
    s_and_b32 s7, s7, 0x1ffff
    buffer_load_dwordx4 v3, s[32:35], s7 offen nt lds
    s_add_u32 m0, s65, 143360
    s_add_u32 s7, s56, 28672
    s_and_b32 s7, s7, 0x1ffff
    buffer_load_dwordx4 v3, s[32:35], s7 offen nt lds
    s_add_u32 m0, s65, 147456
    s_add_u32 s7, s56, 32768
    s_and_b32 s7, s7, 0x1ffff
    buffer_load_dwordx4 v3, s[32:35], s7 offen nt lds
    s_waitcnt vmcnt(9)
    s_barrier
    s_waitcnt vmcnt(5)
    s_barrier
    ds_read_b128 v[96:99], v38 offset:16384
    ds_read_b128 v[100:103], v38 offset:18432
    ds_read_b128 v[104:107], v38 offset:20480
    ds_read_b128 v[108:111], v38 offset:22528
    ds_read_b128 v[64:67], v10 offset:16384
    s_add_u32 m0, s65, 151552
    s_add_u32 s7, s56, 36864
    s_and_b32 s7, s7, 0x1ffff
    buffer_load_dwordx4 v3, s[32:35], s7 offen nt lds
    ds_read_b128 v[68:71], v10 offset:20480
    s_add_u32 m0, s65, 155648
    s_add_u32 s7, s56, 40960
    s_and_b32 s7, s7, 0x1ffff
    buffer_load_dwordx4 v3, s[32:35], s7 offen nt lds
    ds_read_b128 v[72:75], v11 offset:16384
    s_add_u32 m0, s65, 159744
    s_add_u32 s7, s56, 45056
    s_and_b32 s7, s7, 0x1ffff
    buffer_load_dwordx4 v3, s[32:35], s7 offen nt lds
    ds_read_b128 v[76:79], v11 offset:20480
    s_nop 7
    ds_read_b128 v[80:83], v12 offset:16384
    s_nop 7
    ds_read_b128 v[84:87], v12 offset:20480
    s_nop 7
    ds_read_b128 v[88:91], v13 offset:16384
    s_nop 7
    ds_read_b128 v[92:95], v13 offset:20480
    s_nop 7
    s_waitcnt vmcnt(4)
    s_barrier
    s_waitcnt lgkmcnt(7)
    v_mfma_f32_16x16x32_bf16 v[112:115], v[64:67], v[96:99], 0
    ds_read_b128 v[64:67], v10 offset:32768
    s_waitcnt vmcnt(5)
    s_add_u32 m0, s65, 98304
    s_add_u32 s7, s56, 49152
    s_and_b32 s7, s7, 0x1ffff
    buffer_load_dwordx4 v3, s[32:35], s7 offen nt lds
    s_waitcnt lgkmcnt(7)
    v_mfma_f32_16x16x32_bf16 v[116:119], v[68:71], v[96:99], 0
    ds_read_b128 v[68:71], v10 offset:36864
    s_waitcnt vmcnt(5)
    s_add_u32 m0, s65, 102400
    s_add_u32 s7, s56, 53248
    s_and_b32 s7, s7, 0x1ffff
    buffer_load_dwordx4 v3, s[32:35], s7 offen nt lds
    s_waitcnt lgkmcnt(7)
    v_mfma_f32_16x16x32_bf16 v[112:115], v[72:75], v[100:103], v[112:115]
    ds_read_b128 v[72:75], v11 offset:32768
    s_add_u32 s100, s62, 0
    s_and_b32 s100, s100, 3
    s_lshl_b32 s100, s100, 17
    s_waitcnt vmcnt(5)
    s_add_u32 m0, s65, 0
    s_add_u32 s7, s100, 0
    buffer_load_dwordx4 v5, s[40:43], s7 offen lds
    s_waitcnt lgkmcnt(7)
    v_mfma_f32_16x16x32_bf16 v[116:119], v[76:79], v[100:103], v[116:119]
    ds_read_b128 v[76:79], v11 offset:36864
    s_waitcnt vmcnt(5)
    s_add_u32 m0, s65, 106496
    s_add_u32 s7, s56, 57344
    s_and_b32 s7, s7, 0x1ffff
    buffer_load_dwordx4 v3, s[32:35], s7 offen nt lds
    s_waitcnt lgkmcnt(7)
    v_mfma_f32_16x16x32_bf16 v[112:115], v[80:83], v[104:107], v[112:115]
    ds_read_b128 v[80:83], v12 offset:32768
    s_waitcnt vmcnt(5)
    s_add_u32 m0, s65, 110592
    s_add_u32 s7, s56, 61440
    s_and_b32 s7, s7, 0x1ffff
    buffer_load_dwordx4 v3, s[32:35], s7 offen nt lds
    s_waitcnt lgkmcnt(7)
    v_mfma_f32_16x16x32_bf16 v[116:119], v[84:87], v[104:107], v[116:119]
    ds_read_b128 v[84:87], v12 offset:36864
    s_waitcnt lgkmcnt(7)
    v_mfma_f32_16x16x32_bf16 v[112:115], v[88:91], v[108:111], v[112:115]
    ds_read_b128 v[88:91], v13 offset:32768
    s_waitcnt lgkmcnt(7)
    v_mfma_f32_16x16x32_bf16 v[116:119], v[92:95], v[108:111], v[116:119]
    ds_read_b128 v[92:95], v13 offset:36864
    s_waitcnt vmcnt(5)
    s_barrier
    s_waitcnt lgkmcnt(7)
    v_mfma_f32_16x16x32_bf16 v[120:123], v[64:67], v[96:99], 0
    ds_read_b128 v[64:67], v10 offset:49152
    v_max3_f32 v30, v112, v113, v114
    s_waitcnt vmcnt(5)
    s_add_u32 m0, s65, 4096
    s_add_u32 s7, s100, 16384
    buffer_load_dwordx4 v5, s[40:43], s7 offen lds
    s_waitcnt lgkmcnt(7)
    v_mfma_f32_16x16x32_bf16 v[124:127], v[68:71], v[96:99], 0
    ds_read_b128 v[68:71], v10 offset:53248
    v_max3_f32 v30, v30, v115, v116
    s_waitcnt vmcnt(5)
    s_add_u32 m0, s65, 81920
    s_add_u32 s7, s56, 65536
    s_and_b32 s7, s7, 0x1ffff
    buffer_load_dwordx4 v3, s[32:35], s7 offen nt lds
    s_waitcnt lgkmcnt(7)
    v_mfma_f32_16x16x32_bf16 v[120:123], v[72:75], v[100:103], v[120:123]
    ds_read_b128 v[72:75], v11 offset:49152
    v_max3_f32 v30, v30, v117, v118
    s_waitcnt vmcnt(5)
    s_add_u32 m0, s65, 86016
    s_add_u32 s7, s56, 69632
    s_and_b32 s7, s7, 0x1ffff
    buffer_load_dwordx4 v3, s[32:35], s7 offen nt lds
    s_waitcnt lgkmcnt(7)
    v_mfma_f32_16x16x32_bf16 v[124:127], v[76:79], v[100:103], v[124:127]
    ds_read_b128 v[76:79], v11 offset:53248
    v_max_f32 v30, v30, v119
    s_waitcnt vmcnt(5)
    s_add_u32 m0, s65, 8192
    s_add_u32 s7, s100, 32768
    buffer_load_dwordx4 v5, s[40:43], s7 offen lds
    s_waitcnt lgkmcnt(7)
    v_mfma_f32_16x16x32_bf16 v[120:123], v[80:83], v[104:107], v[120:123]
    ds_read_b128 v[80:83], v12 offset:49152
    s_waitcnt vmcnt(5)
    s_add_u32 m0, s65, 90112
    s_add_u32 s7, s56, 73728
    s_and_b32 s7, s7, 0x1ffff
    buffer_load_dwordx4 v3, s[32:35], s7 offen nt lds
    s_waitcnt lgkmcnt(7)
    v_mfma_f32_16x16x32_bf16 v[124:127], v[84:87], v[104:107], v[124:127]
    ds_read_b128 v[84:87], v12 offset:53248
    s_waitcnt vmcnt(5)
    s_add_u32 m0, s65, 94208
    s_add_u32 s7, s56, 77824
    s_and_b32 s7, s7, 0x1ffff
    buffer_load_dwordx4 v3, s[32:35], s7 offen nt lds
    s_waitcnt lgkmcnt(7)
    v_mfma_f32_16x16x32_bf16 v[120:123], v[88:91], v[108:111], v[120:123]
    ds_read_b128 v[88:91], v13 offset:49152
    s_waitcnt lgkmcnt(7)
    v_mfma_f32_16x16x32_bf16 v[124:127], v[92:95], v[108:111], v[124:127]
    ds_read_b128 v[92:95], v13 offset:53248
    s_waitcnt vmcnt(6)
    s_barrier
    s_waitcnt lgkmcnt(7)
    v_mfma_f32_16x16x32_bf16 v[128:131], v[64:67], v[96:99], 0
    ds_read_b128 v[64:67], v10
    v_max3_f32 v30, v30, v120, v121
    s_waitcnt vmcnt(5)
    s_add_u32 m0, s65, 12288
    s_add_u32 s7, s100, 49152
    buffer_load_dwordx4 v5, s[40:43], s7 offen lds
    s_waitcnt lgkmcnt(7)
    v_mfma_f32_16x16x32_bf16 v[132:135], v[68:71], v[96:99], 0
    ds_read_b128 v[68:71], v10 offset:4096
    v_max3_f32 v30, v30, v122, v123
    s_waitcnt vmcnt(5)
    s_add_u32 m0, s65, 114688
    s_add_u32 s7, s56, 81920
    s_and_b32 s7, s7, 0x1ffff
    buffer_load_dwordx4 v3, s[32:35], s7 offen nt lds
    s_waitcnt lgkmcnt(7)
    v_mfma_f32_16x16x32_bf16 v[128:131], v[72:75], v[100:103], v[128:131]
    ds_read_b128 v[72:75], v11
    v_max3_f32 v30, v30, v124, v125
    s_waitcnt vmcnt(5)
    s_add_u32 m0, s65, 118784
    s_add_u32 s7, s56, 86016
    s_and_b32 s7, s7, 0x1ffff
    buffer_load_dwordx4 v3, s[32:35], s7 offen nt lds
    s_waitcnt lgkmcnt(7)
    v_mfma_f32_16x16x32_bf16 v[132:135], v[76:79], v[100:103], v[132:135]
    ds_read_b128 v[76:79], v11 offset:4096
    v_max3_f32 v30, v30, v126, v127
    s_add_u32 s100, s62, 0
    s_and_b32 s100, s100, 3
    s_lshl_b32 s100, s100, 17
    s_waitcnt vmcnt(5)
    s_add_u32 m0, s65, 32768
    s_add_u32 s7, s100, 65536
    buffer_load_dwordx4 v5, s[40:43], s7 offen lds
    s_waitcnt lgkmcnt(7)
    v_mfma_f32_16x16x32_bf16 v[128:131], v[80:83], v[104:107], v[128:131]
    ds_read_b128 v[80:83], v12
    s_waitcnt vmcnt(5)
    s_add_u32 m0, s65, 122880
    s_add_u32 s7, s56, 90112
    s_and_b32 s7, s7, 0x1ffff
    buffer_load_dwordx4 v3, s[32:35], s7 offen nt lds
    s_waitcnt lgkmcnt(7)
    v_mfma_f32_16x16x32_bf16 v[132:135], v[84:87], v[104:107], v[132:135]
    ds_read_b128 v[84:87], v12 offset:4096
    s_waitcnt vmcnt(5)
    s_add_u32 m0, s65, 126976
    s_add_u32 s7, s56, 94208
    s_and_b32 s7, s7, 0x1ffff
    buffer_load_dwordx4 v3, s[32:35], s7 offen nt lds
    s_waitcnt lgkmcnt(7)
    v_mfma_f32_16x16x32_bf16 v[128:131], v[88:91], v[108:111], v[128:131]
    ds_read_b128 v[88:91], v13
    s_waitcnt lgkmcnt(7)
    v_mfma_f32_16x16x32_bf16 v[132:135], v[92:95], v[108:111], v[132:135]
    ds_read_b128 v[92:95], v13 offset:4096
    s_load_dwordx2 s[68:69], s[20:21], 0
    s_waitcnt vmcnt(6)
    s_barrier
    s_waitcnt lgkmcnt(7)
    v_mfma_f32_16x16x32_bf16 v[136:139], v[64:67], v[96:99], 0
    v_add_u32 v10, 0xffffc000, v10
    v_add_u32 v11, 0xffffc000, v11
    v_add_u32 v12, 0xffffc000, v12
    v_add_u32 v13, 0xffffc000, v13
    ds_read_b128 v[64:67], v10
    v_max3_f32 v30, v30, v128, v129
    s_waitcnt vmcnt(5)
    s_add_u32 m0, s65, 36864
    s_add_u32 s7, s100, 81920
    buffer_load_dwordx4 v5, s[40:43], s7 offen lds
    s_waitcnt lgkmcnt(7)
    v_mfma_f32_16x16x32_bf16 v[140:143], v[68:71], v[96:99], 0
    ds_read_b128 v[68:71], v10 offset:4096
    v_max3_f32 v30, v30, v130, v131
    s_waitcnt vmcnt(5)
    s_add_u32 m0, s65, 131072
    s_add_u32 s7, s56, 98304
    s_and_b32 s7, s7, 0x1ffff
    buffer_load_dwordx4 v3, s[32:35], s7 offen nt lds
    s_waitcnt lgkmcnt(7)
    v_mfma_f32_16x16x32_bf16 v[136:139], v[72:75], v[100:103], v[136:139]
    ds_read_b128 v[72:75], v11
    v_max3_f32 v30, v30, v132, v133
    s_waitcnt vmcnt(5)
    s_add_u32 m0, s65, 135168
    s_add_u32 s7, s56, 102400
    s_and_b32 s7, s7, 0x1ffff
    buffer_load_dwordx4 v3, s[32:35], s7 offen nt lds
    s_waitcnt lgkmcnt(7)
    v_mfma_f32_16x16x32_bf16 v[140:143], v[76:79], v[100:103], v[140:143]
    ds_read_b128 v[76:79], v11 offset:4096
    v_max3_f32 v30, v30, v134, v135
    s_waitcnt vmcnt(5)
    s_add_u32 m0, s65, 40960
    s_add_u32 s7, s100, 98304
    buffer_load_dwordx4 v5, s[40:43], s7 offen lds
    s_waitcnt lgkmcnt(7)
    v_mfma_f32_16x16x32_bf16 v[136:139], v[80:83], v[104:107], v[136:139]
    ds_read_b128 v[80:83], v12
    s_waitcnt vmcnt(5)
    s_add_u32 m0, s65, 139264
    s_add_u32 s7, s56, 106496
    s_and_b32 s7, s7, 0x1ffff
    buffer_load_dwordx4 v3, s[32:35], s7 offen nt lds
    s_waitcnt lgkmcnt(7)
    v_mfma_f32_16x16x32_bf16 v[140:143], v[84:87], v[104:107], v[140:143]
    ds_read_b128 v[84:87], v12 offset:4096
    s_waitcnt vmcnt(5)
    s_add_u32 m0, s65, 143360
    s_add_u32 s7, s56, 110592
    s_and_b32 s7, s7, 0x1ffff
    buffer_load_dwordx4 v3, s[32:35], s7 offen nt lds
    s_waitcnt lgkmcnt(7)
    v_mfma_f32_16x16x32_bf16 v[136:139], v[88:91], v[108:111], v[136:139]
    ds_read_b128 v[88:91], v13
    s_waitcnt lgkmcnt(7)
    v_mfma_f32_16x16x32_bf16 v[140:143], v[92:95], v[108:111], v[140:143]
    ds_read_b128 v[92:95], v13 offset:4096
    s_waitcnt vmcnt(6)
    s_barrier
    s_waitcnt lgkmcnt(7)
    v_mfma_f32_16x16x32_bf16 v[144:147], v[64:67], v[96:99], 0
    ds_read_b128 v[64:67], v10 offset:32768
    v_max3_f32 v30, v30, v136, v137
    s_waitcnt vmcnt(5)
    s_add_u32 m0, s65, 45056
    s_add_u32 s7, s100, 114688
    buffer_load_dwordx4 v5, s[40:43], s7 offen lds
    s_waitcnt lgkmcnt(7)
    v_mfma_f32_16x16x32_bf16 v[148:151], v[68:71], v[96:99], 0
    ds_read_b128 v[68:71], v10 offset:36864
    v_max3_f32 v30, v30, v138, v139
    s_waitcnt vmcnt(5)
    s_add_u32 m0, s65, 147456
    s_add_u32 s7, s56, 114688
    s_and_b32 s7, s7, 0x1ffff
    buffer_load_dwordx4 v3, s[32:35], s7 offen nt lds
    s_waitcnt lgkmcnt(7)
    v_mfma_f32_16x16x32_bf16 v[144:147], v[72:75], v[100:103], v[144:147]
    ds_read_b128 v[72:75], v11 offset:32768
    v_max3_f32 v30, v30, v140, v141
    s_waitcnt vmcnt(5)
    s_add_u32 m0, s65, 151552
    s_add_u32 s7, s56, 118784
    s_and_b32 s7, s7, 0x1ffff
    buffer_load_dwordx4 v3, s[32:35], s7 offen nt lds
    s_waitcnt lgkmcnt(7)
    v_mfma_f32_16x16x32_bf16 v[148:151], v[76:79], v[100:103], v[148:151]
    ds_read_b128 v[76:79], v11 offset:36864
    v_max3_f32 v30, v30, v142, v143
    s_add_u32 s100, s62, 1
    s_and_b32 s100, s100, 3
    s_lshl_b32 s100, s100, 17
    s_waitcnt vmcnt(5)
    s_add_u32 m0, s65, 49152
    s_add_u32 s7, s100, 0
    buffer_load_dwordx4 v5, s[40:43], s7 offen lds
    s_waitcnt lgkmcnt(7)
    v_mfma_f32_16x16x32_bf16 v[144:147], v[80:83], v[104:107], v[144:147]
    ds_read_b128 v[80:83], v12 offset:32768
    s_waitcnt vmcnt(5)
    s_add_u32 m0, s65, 155648
    s_add_u32 s7, s56, 122880
    s_and_b32 s7, s7, 0x1ffff
    buffer_load_dwordx4 v3, s[32:35], s7 offen nt lds
    s_waitcnt lgkmcnt(7)
    v_mfma_f32_16x16x32_bf16 v[148:151], v[84:87], v[104:107], v[148:151]
    ds_read_b128 v[84:87], v12 offset:36864
    s_waitcnt vmcnt(5)
    s_add_u32 m0, s65, 159744
    s_add_u32 s7, s56, 126976
    s_and_b32 s7, s7, 0x1ffff
    buffer_load_dwordx4 v3, s[32:35], s7 offen nt lds
    s_waitcnt lgkmcnt(7)
    v_mfma_f32_16x16x32_bf16 v[144:147], v[88:91], v[108:111], v[144:147]
    ds_read_b128 v[88:91], v13 offset:32768
    s_waitcnt lgkmcnt(7)
    v_mfma_f32_16x16x32_bf16 v[148:151], v[92:95], v[108:111], v[148:151]
    ds_read_b128 v[92:95], v13 offset:36864
    s_waitcnt vmcnt(6)
    s_barrier
    s_waitcnt lgkmcnt(7)
    v_mfma_f32_16x16x32_bf16 v[152:155], v[64:67], v[96:99], 0
    ds_read_b128 v[64:67], v10 offset:49152
    v_max3_f32 v30, v30, v144, v145
    s_waitcnt vmcnt(5)
    s_add_u32 m0, s65, 53248
    s_add_u32 s7, s100, 16384
    buffer_load_dwordx4 v5, s[40:43], s7 offen lds
    s_waitcnt lgkmcnt(7)
    v_mfma_f32_16x16x32_bf16 v[156:159], v[68:71], v[96:99], 0
    ds_read_b128 v[68:71], v10 offset:53248
    v_max3_f32 v30, v30, v146, v147
    s_waitcnt vmcnt(5)
    s_add_u32 m0, s65, 98304
    s_add_u32 s7, s56, 0
    s_and_b32 s7, s7, 0x1ffff
    buffer_load_dwordx4 v4, s[36:39], s7 offen nt lds
    s_waitcnt lgkmcnt(7)
    v_mfma_f32_16x16x32_bf16 v[152:155], v[72:75], v[100:103], v[152:155]
    ds_read_b128 v[72:75], v11 offset:49152
    v_max3_f32 v30, v30, v148, v149
    s_waitcnt vmcnt(5)
    s_add_u32 m0, s65, 102400
    s_add_u32 s7, s56, 8192
    s_and_b32 s7, s7, 0x1ffff
    buffer_load_dwordx4 v4, s[36:39], s7 offen nt lds
    s_waitcnt lgkmcnt(7)
    v_mfma_f32_16x16x32_bf16 v[156:159], v[76:79], v[100:103], v[156:159]
    ds_read_b128 v[76:79], v11 offset:53248
    v_max3_f32 v30, v30, v150, v151
    s_waitcnt vmcnt(5)
    s_add_u32 m0, s65, 57344
    s_add_u32 s7, s100, 32768
    buffer_load_dwordx4 v5, s[40:43], s7 offen lds
    s_waitcnt lgkmcnt(7)
    v_mfma_f32_16x16x32_bf16 v[152:155], v[80:83], v[104:107], v[152:155]
    ds_read_b128 v[80:83], v12 offset:49152
    s_waitcnt vmcnt(5)
    s_add_u32 m0, s65, 106496
    s_add_u32 s7, s56, 16384
    s_and_b32 s7, s7, 0x1ffff
    buffer_load_dwordx4 v4, s[36:39], s7 offen nt lds
    s_waitcnt lgkmcnt(7)
    v_mfma_f32_16x16x32_bf16 v[156:159], v[84:87], v[104:107], v[156:159]
    ds_read_b128 v[84:87], v12 offset:53248
    s_waitcnt vmcnt(5)
    s_add_u32 m0, s65, 110592
    s_add_u32 s7, s56, 24576
    s_and_b32 s7, s7, 0x1ffff
    buffer_load_dwordx4 v4, s[36:39], s7 offen nt lds
    s_waitcnt lgkmcnt(7)
    v_mfma_f32_16x16x32_bf16 v[152:155], v[88:91], v[108:111], v[152:155]
    ds_read_b128 v[88:91], v13 offset:49152
    s_waitcnt lgkmcnt(7)
    v_mfma_f32_16x16x32_bf16 v[156:159], v[92:95], v[108:111], v[156:159]
    ds_read_b128 v[92:95], v13 offset:53248
    s_waitcnt vmcnt(6)
    s_barrier
    s_waitcnt lgkmcnt(7)
    v_mfma_f32_16x16x32_bf16 v[160:163], v[64:67], v[96:99], 0
    v_add_u32 v10, 0x4000, v10
    v_add_u32 v11, 0x4000, v11
    v_add_u32 v12, 0x4000, v12
    v_add_u32 v13, 0x4000, v13
    ds_read_b128 v[64:67], v10 offset:49152
    v_max3_f32 v30, v30, v152, v153
    s_waitcnt vmcnt(5)
    s_add_u32 m0, s65, 61440
    s_add_u32 s7, s100, 49152
    buffer_load_dwordx4 v5, s[40:43], s7 offen lds
    s_waitcnt lgkmcnt(7)
    v_mfma_f32_16x16x32_bf16 v[164:167], v[68:71], v[96:99], 0
    ds_read_b128 v[68:71], v10 offset:53248
    v_max3_f32 v30, v30, v154, v155
    s_waitcnt vmcnt(5)
    s_add_u32 m0, s65, 81920
    s_add_u32 s7, s56, 32768
    s_and_b32 s7, s7, 0x1ffff
    buffer_load_dwordx4 v4, s[36:39], s7 offen nt lds
    s_waitcnt lgkmcnt(7)
    v_mfma_f32_16x16x32_bf16 v[160:163], v[72:75], v[100:103], v[160:163]
    ds_read_b128 v[72:75], v11 offset:49152
    v_max3_f32 v30, v30, v156, v157
    s_waitcnt vmcnt(5)
    s_add_u32 m0, s65, 86016
    s_add_u32 s7, s56, 40960
    s_and_b32 s7, s7, 0x1ffff
    buffer_load_dwordx4 v4, s[36:39], s7 offen nt lds
    s_waitcnt lgkmcnt(7)
    v_mfma_f32_16x16x32_bf16 v[164:167], v[76:79], v[100:103], v[164:167]
    ds_read_b128 v[76:79], v11 offset:53248
    v_max3_f32 v30, v30, v158, v159
    s_add_u32 s100, s62, 2
    s_and_b32 s100, s100, 3
    s_lshl_b32 s100, s100, 17
    s_waitcnt vmcnt(5)
    s_add_u32 m0, s65, 65536
    s_add_u32 s7, s100, 0
    buffer_load_dwordx4 v5, s[40:43], s7 offen lds
    s_waitcnt lgkmcnt(7)
    v_mfma_f32_16x16x32_bf16 v[160:163], v[80:83], v[104:107], v[160:163]
    ds_read_b128 v[80:83], v12 offset:49152
    s_waitcnt vmcnt(5)
    s_add_u32 m0, s65, 90112
    s_add_u32 s7, s56, 49152
    s_and_b32 s7, s7, 0x1ffff
    buffer_load_dwordx4 v4, s[36:39], s7 offen nt lds
    s_waitcnt lgkmcnt(7)
    v_mfma_f32_16x16x32_bf16 v[164:167], v[84:87], v[104:107], v[164:167]
    ds_read_b128 v[84:87], v12 offset:53248
    s_waitcnt vmcnt(5)
    s_add_u32 m0, s65, 94208
    s_add_u32 s7, s56, 57344
    s_and_b32 s7, s7, 0x1ffff
    buffer_load_dwordx4 v4, s[36:39], s7 offen nt lds
    s_waitcnt lgkmcnt(7)
    v_mfma_f32_16x16x32_bf16 v[160:163], v[88:91], v[108:111], v[160:163]
    ds_read_b128 v[88:91], v13 offset:49152
    s_waitcnt lgkmcnt(7)
    v_mfma_f32_16x16x32_bf16 v[164:167], v[92:95], v[108:111], v[164:167]
    ds_read_b128 v[92:95], v13 offset:53248
    s_lshl_b32 s6, s4, 11
    v_add_u32 v37, s6, v26
    v_xor_b32 v38, 2048, v37
    s_waitcnt vmcnt(6)
    s_barrier
    s_waitcnt lgkmcnt(7)
    v_mfma_f32_16x16x32_bf16 v[168:171], v[64:67], v[96:99], 0
    v_add_u32 v14, 0x14000, v14
    v_add_u32 v15, 0x14000, v15
    v_add_u32 v16, 0x14000, v16
    v_add_u32 v17, 0x14000, v17
    ds_read_b64_tr_b16 v[64:65], v14 offset:16384
    ds_read_b64_tr_b16 v[66:67], v14 offset:18432
    v_max3_f32 v30, v30, v160, v161
    s_waitcnt vmcnt(5)
    s_add_u32 m0, s65, 69632
    s_add_u32 s7, s100, 16384
    buffer_load_dwordx4 v5, s[40:43], s7 offen lds
    s_waitcnt lgkmcnt(8)
    v_mfma_f32_16x16x32_bf16 v[172:175], v[68:71], v[96:99], 0
    ds_read_b64_tr_b16 v[68:69], v15 offset:16384
    ds_read_b64_tr_b16 v[70:71], v15 offset:18432
    v_max3_f32 v30, v30, v162, v163
    s_waitcnt vmcnt(5)
    s_add_u32 m0, s65, 114688
    s_add_u32 s7, s56, 65536
    s_and_b32 s7, s7, 0x1ffff
    buffer_load_dwordx4 v4, s[36:39], s7 offen nt lds
    s_waitcnt lgkmcnt(9)
    v_mfma_f32_16x16x32_bf16 v[168:171], v[72:75], v[100:103], v[168:171]
    ds_read_b64_tr_b16 v[72:73], v16 offset:16384
    ds_read_b64_tr_b16 v[74:75], v16 offset:18432
    v_max3_f32 v30, v30, v164, v165
    s_waitcnt vmcnt(5)
    s_add_u32 m0, s65, 118784
    s_add_u32 s7, s56, 73728
    s_and_b32 s7, s7, 0x1ffff
    buffer_load_dwordx4 v4, s[36:39], s7 offen nt lds
    s_waitcnt lgkmcnt(10)
    v_mfma_f32_16x16x32_bf16 v[172:175], v[76:79], v[100:103], v[172:175]
    ds_read_b64_tr_b16 v[76:77], v17 offset:16384
    ds_read_b64_tr_b16 v[78:79], v17 offset:18432
    v_max3_f32 v30, v30, v166, v167
    s_waitcnt vmcnt(5)
    s_add_u32 m0, s65, 73728
    s_add_u32 s7, s100, 32768
    buffer_load_dwordx4 v5, s[40:43], s7 offen lds
    s_waitcnt lgkmcnt(11)
    v_mfma_f32_16x16x32_bf16 v[168:171], v[80:83], v[104:107], v[168:171]
    ds_read_b64_tr_b16 v[80:81], v14 offset:24576
    ds_read_b64_tr_b16 v[82:83], v14 offset:26624
    s_waitcnt vmcnt(5)
    s_add_u32 m0, s65, 122880
    s_add_u32 s7, s56, 81920
    s_and_b32 s7, s7, 0x1ffff
    buffer_load_dwordx4 v4, s[36:39], s7 offen nt lds
    s_waitcnt lgkmcnt(12)
    v_mfma_f32_16x16x32_bf16 v[172:175], v[84:87], v[104:107], v[172:175]
    ds_read_b64_tr_b16 v[84:85], v15 offset:24576
    ds_read_b64_tr_b16 v[86:87], v15 offset:26624
    s_waitcnt vmcnt(5)
    s_add_u32 m0, s65, 126976
    s_add_u32 s7, s56, 90112
    s_and_b32 s7, s7, 0x1ffff
    buffer_load_dwordx4 v4, s[36:39], s7 offen nt lds
    s_waitcnt lgkmcnt(13)
    v_mfma_f32_16x16x32_bf16 v[168:171], v[88:91], v[108:111], v[168:171]
    ds_read_b64_tr_b16 v[88:89], v16 offset:24576
    ds_read_b64_tr_b16 v[90:91], v16 offset:26624
    s_waitcnt lgkmcnt(14)
    v_mfma_f32_16x16x32_bf16 v[172:175], v[92:95], v[108:111], v[172:175]
    ds_read_b64_tr_b16 v[92:93], v17 offset:24576
    ds_read_b64_tr_b16 v[94:95], v17 offset:26624
    s_nop 1
    v_max3_f32 v30, v30, v168, v169
    v_max3_f32 v30, v30, v170, v171
    s_nop 1
    v_max3_f32 v30, v30, v172, v173
    v_max3_f32 v30, v30, v174, v175
    v_mov_b32 v34, v30
    s_nop 1
    v_permlane16_swap_b32 v34, v30
    v_max_f32 v30, v30, v34
    v_mov_b32 v34, v30
    s_nop 1
    v_permlane32_swap_b32 v34, v30
    v_max_f32 v30, v30, v34
    v_sub_f32 v112, v112, v30
    v_sub_f32 v113, v113, v30
    v_sub_f32 v114, v114, v30
    v_sub_f32 v115, v115, v30
    v_sub_f32 v116, v116, v30
    v_sub_f32 v117, v117, v30
    v_sub_f32 v118, v118, v30
    v_sub_f32 v119, v119, v30
    v_exp_f32 v112, v112
    v_exp_f32 v113, v113
    v_exp_f32 v114, v114
    v_exp_f32 v115, v115
    v_exp_f32 v116, v116
    v_exp_f32 v117, v117
    v_exp_f32 v118, v118
    v_exp_f32 v119, v119
    v_cvt_pk_bf16_f32 v112, v112, v113
    v_cvt_pk_bf16_f32 v113, v114, v115
    v_cvt_pk_bf16_f32 v114, v116, v117
    v_cvt_pk_bf16_f32 v115, v118, v119
    s_waitcnt lgkmcnt(0)
    s_cmp_lg_u32 s68, 0
    s_cbranch_scc1 L_nonce_ok
    s_mov_b32 s71, 0
L_nonce_loop:
    s_load_dwordx2 s[68:69], s[20:21], 0 glc
    s_waitcnt lgkmcnt(0)
    s_cmp_lg_u32 s68, 0
    s_cbranch_scc1 L_nonce_ok
    s_add_u32 s71, s71, 1
    s_cmp_lt_u32 s71, 200000
    s_cbranch_scc1 L_nonce_loop
L_nonce_ok:
    s_waitcnt vmcnt(6)
    s_barrier
    s_waitcnt lgkmcnt(14)
    v_mfma_f32_16x16x32_bf16 v[176:179], v[64:67], v[112:115], 0
    ds_read_b64_tr_b16 v[64:65], v14
    ds_read_b64_tr_b16 v[66:67], v14 offset:2048
    v_sub_f32 v120, v120, v30
    v_sub_f32 v121, v121, v30
    v_sub_f32 v122, v122, v30
    v_sub_f32 v123, v123, v30
    v_sub_f32 v124, v124, v30
    s_waitcnt vmcnt(5)
    s_add_u32 m0, s65, 77824
    s_add_u32 s7, s100, 49152
    buffer_load_dwordx4 v5, s[40:43], s7 offen lds
    s_waitcnt lgkmcnt(14)
    v_mfma_f32_16x16x32_bf16 v[180:183], v[68:71], v[112:115], 0
    ds_read_b64_tr_b16 v[68:69], v15
    ds_read_b64_tr_b16 v[70:71], v15 offset:2048
    v_sub_f32 v125, v125, v30
    v_sub_f32 v126, v126, v30
    v_sub_f32 v127, v127, v30
    v_exp_f32 v120, v120
    v_exp_f32 v121, v121
    s_waitcnt vmcnt(7)
    s_add_u32 m0, s65, 131072
    s_add_u32 s7, s56, 98304
    s_and_b32 s7, s7, 0x1ffff
    buffer_load_dwordx4 v4, s[36:39], s7 offen nt lds
    s_waitcnt lgkmcnt(14)
    v_mfma_f32_16x16x32_bf16 v[184:187], v[72:75], v[112:115], 0
    ds_read_b64_tr_b16 v[72:73], v16
    ds_read_b64_tr_b16 v[74:75], v16 offset:2048
    v_exp_f32 v122, v122
    v_exp_f32 v123, v123
    v_exp_f32 v124, v124
    v_exp_f32 v125, v125
    v_exp_f32 v126, v126
    s_waitcnt vmcnt(7)
    s_add_u32 m0, s65, 135168
    s_add_u32 s7, s56, 106496
    s_and_b32 s7, s7, 0x1ffff
    buffer_load_dwordx4 v4, s[36:39], s7 offen nt lds
    s_waitcnt lgkmcnt(14)
    v_mfma_f32_16x16x32_bf16 v[188:191], v[76:79], v[112:115], 0
    ds_read_b64_tr_b16 v[76:77], v17
    ds_read_b64_tr_b16 v[78:79], v17 offset:2048
    v_exp_f32 v127, v127
    v_cvt_pk_bf16_f32 v120, v120, v121
    v_cvt_pk_bf16_f32 v121, v122, v123
    v_cvt_pk_bf16_f32 v122, v124, v125
    v_cvt_pk_bf16_f32 v123, v126, v127
    s_waitcnt vmcnt(7)
    s_add_u32 m0, s65, 139264
    s_add_u32 s7, s56, 114688
    s_and_b32 s7, s7, 0x1ffff
    buffer_load_dwordx4 v4, s[36:39], s7 offen nt lds
    s_waitcnt lgkmcnt(14)
    v_mfma_f32_16x16x32_bf16 v[176:179], v[80:83], v[120:123], v[176:179]
    ds_read_b64_tr_b16 v[80:81], v14 offset:8192
    ds_read_b64_tr_b16 v[82:83], v14 offset:10240
    v_sub_f32 v128, v128, v30
    v_sub_f32 v129, v129, v30
    v_sub_f32 v130, v130, v30
    v_sub_f32 v131, v131, v30
    v_sub_f32 v132, v132, v30
    s_waitcnt vmcnt(7)
    s_add_u32 m0, s65, 143360
    s_add_u32 s7, s56, 122880
    s_and_b32 s7, s7, 0x1ffff
    buffer_load_dwordx4 v4, s[36:39], s7 offen nt lds
    s_waitcnt lgkmcnt(14)
    v_mfma_f32_16x16x32_bf16 v[180:183], v[84:87], v[120:123], v[180:183]
    ds_read_b64_tr_b16 v[84:85], v15 offset:8192
    ds_read_b64_tr_b16 v[86:87], v15 offset:10240
    v_sub_f32 v133, v133, v30
    v_sub_f32 v134, v134, v30
    v_sub_f32 v135, v135, v30
    v_exp_f32 v128, v128
    v_exp_f32 v129, v129
    s_waitcnt vmcnt(7)
    s_add_u32 m0, s65, 147456
    s_add_u32 s7, s56, 128
    s_and_b32 s7, s7, 0x1ffff
    buffer_load_dwordx4 v4, s[36:39], s7 offen nt lds
    s_waitcnt lgkmcnt(14)
    v_mfma_f32_16x16x32_bf16 v[184:187], v[88:91], v[120:123], v[184:187]
    ds_read_b64_tr_b16 v[88:89], v16 offset:8192
    ds_read_b64_tr_b16 v[90:91], v16 offset:10240
    v_exp_f32 v130, v130
    v_exp_f32 v131, v131
    v_exp_f32 v132, v132
    v_exp_f32 v133, v133
    v_exp_f32 v134, v134
    s_waitcnt vmcnt(7)
    s_add_u32 m0, s65, 151552
    s_add_u32 s7, s56, 8320
    s_and_b32 s7, s7, 0x1ffff
    buffer_load_dwordx4 v4, s[36:39], s7 offen nt lds
    s_waitcnt lgkmcnt(14)
    v_mfma_f32_16x16x32_bf16 v[188:191], v[92:95], v[120:123], v[188:191]
    ds_read_b64_tr_b16 v[92:93], v17 offset:8192
    ds_read_b64_tr_b16 v[94:95], v17 offset:10240
    v_exp_f32 v135, v135
    v_cvt_pk_bf16_f32 v128, v128, v129
    v_cvt_pk_bf16_f32 v129, v130, v131
    v_cvt_pk_bf16_f32 v130, v132, v133
    v_cvt_pk_bf16_f32 v131, v134, v135
    v_mfma_f32_16x16x32_bf16 v[48:51], v[44:47], v[112:115], 0
    v_mfma_f32_16x16x32_bf16 v[48:51], v[44:47], v[120:123], v[48:51]
    s_waitcnt vmcnt(7)
    s_barrier
    s_waitcnt lgkmcnt(14)
    v_mfma_f32_16x16x32_bf16 v[176:179], v[64:67], v[128:131], v[176:179]
    ds_read_b64_tr_b16 v[64:65], v14 offset:32768
    ds_read_b64_tr_b16 v[66:67], v14 offset:34816
    v_sub_f32 v136, v136, v30
    v_sub_f32 v137, v137, v30
    v_sub_f32 v138, v138, v30
    v_sub_f32 v139, v139, v30
    v_sub_f32 v140, v140, v30
    s_waitcnt vmcnt(7)
    s_add_u32 m0, s65, 155648
    s_add_u32 s7, s56, 16512
    s_and_b32 s7, s7, 0x1ffff
    buffer_load_dwordx4 v4, s[36:39], s7 offen nt lds
    s_waitcnt lgkmcnt(14)
    v_mfma_f32_16x16x32_bf16 v[180:183], v[68:71], v[128:131], v[180:183]
    ds_read_b64_tr_b16 v[68:69], v15 offset:32768
    ds_read_b64_tr_b16 v[70:71], v15 offset:34816
    v_sub_f32 v141, v141, v30
    v_sub_f32 v142, v142, v30
    v_sub_f32 v143, v143, v30
    v_exp_f32 v136, v136
    v_exp_f32 v137, v137
    s_waitcnt vmcnt(7)
    s_add_u32 m0, s65, 159744
    s_add_u32 s7, s56, 24704
    s_and_b32 s7, s7, 0x1ffff
    buffer_load_dwordx4 v4, s[36:39], s7 offen nt lds
    s_waitcnt lgkmcnt(14)
    v_mfma_f32_16x16x32_bf16 v[184:187], v[72:75], v[128:131], v[184:187]
    ds_read_b64_tr_b16 v[72:73], v16 offset:32768
    ds_read_b64_tr_b16 v[74:75], v16 offset:34816
    v_exp_f32 v138, v138
    v_exp_f32 v139, v139
    v_exp_f32 v140, v140
    v_exp_f32 v141, v141
    v_exp_f32 v142, v142
    s_waitcnt vmcnt(7)
    s_add_u32 m0, s65, 98304
    s_add_u32 s7, s56, 32896
    s_and_b32 s7, s7, 0x1ffff
    buffer_load_dwordx4 v4, s[36:39], s7 offen nt lds
    s_waitcnt lgkmcnt(14)
    v_mfma_f32_16x16x32_bf16 v[188:191], v[76:79], v[128:131], v[188:191]
    ds_read_b64_tr_b16 v[76:77], v17 offset:32768
    ds_read_b64_tr_b16 v[78:79], v17 offset:34816
    v_exp_f32 v143, v143
    v_cvt_pk_bf16_f32 v136, v136, v137
    v_cvt_pk_bf16_f32 v137, v138, v139
    v_cvt_pk_bf16_f32 v138, v140, v141
    v_cvt_pk_bf16_f32 v139, v142, v143
    s_waitcnt vmcnt(7)
    s_add_u32 m0, s65, 102400
    s_add_u32 s7, s56, 41088
    s_and_b32 s7, s7, 0x1ffff
    buffer_load_dwordx4 v4, s[36:39], s7 offen nt lds
    s_waitcnt lgkmcnt(14)
    v_mfma_f32_16x16x32_bf16 v[176:179], v[80:83], v[136:139], v[176:179]
    ds_read_b64_tr_b16 v[80:81], v14 offset:40960
    ds_read_b64_tr_b16 v[82:83], v14 offset:43008
    v_sub_f32 v144, v144, v30
    v_sub_f32 v145, v145, v30
    v_sub_f32 v146, v146, v30
    v_sub_f32 v147, v147, v30
    v_sub_f32 v148, v148, v30
    s_waitcnt vmcnt(7)
    s_add_u32 m0, s65, 106496
    s_add_u32 s7, s56, 49280
    s_and_b32 s7, s7, 0x1ffff
    buffer_load_dwordx4 v4, s[36:39], s7 offen nt lds
    s_waitcnt lgkmcnt(14)
    v_mfma_f32_16x16x32_bf16 v[180:183], v[84:87], v[136:139], v[180:183]
    ds_read_b64_tr_b16 v[84:85], v15 offset:40960
    ds_read_b64_tr_b16 v[86:87], v15 offset:43008
    v_sub_f32 v149, v149, v30
    v_sub_f32 v150, v150, v30
    v_sub_f32 v151, v151, v30
    v_exp_f32 v144, v144
    v_exp_f32 v145, v145
    s_waitcnt vmcnt(7)
    s_add_u32 m0, s65, 110592
    s_add_u32 s7, s56, 57472
    s_and_b32 s7, s7, 0x1ffff
    buffer_load_dwordx4 v4, s[36:39], s7 offen nt lds
    s_waitcnt lgkmcnt(14)
    v_mfma_f32_16x16x32_bf16 v[184:187], v[88:91], v[136:139], v[184:187]
    ds_read_b64_tr_b16 v[88:89], v16 offset:40960
    ds_read_b64_tr_b16 v[90:91], v16 offset:43008
    v_exp_f32 v146, v146
    v_exp_f32 v147, v147
    v_exp_f32 v148, v148
    v_exp_f32 v149, v149
    v_exp_f32 v150, v150
    s_waitcnt lgkmcnt(14)
    v_mfma_f32_16x16x32_bf16 v[188:191], v[92:95], v[136:139], v[188:191]
    ds_read_b64_tr_b16 v[92:93], v17 offset:40960
    ds_read_b64_tr_b16 v[94:95], v17 offset:43008
    v_exp_f32 v151, v151
    v_cvt_pk_bf16_f32 v144, v144, v145
    v_cvt_pk_bf16_f32 v145, v146, v147
    v_cvt_pk_bf16_f32 v146, v148, v149
    v_cvt_pk_bf16_f32 v147, v150, v151
    v_mfma_f32_16x16x32_bf16 v[48:51], v[44:47], v[128:131], v[48:51]
    v_mfma_f32_16x16x32_bf16 v[48:51], v[44:47], v[136:139], v[48:51]
    s_waitcnt vmcnt(8)
    s_barrier
    s_waitcnt lgkmcnt(14)
    v_mfma_f32_16x16x32_bf16 v[176:179], v[64:67], v[144:147], v[176:179]
    ds_read_b64_tr_b16 v[64:65], v14 offset:49152
    ds_read_b64_tr_b16 v[66:67], v14 offset:51200
    v_sub_f32 v152, v152, v30
    v_sub_f32 v153, v153, v30
    v_sub_f32 v154, v154, v30
    v_sub_f32 v155, v155, v30
    v_sub_f32 v156, v156, v30
    s_waitcnt vmcnt(7)
    s_add_u32 m0, s65, 81920
    s_add_u32 s7, s56, 65664
    s_and_b32 s7, s7, 0x1ffff
    buffer_load_dwordx4 v4, s[36:39], s7 offen nt lds
    s_waitcnt lgkmcnt(14)
    v_mfma_f32_16x16x32_bf16 v[180:183], v[68:71], v[144:147], v[180:183]
    ds_read_b64_tr_b16 v[68:69], v15 offset:49152
    ds_read_b64_tr_b16 v[70:71], v15 offset:51200
    v_sub_f32 v157, v157, v30
    v_sub_f32 v158, v158, v30
    v_sub_f32 v159, v159, v30
    v_exp_f32 v152, v152
    v_exp_f32 v153, v153
    s_waitcnt vmcnt(7)
    s_add_u32 m0, s65, 86016
    s_add_u32 s7, s56, 73856
    s_and_b32 s7, s7, 0x1ffff
    buffer_load_dwordx4 v4, s[36:39], s7 offen nt lds
    s_waitcnt lgkmcnt(14)
    v_mfma_f32_16x16x32_bf16 v[184:187], v[72:75], v[144:147], v[184:187]
    ds_read_b64_tr_b16 v[72:73], v16 offset:49152
    ds_read_b64_tr_b16 v[74:75], v16 offset:51200
    v_exp_f32 v154, v154
    v_exp_f32 v155, v155
    v_exp_f32 v156, v156
    v_exp_f32 v157, v157
    v_exp_f32 v158, v158
    s_waitcnt vmcnt(7)
    s_add_u32 m0, s65, 90112
    s_add_u32 s7, s56, 82048
    s_and_b32 s7, s7, 0x1ffff
    buffer_load_dwordx4 v4, s[36:39], s7 offen nt lds
    s_waitcnt lgkmcnt(14)
    v_mfma_f32_16x16x32_bf16 v[188:191], v[76:79], v[144:147], v[188:191]
    ds_read_b64_tr_b16 v[76:77], v17 offset:49152
    ds_read_b64_tr_b16 v[78:79], v17 offset:51200
    v_exp_f32 v159, v159
    v_cvt_pk_bf16_f32 v152, v152, v153
    v_cvt_pk_bf16_f32 v153, v154, v155
    v_cvt_pk_bf16_f32 v154, v156, v157
    v_cvt_pk_bf16_f32 v155, v158, v159
    s_waitcnt vmcnt(7)
    s_add_u32 m0, s65, 94208
    s_add_u32 s7, s56, 90240
    s_and_b32 s7, s7, 0x1ffff
    buffer_load_dwordx4 v4, s[36:39], s7 offen nt lds
    s_waitcnt lgkmcnt(14)
    v_mfma_f32_16x16x32_bf16 v[176:179], v[80:83], v[152:155], v[176:179]
    ds_read_b64_tr_b16 v[80:81], v14 offset:57344
    ds_read_b64_tr_b16 v[82:83], v14 offset:59392
    v_sub_f32 v160, v160, v30
    v_sub_f32 v161, v161, v30
    v_sub_f32 v162, v162, v30
    v_sub_f32 v163, v163, v30
    v_sub_f32 v164, v164, v30
    s_waitcnt lgkmcnt(14)
    v_mfma_f32_16x16x32_bf16 v[180:183], v[84:87], v[152:155], v[180:183]
    ds_read_b64_tr_b16 v[84:85], v15 offset:57344
    ds_read_b64_tr_b16 v[86:87], v15 offset:59392
    v_sub_f32 v165, v165, v30
    v_sub_f32 v166, v166, v30
    v_sub_f32 v167, v167, v30
    v_exp_f32 v160, v160
    v_exp_f32 v161, v161
    s_waitcnt lgkmcnt(14)
    v_mfma_f32_16x16x32_bf16 v[184:187], v[88:91], v[152:155], v[184:187]
    ds_read_b64_tr_b16 v[88:89], v16 offset:57344
    ds_read_b64_tr_b16 v[90:91], v16 offset:59392
    v_exp_f32 v162, v162
    v_exp_f32 v163, v163
    v_exp_f32 v164, v164
    v_exp_f32 v165, v165
    v_exp_f32 v166, v166
    s_waitcnt lgkmcnt(14)
    v_mfma_f32_16x16x32_bf16 v[188:191], v[92:95], v[152:155], v[188:191]
    ds_read_b64_tr_b16 v[92:93], v17 offset:57344
    ds_read_b64_tr_b16 v[94:95], v17 offset:59392
    v_exp_f32 v167, v167
    v_cvt_pk_bf16_f32 v160, v160, v161
    v_cvt_pk_bf16_f32 v161, v162, v163
    v_cvt_pk_bf16_f32 v162, v164, v165
    v_cvt_pk_bf16_f32 v163, v166, v167
    v_mfma_f32_16x16x32_bf16 v[48:51], v[44:47], v[144:147], v[48:51]
    v_mfma_f32_16x16x32_bf16 v[48:51], v[44:47], v[152:155], v[48:51]
    s_waitcnt vmcnt(8)
    s_barrier
    v_and_b32 v34, 3, v0
    v_lshlrev_b32 v34, 2, v34
    ds_read_b32 v35, v34 offset:28672
    s_waitcnt lgkmcnt(0)
    v_cmp_ne_u32 vcc, 0, v35
    s_nop 1
    s_andn2_b64 s[6:7], vcc, s[66:67]
    s_cbranch_scc1 L_fallback_helper
    v_mfma_f32_16x16x32_bf16 v[176:179], v[64:67], v[160:163], v[176:179]
    v_add_u32 v14, 0x4000, v14
    v_add_u32 v15, 0x4000, v15
    v_add_u32 v16, 0x4000, v16
    v_add_u32 v17, 0x4000, v17
    ds_read_b64_tr_b16 v[64:65], v14 offset:49152
    ds_read_b64_tr_b16 v[66:67], v14 offset:51200
    v_sub_f32 v168, v168, v30
    v_sub_f32 v169, v169, v30
    v_sub_f32 v170, v170, v30
    v_sub_f32 v171, v171, v30
    v_sub_f32 v172, v172, v30
    s_waitcnt vmcnt(7)
    s_add_u32 m0, s65, 114688
    s_add_u32 s7, s56, 98432
    s_and_b32 s7, s7, 0x1ffff
    buffer_load_dwordx4 v4, s[36:39], s7 offen nt lds
    v_mfma_f32_16x16x32_bf16 v[180:183], v[68:71], v[160:163], v[180:183]
    ds_read_b64_tr_b16 v[68:69], v15 offset:49152
    ds_read_b64_tr_b16 v[70:71], v15 offset:51200
    v_sub_f32 v173, v173, v30
    v_sub_f32 v174, v174, v30
    v_sub_f32 v175, v175, v30
    v_exp_f32 v168, v168
    v_exp_f32 v169, v169
    s_waitcnt vmcnt(7)
    s_add_u32 m0, s65, 118784
    s_add_u32 s7, s56, 106624
    s_and_b32 s7, s7, 0x1ffff
    buffer_load_dwordx4 v4, s[36:39], s7 offen nt lds
    v_mfma_f32_16x16x32_bf16 v[184:187], v[72:75], v[160:163], v[184:187]
    ds_read_b64_tr_b16 v[72:73], v16 offset:49152
    ds_read_b64_tr_b16 v[74:75], v16 offset:51200
    v_exp_f32 v170, v170
    v_exp_f32 v171, v171
    v_exp_f32 v172, v172
    v_exp_f32 v173, v173
    v_exp_f32 v174, v174
    s_waitcnt vmcnt(7)
    s_add_u32 m0, s65, 122880
    s_add_u32 s7, s56, 114816
    s_and_b32 s7, s7, 0x1ffff
    buffer_load_dwordx4 v4, s[36:39], s7 offen nt lds
    v_mfma_f32_16x16x32_bf16 v[188:191], v[76:79], v[160:163], v[188:191]
    ds_read_b64_tr_b16 v[76:77], v17 offset:49152
    ds_read_b64_tr_b16 v[78:79], v17 offset:51200
    v_exp_f32 v175, v175
    v_cvt_pk_bf16_f32 v168, v168, v169
    v_cvt_pk_bf16_f32 v169, v170, v171
    v_cvt_pk_bf16_f32 v170, v172, v173
    v_cvt_pk_bf16_f32 v171, v174, v175
    s_waitcnt vmcnt(7)
    s_add_u32 m0, s65, 126976
    s_add_u32 s7, s56, 123008
    s_and_b32 s7, s7, 0x1ffff
    buffer_load_dwordx4 v4, s[36:39], s7 offen nt lds
    v_mfma_f32_16x16x32_bf16 v[176:179], v[80:83], v[168:171], v[176:179]
    ds_read_b64_tr_b16 v[80:81], v14 offset:57344
    ds_read_b64_tr_b16 v[82:83], v14 offset:59392
    v_mfma_f32_16x16x32_bf16 v[180:183], v[84:87], v[168:171], v[180:183]
    ds_read_b64_tr_b16 v[84:85], v15 offset:57344
    ds_read_b64_tr_b16 v[86:87], v15 offset:59392
    v_mfma_f32_16x16x32_bf16 v[184:187], v[88:91], v[168:171], v[184:187]
    ds_read_b64_tr_b16 v[88:89], v16 offset:57344
    ds_read_b64_tr_b16 v[90:91], v16 offset:59392
    v_mfma_f32_16x16x32_bf16 v[188:191], v[92:95], v[168:171], v[188:191]
    ds_read_b64_tr_b16 v[92:93], v17 offset:57344
    ds_read_b64_tr_b16 v[94:95], v17 offset:59392
    v_mfma_f32_16x16x32_bf16 v[48:51], v[44:47], v[160:163], v[48:51]
    v_mfma_f32_16x16x32_bf16 v[48:51], v[44:47], v[168:171], v[48:51]
    ds_write_b128 v37, v[184:187] offset:16384
    ds_write_b128 v37, v[188:191] offset:17408
    v_mov_b32 v248, v176
    v_mov_b32 v249, v177
    v_mov_b32 v250, v178
    v_mov_b32 v251, v179
    v_mov_b32 v252, v180
    v_mov_b32 v253, v181
    v_mov_b32 v254, v182
    v_mov_b32 v255, v183
    v_lshrrev_b32 v34, 2, v37
    ds_write_b32 v34, v30 offset:24576
    ds_write_b32 v34, v48 offset:24832
    s_waitcnt vmcnt(8)
    s_waitcnt lgkmcnt(0)
    s_barrier
    v_lshrrev_b32 v34, 2, v38
    ds_read_b32 v39, v34 offset:24576
    ds_read_b32 v40, v34 offset:24832
    ds_read_b128 v[240:243], v38 offset:16384
    ds_read_b128 v[244:247], v38 offset:17408
    v_mfma_f32_16x16x32_bf16 v[176:179], v[64:67], v[112:115], 0
    ds_read_b64_tr_b16 v[64:65], v14
    ds_read_b64_tr_b16 v[66:67], v14 offset:2048
    s_waitcnt lgkmcnt(5)
    v_max_f32 v34, v30, v39
    v_sub_f32 v35, v39, v34
    v_exp_f32 v35, v35
    v_sub_f32 v34, v30, v34
    v_mfma_f32_16x16x32_bf16 v[180:183], v[68:71], v[112:115], 0
    ds_read_b64_tr_b16 v[68:69], v15
    ds_read_b64_tr_b16 v[70:71], v15 offset:2048
    v_exp_f32 v34, v34
    s_waitcnt lgkmcnt(6)
    v_mul_f32 v32, v35, v40
    v_fmac_f32 v32, v34, v48
    v_rcp_f32 v32, v32
    v_mfma_f32_16x16x32_bf16 v[184:187], v[72:75], v[112:115], 0
    ds_read_b64_tr_b16 v[72:73], v16
    ds_read_b64_tr_b16 v[74:75], v16 offset:2048
    v_mul_f32 v39, v34, v32
    v_mul_f32 v40, v35, v32
    v_mul_f32 v248, v248, v39
    v_mul_f32 v249, v249, v39
    v_mfma_f32_16x16x32_bf16 v[188:191], v[76:79], v[112:115], 0
    ds_read_b64_tr_b16 v[76:77], v17
    ds_read_b64_tr_b16 v[78:79], v17 offset:2048
    v_mul_f32 v250, v250, v39
    v_mul_f32 v251, v251, v39
    v_mul_f32 v252, v252, v39
    v_mul_f32 v253, v253, v39
    v_mfma_f32_16x16x32_bf16 v[176:179], v[80:83], v[120:123], v[176:179]
    ds_read_b64_tr_b16 v[80:81], v14 offset:8192
    ds_read_b64_tr_b16 v[82:83], v14 offset:10240
    v_mul_f32 v254, v254, v39
    v_mul_f32 v255, v255, v39
    s_waitcnt lgkmcnt(11)
    v_fmac_f32 v248, v240, v40
    v_fmac_f32 v249, v241, v40
    v_mfma_f32_16x16x32_bf16 v[180:183], v[84:87], v[120:123], v[180:183]
    ds_read_b64_tr_b16 v[84:85], v15 offset:8192
    ds_read_b64_tr_b16 v[86:87], v15 offset:10240
    v_fmac_f32 v250, v242, v40
    v_fmac_f32 v251, v243, v40
    s_waitcnt lgkmcnt(12)
    v_fmac_f32 v252, v244, v40
    v_fmac_f32 v253, v245, v40
    v_mfma_f32_16x16x32_bf16 v[184:187], v[88:91], v[120:123], v[184:187]
    ds_read_b64_tr_b16 v[88:89], v16 offset:8192
    ds_read_b64_tr_b16 v[90:91], v16 offset:10240
    v_fmac_f32 v254, v246, v40
    v_fmac_f32 v255, v247, v40
    v_cvt_pk_bf16_f32 v208, v248, v249
    v_cvt_pk_bf16_f32 v209, v250, v251
    v_mfma_f32_16x16x32_bf16 v[188:191], v[92:95], v[120:123], v[188:191]
    ds_read_b64_tr_b16 v[92:93], v17 offset:8192
    ds_read_b64_tr_b16 v[94:95], v17 offset:10240
    v_cvt_pk_bf16_f32 v210, v252, v253
    v_cvt_pk_bf16_f32 v211, v254, v255
    s_mul_i32 s7, s58, 40960
    s_add_u32 s7, s7, s65
    s_add_u32 s7, s7, 16384
    buffer_store_dwordx4 v[208:211], v26, s[44:47], s7 offen sc1
    s_waitcnt vmcnt(5)
    s_barrier
    s_waitcnt lgkmcnt(14)
    v_mfma_f32_16x16x32_bf16 v[176:179], v[64:67], v[128:131], v[176:179]
    v_add_u32 v14, 0xffffc000, v14
    v_add_u32 v15, 0xffffc000, v15
    v_add_u32 v16, 0xffffc000, v16
    v_add_u32 v17, 0xffffc000, v17
    ds_read_b64_tr_b16 v[64:65], v14
    ds_read_b64_tr_b16 v[66:67], v14 offset:2048
    s_waitcnt lgkmcnt(14)
    v_mfma_f32_16x16x32_bf16 v[180:183], v[68:71], v[128:131], v[180:183]
    ds_read_b64_tr_b16 v[68:69], v15
    ds_read_b64_tr_b16 v[70:71], v15 offset:2048
    s_waitcnt lgkmcnt(14)
    v_mfma_f32_16x16x32_bf16 v[184:187], v[72:75], v[128:131], v[184:187]
    ds_read_b64_tr_b16 v[72:73], v16
    ds_read_b64_tr_b16 v[74:75], v16 offset:2048
    s_waitcnt lgkmcnt(14)
    v_mfma_f32_16x16x32_bf16 v[188:191], v[76:79], v[128:131], v[188:191]
    ds_read_b64_tr_b16 v[76:77], v17
    ds_read_b64_tr_b16 v[78:79], v17 offset:2048
    s_waitcnt lgkmcnt(14)
    v_mfma_f32_16x16x32_bf16 v[176:179], v[80:83], v[136:139], v[176:179]
    ds_read_b64_tr_b16 v[80:81], v14 offset:8192
    ds_read_b64_tr_b16 v[82:83], v14 offset:10240
    s_waitcnt lgkmcnt(14)
    v_mfma_f32_16x16x32_bf16 v[180:183], v[84:87], v[136:139], v[180:183]
    ds_read_b64_tr_b16 v[84:85], v15 offset:8192
    ds_read_b64_tr_b16 v[86:87], v15 offset:10240
    s_waitcnt lgkmcnt(14)
    v_mfma_f32_16x16x32_bf16 v[184:187], v[88:91], v[136:139], v[184:187]
    ds_read_b64_tr_b16 v[88:89], v16 offset:8192
    ds_read_b64_tr_b16 v[90:91], v16 offset:10240
    s_waitcnt lgkmcnt(14)
    v_mfma_f32_16x16x32_bf16 v[188:191], v[92:95], v[136:139], v[188:191]
    ds_read_b64_tr_b16 v[92:93], v17 offset:8192
    ds_read_b64_tr_b16 v[94:95], v17 offset:10240
    s_waitcnt vmcnt(1)
    s_waitcnt vmcnt(0)
    s_barrier
    s_cmp_eq_u32 s4, 0
    s_cbranch_scc0 L_f10_skip
    s_lshl_b32 s5, s61, 5
    s_add_u32 s5, s5, s63
    s_lshl_b32 s5, s5, 8
    s_add_u32 s5, s5, 0
    v_mov_b32 v41, s5
    v_mov_b32 v42, s68
    v_mov_b32 v43, s69
    s_mov_b64 exec, 1
    global_store_dwordx2 v41, v[42:43], s[22:23] sc1
    s_mov_b64 exec, -1
L_f10_skip:
    s_waitcnt lgkmcnt(14)
    v_mfma_f32_16x16x32_bf16 v[176:179], v[64:67], v[144:147], v[176:179]
    ds_read_b64_tr_b16 v[64:65], v14 offset:32768
    ds_read_b64_tr_b16 v[66:67], v14 offset:34816
    s_add_u32 s100, s62, 3
    s_and_b32 s100, s100, 3
    s_lshl_b32 s100, s100, 17
    s_add_u32 m0, s65, 131072
    s_add_u32 s7, s100, 0
    buffer_load_dwordx4 v5, s[40:43], s7 offen lds
    s_add_u32 m0, s65, 135168
    s_add_u32 s7, s100, 16384
    buffer_load_dwordx4 v5, s[40:43], s7 offen lds
    s_waitcnt lgkmcnt(14)
    v_mfma_f32_16x16x32_bf16 v[180:183], v[68:71], v[144:147], v[180:183]
    ds_read_b64_tr_b16 v[68:69], v15 offset:32768
    ds_read_b64_tr_b16 v[70:71], v15 offset:34816
    s_add_u32 m0, s65, 139264
    s_add_u32 s7, s100, 32768
    buffer_load_dwordx4 v5, s[40:43], s7 offen lds
    s_add_u32 m0, s65, 143360
    s_add_u32 s7, s100, 49152
    buffer_load_dwordx4 v5, s[40:43], s7 offen lds
    s_waitcnt lgkmcnt(14)
    v_mfma_f32_16x16x32_bf16 v[184:187], v[72:75], v[144:147], v[184:187]
    ds_read_b64_tr_b16 v[72:73], v16 offset:32768
    ds_read_b64_tr_b16 v[74:75], v16 offset:34816
    s_add_u32 s100, s62, 1
    s_and_b32 s100, s100, 3
    s_lshl_b32 s100, s100, 17
    s_add_u32 m0, s65, 147456
    s_add_u32 s7, s100, 65536
    buffer_load_dwordx4 v5, s[40:43], s7 offen lds
    s_add_u32 m0, s65, 151552
    s_add_u32 s7, s100, 81920
    buffer_load_dwordx4 v5, s[40:43], s7 offen lds
    s_waitcnt lgkmcnt(14)
    v_mfma_f32_16x16x32_bf16 v[188:191], v[76:79], v[144:147], v[188:191]
    ds_read_b64_tr_b16 v[76:77], v17 offset:32768
    ds_read_b64_tr_b16 v[78:79], v17 offset:34816
    s_add_u32 m0, s65, 155648
    s_add_u32 s7, s100, 98304
    buffer_load_dwordx4 v5, s[40:43], s7 offen lds
    s_add_u32 m0, s65, 159744
    s_add_u32 s7, s100, 114688
    buffer_load_dwordx4 v5, s[40:43], s7 offen lds
    s_waitcnt lgkmcnt(14)
    v_mfma_f32_16x16x32_bf16 v[176:179], v[80:83], v[152:155], v[176:179]
    ds_read_b64_tr_b16 v[80:81], v14 offset:40960
    ds_read_b64_tr_b16 v[82:83], v14 offset:43008
    s_add_u32 s100, s62, 2
    s_and_b32 s100, s100, 3
    s_lshl_b32 s100, s100, 17
    s_add_u32 m0, s65, 98304
    s_add_u32 s7, s100, 65536
    buffer_load_dwordx4 v5, s[40:43], s7 offen lds
    s_waitcnt lgkmcnt(14)
    v_mfma_f32_16x16x32_bf16 v[180:183], v[84:87], v[152:155], v[180:183]
    ds_read_b64_tr_b16 v[84:85], v15 offset:40960
    ds_read_b64_tr_b16 v[86:87], v15 offset:43008
    s_add_u32 m0, s65, 102400
    s_add_u32 s7, s100, 81920
    buffer_load_dwordx4 v5, s[40:43], s7 offen lds
    s_waitcnt lgkmcnt(14)
    v_mfma_f32_16x16x32_bf16 v[184:187], v[88:91], v[152:155], v[184:187]
    ds_read_b64_tr_b16 v[88:89], v16 offset:40960
    ds_read_b64_tr_b16 v[90:91], v16 offset:43008
    s_add_u32 m0, s65, 106496
    s_add_u32 s7, s100, 98304
    buffer_load_dwordx4 v5, s[40:43], s7 offen lds
    s_waitcnt lgkmcnt(14)
    v_mfma_f32_16x16x32_bf16 v[188:191], v[92:95], v[152:155], v[188:191]
    ds_read_b64_tr_b16 v[92:93], v17 offset:40960
    ds_read_b64_tr_b16 v[94:95], v17 offset:43008
    s_add_u32 m0, s65, 110592
    s_add_u32 s7, s100, 114688
    buffer_load_dwordx4 v5, s[40:43], s7 offen lds
    s_barrier
    s_cmp_eq_u32 s4, 0
    s_cbranch_scc0 L_e10_skip
    s_lshl_b32 s5, s61, 5
    s_add_u32 s5, s5, s63
    s_lshl_b32 s5, s5, 8
    s_add_u32 s5, s5, 0
    v_add_u32 v58, 1, v0
    v_lshlrev_b32 v58, 8, v58
    v_xor_b32 v58, s5, v58
    s_mov_b64 exec, 7
    global_load_dwordx2 v[60:61], v58, s[22:23] sc1
    s_mov_b64 exec, -1
L_e10_skip:
    s_waitcnt lgkmcnt(14)
    v_mfma_f32_16x16x32_bf16 v[176:179], v[64:67], v[160:163], v[176:179]
    s_waitcnt lgkmcnt(12)
    v_mfma_f32_16x16x32_bf16 v[180:183], v[68:71], v[160:163], v[180:183]
    s_waitcnt lgkmcnt(10)
    v_mfma_f32_16x16x32_bf16 v[184:187], v[72:75], v[160:163], v[184:187]
    s_waitcnt lgkmcnt(8)
    v_mfma_f32_16x16x32_bf16 v[188:191], v[76:79], v[160:163], v[188:191]
    s_waitcnt lgkmcnt(6)
    v_mfma_f32_16x16x32_bf16 v[176:179], v[80:83], v[168:171], v[176:179]
    s_waitcnt lgkmcnt(4)
    v_mfma_f32_16x16x32_bf16 v[180:183], v[84:87], v[168:171], v[180:183]
    s_waitcnt lgkmcnt(2)
    v_mfma_f32_16x16x32_bf16 v[184:187], v[88:91], v[168:171], v[184:187]
    s_waitcnt lgkmcnt(0)
    v_mfma_f32_16x16x32_bf16 v[188:191], v[92:95], v[168:171], v[188:191]
    s_nop 3
    ds_write_b128 v37, v[184:187] offset:16384
    s_nop 2
    ds_write_b128 v37, v[188:191] offset:17408
    v_mov_b32 v248, v176
    v_mov_b32 v249, v177
    v_mov_b32 v250, v178
    v_mov_b32 v251, v179
    v_mov_b32 v252, v180
    v_mov_b32 v253, v181
    v_mov_b32 v254, v182
    v_mov_b32 v255, v183
    s_waitcnt lgkmcnt(0)
    s_barrier
    ds_read_b128 v[240:243], v38 offset:16384
    ds_read_b128 v[244:247], v38 offset:17408
    v_mul_f32 v248, v248, v39
    v_mul_f32 v249, v249, v39
    v_mul_f32 v250, v250, v39
    v_mul_f32 v251, v251, v39
    v_mul_f32 v252, v252, v39
    v_mul_f32 v253, v253, v39
    v_mul_f32 v254, v254, v39
    v_mul_f32 v255, v255, v39
    s_waitcnt lgkmcnt(1)
    v_fmac_f32 v248, v240, v40
    v_fmac_f32 v249, v241, v40
    v_fmac_f32 v250, v242, v40
    v_fmac_f32 v251, v243, v40
    s_waitcnt lgkmcnt(0)
    v_fmac_f32 v252, v244, v40
    v_fmac_f32 v253, v245, v40
    v_fmac_f32 v254, v246, v40
    v_fmac_f32 v255, v247, v40
    v_cvt_pk_bf16_f32 v212, v248, v249
    v_cvt_pk_bf16_f32 v213, v250, v251
    v_cvt_pk_bf16_f32 v214, v252, v253
    v_cvt_pk_bf16_f32 v215, v254, v255
    s_mul_i32 s7, s58, 40960
    s_add_u32 s7, s7, s65
    s_add_u32 s7, s7, 36864
    buffer_store_dwordx4 v[212:215], v26, s[44:47], s7 offen sc1
    ds_read_b64_tr_b16 v[64:65], v18
    ds_read_b64_tr_b16 v[66:67], v18 offset:4096
    s_nop 7
    ds_read_b64_tr_b16 v[68:69], v19
    ds_read_b64_tr_b16 v[70:71], v19 offset:4096
    s_nop 7
    ds_read_b64_tr_b16 v[72:73], v20
    ds_read_b64_tr_b16 v[74:75], v20 offset:4096
    s_nop 7
    ds_read_b64_tr_b16 v[76:77], v21
    ds_read_b64_tr_b16 v[78:79], v21 offset:4096
    s_nop 7
    ds_read_b64_tr_b16 v[80:81], v22
    ds_read_b64_tr_b16 v[82:83], v22 offset:4096
    s_nop 7
    ds_read_b64_tr_b16 v[84:85], v23
    ds_read_b64_tr_b16 v[86:87], v23 offset:4096
    s_nop 7
    ds_read_b64_tr_b16 v[88:89], v24
    ds_read_b64_tr_b16 v[90:91], v24 offset:4096
    s_nop 7
    ds_read_b64_tr_b16 v[92:93], v25
    ds_read_b64_tr_b16 v[94:95], v25 offset:4096
    s_nop 7
    s_cmp_eq_u32 s4, 0
    s_cbranch_scc0 L_p10_skip
    s_waitcnt vmcnt(1)
    v_cmp_eq_u64 vcc, s[68:69], v[60:61]
    s_nop 1
    s_and_b32 s5, vcc_lo, 7
    s_cmp_eq_u32 s5, 7
    s_cbranch_scc1 L_p10_skip
    s_lshl_b32 s5, s61, 5
    s_add_u32 s5, s5, s63
    s_lshl_b32 s5, s5, 8
    s_add_u32 s5, s5, 0
    s_xor_b32 s6, s5, 0x200
    s_xor_b32 s7, s5, 0x300
    s_xor_b32 s5, s5, 0x100
    s_mov_b32 s71, 0
L_p10_loop:
    s_load_dwordx2 s[8:9], s[22:23], s5 offset:0 glc
    s_load_dwordx2 s[10:11], s[22:23], s6 offset:0 glc
    s_load_dwordx2 s[12:13], s[22:23], s7 offset:0 glc
    s_waitcnt lgkmcnt(0)
    s_xor_b64 s[8:9], s[8:9], s[68:69]
    s_xor_b64 s[10:11], s[10:11], s[68:69]
    s_xor_b64 s[12:13], s[12:13], s[68:69]
    s_or_b64 s[8:9], s[8:9], s[10:11]
    s_or_b64 s[8:9], s[8:9], s[12:13]
    s_cmp_eq_u64 s[8:9], 0
    s_cbranch_scc1 L_p10_ok
    s_add_u32 s71, s71, 1
    s_cmp_lt_u32 s71, 200000
    s_cbranch_scc1 L_p10_loop
L_p10_ok:
L_p10_skip:
    s_barrier
    s_add_u32 s5, s58, 1
    s_and_b32 s5, s5, 3
    s_mul_i32 s5, s5, 40960
    s_add_u32 s5, s5, s65
    s_add_u32 s5, s5, 16384
    buffer_load_dwordx4 v[216:219], v26, s[44:47], s5 offen sc1
    s_add_u32 s5, s58, 2
    s_and_b32 s5, s5, 3
    s_mul_i32 s5, s5, 40960
    s_add_u32 s5, s5, s65
    s_add_u32 s5, s5, 16384
    buffer_load_dwordx4 v[220:223], v26, s[44:47], s5 offen sc1
    s_add_u32 s5, s58, 3
    s_and_b32 s5, s5, 3
    s_mul_i32 s5, s5, 40960
    s_add_u32 s5, s5, s65
    s_add_u32 s5, s5, 16384
    buffer_load_dwordx4 v[224:227], v26, s[44:47], s5 offen sc1
    s_waitcnt lgkmcnt(14)
    v_mfma_f32_16x16x32_bf16 v[176:179], v[64:67], v[208:211], 0
    ds_read_b64_tr_b16 v[64:65], v18 offset:32768
    ds_read_b64_tr_b16 v[66:67], v18 offset:36864
    s_add_u32 s100, s62, 3
    s_and_b32 s100, s100, 3
    s_lshl_b32 s100, s100, 17
    s_add_u32 m0, s65, 81920
    s_add_u32 s7, s100, 65536
    buffer_load_dwordx4 v5, s[40:43], s7 offen lds
    s_waitcnt lgkmcnt(14)
    v_mfma_f32_16x16x32_bf16 v[180:183], v[68:71], v[208:211], 0
    ds_read_b64_tr_b16 v[68:69], v19 offset:32768
    ds_read_b64_tr_b16 v[70:71], v19 offset:36864
    s_add_u32 m0, s65, 86016
    s_add_u32 s7, s100, 81920
    buffer_load_dwordx4 v5, s[40:43], s7 offen lds
    s_waitcnt lgkmcnt(14)
    v_mfma_f32_16x16x32_bf16 v[184:187], v[72:75], v[208:211], 0
    ds_read_b64_tr_b16 v[72:73], v20 offset:32768
    ds_read_b64_tr_b16 v[74:75], v20 offset:36864
    s_add_u32 m0, s65, 90112
    s_add_u32 s7, s100, 98304
    buffer_load_dwordx4 v5, s[40:43], s7 offen lds
    s_waitcnt lgkmcnt(14)
    v_mfma_f32_16x16x32_bf16 v[188:191], v[76:79], v[208:211], 0
    ds_read_b64_tr_b16 v[76:77], v21 offset:32768
    ds_read_b64_tr_b16 v[78:79], v21 offset:36864
    s_add_u32 m0, s65, 94208
    s_add_u32 s7, s100, 114688
    buffer_load_dwordx4 v5, s[40:43], s7 offen lds
    s_waitcnt lgkmcnt(14)
    v_mfma_f32_16x16x32_bf16 v[192:195], v[80:83], v[208:211], 0
    ds_read_b64_tr_b16 v[80:81], v22 offset:32768
    ds_read_b64_tr_b16 v[82:83], v22 offset:36864
    s_waitcnt lgkmcnt(14)
    v_mfma_f32_16x16x32_bf16 v[196:199], v[84:87], v[208:211], 0
    ds_read_b64_tr_b16 v[84:85], v23 offset:32768
    ds_read_b64_tr_b16 v[86:87], v23 offset:36864
    s_waitcnt lgkmcnt(14)
    v_mfma_f32_16x16x32_bf16 v[200:203], v[88:91], v[208:211], 0
    ds_read_b64_tr_b16 v[88:89], v24 offset:32768
    ds_read_b64_tr_b16 v[90:91], v24 offset:36864
    s_waitcnt lgkmcnt(14)
    v_mfma_f32_16x16x32_bf16 v[204:207], v[92:95], v[208:211], 0
    ds_read_b64_tr_b16 v[92:93], v25 offset:32768
    ds_read_b64_tr_b16 v[94:95], v25 offset:36864
    s_waitcnt lgkmcnt(14)
    v_mfma_f32_16x16x32_bf16 v[176:179], v[64:67], v[212:215], v[176:179]
    ds_read_b64_tr_b16 v[64:65], v18 offset:49152
    ds_read_b64_tr_b16 v[66:67], v18 offset:53248
    s_waitcnt lgkmcnt(14)
    v_mfma_f32_16x16x32_bf16 v[180:183], v[68:71], v[212:215], v[180:183]
    ds_read_b64_tr_b16 v[68:69], v19 offset:49152
    ds_read_b64_tr_b16 v[70:71], v19 offset:53248
    s_waitcnt lgkmcnt(14)
    v_mfma_f32_16x16x32_bf16 v[184:187], v[72:75], v[212:215], v[184:187]
    ds_read_b64_tr_b16 v[72:73], v20 offset:49152
    ds_read_b64_tr_b16 v[74:75], v20 offset:53248
    s_waitcnt lgkmcnt(14)
    v_mfma_f32_16x16x32_bf16 v[188:191], v[76:79], v[212:215], v[188:191]
    ds_read_b64_tr_b16 v[76:77], v21 offset:49152
    ds_read_b64_tr_b16 v[78:79], v21 offset:53248
    s_waitcnt lgkmcnt(14)
    v_mfma_f32_16x16x32_bf16 v[192:195], v[80:83], v[212:215], v[192:195]
    ds_read_b64_tr_b16 v[80:81], v22 offset:49152
    ds_read_b64_tr_b16 v[82:83], v22 offset:53248
    s_waitcnt lgkmcnt(14)
    v_mfma_f32_16x16x32_bf16 v[196:199], v[84:87], v[212:215], v[196:199]
    ds_read_b64_tr_b16 v[84:85], v23 offset:49152
    ds_read_b64_tr_b16 v[86:87], v23 offset:53248
    s_waitcnt lgkmcnt(14)
    v_mfma_f32_16x16x32_bf16 v[200:203], v[88:91], v[212:215], v[200:203]
    ds_read_b64_tr_b16 v[88:89], v24 offset:49152
    ds_read_b64_tr_b16 v[90:91], v24 offset:53248
    s_waitcnt lgkmcnt(14)
    v_mfma_f32_16x16x32_bf16 v[204:207], v[92:95], v[212:215], v[204:207]
    ds_read_b64_tr_b16 v[92:93], v25 offset:49152
    ds_read_b64_tr_b16 v[94:95], v25 offset:53248
    s_waitcnt vmcnt(16)
    s_waitcnt vmcnt(7)
    s_barrier
    s_cmp_eq_u32 s4, 0
    s_cbranch_scc0 L_f11_skip
    s_lshl_b32 s5, s61, 5
    s_add_u32 s5, s5, s63
    s_lshl_b32 s5, s5, 8
    s_add_u32 s5, s5, 128
    v_mov_b32 v41, s5
    v_mov_b32 v42, s68
    v_mov_b32 v43, s69
    s_mov_b64 exec, 1
    global_store_dwordx2 v41, v[42:43], s[22:23] sc1
    s_mov_b64 exec, -1
L_f11_skip:
    s_waitcnt vmcnt(6) lgkmcnt(14)
    v_mfma_f32_16x16x32_bf16 v[176:179], v[64:67], v[216:219], v[176:179]
    v_add_u32 v18, 0x8000, v18
    v_add_u32 v19, 0x8000, v19
    v_add_u32 v20, 0x8000, v20
    v_add_u32 v21, 0x8000, v21
    v_add_u32 v22, 0x8000, v22
    v_add_u32 v23, 0x8000, v23
    v_add_u32 v24, 0x8000, v24
    v_add_u32 v25, 0x8000, v25
    ds_read_b64_tr_b16 v[64:65], v18 offset:32768
    ds_read_b64_tr_b16 v[66:67], v18 offset:36864
    s_waitcnt lgkmcnt(14)
    v_mfma_f32_16x16x32_bf16 v[180:183], v[68:71], v[216:219], v[180:183]
    ds_read_b64_tr_b16 v[68:69], v19 offset:32768
    ds_read_b64_tr_b16 v[70:71], v19 offset:36864
    s_waitcnt lgkmcnt(14)
    v_mfma_f32_16x16x32_bf16 v[184:187], v[72:75], v[216:219], v[184:187]
    ds_read_b64_tr_b16 v[72:73], v20 offset:32768
    ds_read_b64_tr_b16 v[74:75], v20 offset:36864
    s_waitcnt lgkmcnt(14)
    v_mfma_f32_16x16x32_bf16 v[188:191], v[76:79], v[216:219], v[188:191]
    ds_read_b64_tr_b16 v[76:77], v21 offset:32768
    ds_read_b64_tr_b16 v[78:79], v21 offset:36864
    s_waitcnt lgkmcnt(14)
    v_mfma_f32_16x16x32_bf16 v[192:195], v[80:83], v[216:219], v[192:195]
    ds_read_b64_tr_b16 v[80:81], v22 offset:32768
    ds_read_b64_tr_b16 v[82:83], v22 offset:36864
    s_waitcnt lgkmcnt(14)
    v_mfma_f32_16x16x32_bf16 v[196:199], v[84:87], v[216:219], v[196:199]
    ds_read_b64_tr_b16 v[84:85], v23 offset:32768
    ds_read_b64_tr_b16 v[86:87], v23 offset:36864
    s_waitcnt lgkmcnt(14)
    v_mfma_f32_16x16x32_bf16 v[200:203], v[88:91], v[216:219], v[200:203]
    ds_read_b64_tr_b16 v[88:89], v24 offset:32768
    ds_read_b64_tr_b16 v[90:91], v24 offset:36864
    s_waitcnt lgkmcnt(14)
    v_mfma_f32_16x16x32_bf16 v[204:207], v[92:95], v[216:219], v[204:207]
    ds_read_b64_tr_b16 v[92:93], v25 offset:32768
    ds_read_b64_tr_b16 v[94:95], v25 offset:36864
    s_cmp_eq_u32 s4, 0
    s_cbranch_scc0 L_p11_skip
    s_lshl_b32 s5, s61, 5
    s_add_u32 s5, s5, s63
    s_lshl_b32 s5, s5, 8
    s_add_u32 s5, s5, 0
    s_xor_b32 s6, s5, 0x200
    s_xor_b32 s7, s5, 0x300
    s_xor_b32 s5, s5, 0x100
    s_mov_b32 s71, 0
L_p11_loop:
    s_load_dwordx2 s[8:9], s[22:23], s5 offset:128 glc
    s_load_dwordx2 s[10:11], s[22:23], s6 offset:128 glc
    s_load_dwordx2 s[12:13], s[22:23], s7 offset:128 glc
    s_waitcnt lgkmcnt(0)
    s_xor_b64 s[8:9], s[8:9], s[68:69]
    s_xor_b64 s[10:11], s[10:11], s[68:69]
    s_xor_b64 s[12:13], s[12:13], s[68:69]
    s_or_b64 s[8:9], s[8:9], s[10:11]
    s_or_b64 s[8:9], s[8:9], s[12:13]
    s_cmp_eq_u64 s[8:9], 0
    s_cbranch_scc1 L_p11_ok
    s_add_u32 s71, s71, 1
    s_cmp_lt_u32 s71, 200000
    s_cbranch_scc1 L_p11_loop
L_p11_ok:
L_p11_skip:
    s_waitcnt vmcnt(0)
    s_barrier
    s_add_u32 s5, s58, 1
    s_and_b32 s5, s5, 3
    s_mul_i32 s5, s5, 40960
    s_add_u32 s5, s5, s65
    s_add_u32 s5, s5, 36864
    buffer_load_dwordx4 v[228:231], v26, s[44:47], s5 offen sc1
    s_add_u32 s5, s58, 2
    s_and_b32 s5, s5, 3
    s_mul_i32 s5, s5, 40960
    s_add_u32 s5, s5, s65
    s_add_u32 s5, s5, 36864
    buffer_load_dwordx4 v[232:235], v26, s[44:47], s5 offen sc1
    s_add_u32 s5, s58, 3
    s_and_b32 s5, s5, 3
    s_mul_i32 s5, s5, 40960
    s_add_u32 s5, s5, s65
    s_add_u32 s5, s5, 36864
    buffer_load_dwordx4 v[236:239], v26, s[44:47], s5 offen sc1
    s_waitcnt lgkmcnt(14)
    v_mfma_f32_16x16x32_bf16 v[176:179], v[64:67], v[220:223], v[176:179]
    v_add_u32 v18, 0xc000, v18
    v_add_u32 v19, 0xc000, v19
    v_add_u32 v20, 0xc000, v20
    v_add_u32 v21, 0xc000, v21
    v_add_u32 v22, 0xc000, v22
    v_add_u32 v23, 0xc000, v23
    v_add_u32 v24, 0xc000, v24
    v_add_u32 v25, 0xc000, v25
    ds_read_b64_tr_b16 v[64:65], v18 offset:49152
    ds_read_b64_tr_b16 v[66:67], v18 offset:53248
    s_waitcnt lgkmcnt(14)
    v_mfma_f32_16x16x32_bf16 v[180:183], v[68:71], v[220:223], v[180:183]
    ds_read_b64_tr_b16 v[68:69], v19 offset:49152
    ds_read_b64_tr_b16 v[70:71], v19 offset:53248
    s_waitcnt lgkmcnt(14)
    v_mfma_f32_16x16x32_bf16 v[184:187], v[72:75], v[220:223], v[184:187]
    ds_read_b64_tr_b16 v[72:73], v20 offset:49152
    ds_read_b64_tr_b16 v[74:75], v20 offset:53248
    s_waitcnt lgkmcnt(14)
    v_mfma_f32_16x16x32_bf16 v[188:191], v[76:79], v[220:223], v[188:191]
    ds_read_b64_tr_b16 v[76:77], v21 offset:49152
    ds_read_b64_tr_b16 v[78:79], v21 offset:53248
    s_waitcnt lgkmcnt(14)
    v_mfma_f32_16x16x32_bf16 v[192:195], v[80:83], v[220:223], v[192:195]
    ds_read_b64_tr_b16 v[80:81], v22 offset:49152
    ds_read_b64_tr_b16 v[82:83], v22 offset:53248
    s_waitcnt lgkmcnt(14)
    v_mfma_f32_16x16x32_bf16 v[196:199], v[84:87], v[220:223], v[196:199]
    ds_read_b64_tr_b16 v[84:85], v23 offset:49152
    ds_read_b64_tr_b16 v[86:87], v23 offset:53248
    s_waitcnt lgkmcnt(14)
    v_mfma_f32_16x16x32_bf16 v[200:203], v[88:91], v[220:223], v[200:203]
    ds_read_b64_tr_b16 v[88:89], v24 offset:49152
    ds_read_b64_tr_b16 v[90:91], v24 offset:53248
    s_waitcnt lgkmcnt(14)
    v_mfma_f32_16x16x32_bf16 v[204:207], v[92:95], v[220:223], v[204:207]
    ds_read_b64_tr_b16 v[92:93], v25 offset:49152
    ds_read_b64_tr_b16 v[94:95], v25 offset:53248
    s_waitcnt lgkmcnt(14)
    v_mfma_f32_16x16x32_bf16 v[176:179], v[64:67], v[224:227], v[176:179]
    v_add_u32 v18, 0x4000, v18
    v_add_u32 v19, 0x4000, v19
    v_add_u32 v20, 0x4000, v20
    v_add_u32 v21, 0x4000, v21
    v_add_u32 v22, 0x4000, v22
    v_add_u32 v23, 0x4000, v23
    v_add_u32 v24, 0x4000, v24
    v_add_u32 v25, 0x4000, v25
    ds_read_b64_tr_b16 v[64:65], v18 offset:49152
    ds_read_b64_tr_b16 v[66:67], v18 offset:53248
    s_waitcnt lgkmcnt(14)
    v_mfma_f32_16x16x32_bf16 v[180:183], v[68:71], v[224:227], v[180:183]
    ds_read_b64_tr_b16 v[68:69], v19 offset:49152
    ds_read_b64_tr_b16 v[70:71], v19 offset:53248
    s_waitcnt lgkmcnt(14)
    v_mfma_f32_16x16x32_bf16 v[184:187], v[72:75], v[224:227], v[184:187]
    ds_read_b64_tr_b16 v[72:73], v20 offset:49152
    ds_read_b64_tr_b16 v[74:75], v20 offset:53248
    s_waitcnt lgkmcnt(14)
    v_mfma_f32_16x16x32_bf16 v[188:191], v[76:79], v[224:227], v[188:191]
    ds_read_b64_tr_b16 v[76:77], v21 offset:49152
    ds_read_b64_tr_b16 v[78:79], v21 offset:53248
    s_waitcnt lgkmcnt(14)
    v_mfma_f32_16x16x32_bf16 v[192:195], v[80:83], v[224:227], v[192:195]
    ds_read_b64_tr_b16 v[80:81], v22 offset:49152
    ds_read_b64_tr_b16 v[82:83], v22 offset:53248
    s_waitcnt lgkmcnt(14)
    v_mfma_f32_16x16x32_bf16 v[196:199], v[84:87], v[224:227], v[196:199]
    ds_read_b64_tr_b16 v[84:85], v23 offset:49152
    ds_read_b64_tr_b16 v[86:87], v23 offset:53248
    s_waitcnt lgkmcnt(14)
    v_mfma_f32_16x16x32_bf16 v[200:203], v[88:91], v[224:227], v[200:203]
    ds_read_b64_tr_b16 v[88:89], v24 offset:49152
    ds_read_b64_tr_b16 v[90:91], v24 offset:53248
    s_waitcnt lgkmcnt(14)
    v_mfma_f32_16x16x32_bf16 v[204:207], v[92:95], v[224:227], v[204:207]
    ds_read_b64_tr_b16 v[92:93], v25 offset:49152
    ds_read_b64_tr_b16 v[94:95], v25 offset:53248
    s_waitcnt vmcnt(2) lgkmcnt(14)
    v_mfma_f32_16x16x32_bf16 v[176:179], v[64:67], v[228:231], v[176:179]
    ds_read_b64_tr_b16 v[64:65], v18
    ds_read_b64_tr_b16 v[66:67], v18 offset:4096
    s_waitcnt lgkmcnt(14)
    v_mfma_f32_16x16x32_bf16 v[180:183], v[68:71], v[228:231], v[180:183]
    ds_read_b64_tr_b16 v[68:69], v19
    ds_read_b64_tr_b16 v[70:71], v19 offset:4096
    s_waitcnt lgkmcnt(14)
    v_mfma_f32_16x16x32_bf16 v[184:187], v[72:75], v[228:231], v[184:187]
    ds_read_b64_tr_b16 v[72:73], v20
    ds_read_b64_tr_b16 v[74:75], v20 offset:4096
    s_waitcnt lgkmcnt(14)
    v_mfma_f32_16x16x32_bf16 v[188:191], v[76:79], v[228:231], v[188:191]
    ds_read_b64_tr_b16 v[76:77], v21
    ds_read_b64_tr_b16 v[78:79], v21 offset:4096
    s_waitcnt lgkmcnt(14)
    v_mfma_f32_16x16x32_bf16 v[192:195], v[80:83], v[228:231], v[192:195]
    ds_read_b64_tr_b16 v[80:81], v22
    ds_read_b64_tr_b16 v[82:83], v22 offset:4096
    s_waitcnt lgkmcnt(14)
    v_mfma_f32_16x16x32_bf16 v[196:199], v[84:87], v[228:231], v[196:199]
    ds_read_b64_tr_b16 v[84:85], v23
    ds_read_b64_tr_b16 v[86:87], v23 offset:4096
    s_waitcnt lgkmcnt(14)
    v_mfma_f32_16x16x32_bf16 v[200:203], v[88:91], v[228:231], v[200:203]
    ds_read_b64_tr_b16 v[88:89], v24
    ds_read_b64_tr_b16 v[90:91], v24 offset:4096
    s_waitcnt lgkmcnt(14)
    v_mfma_f32_16x16x32_bf16 v[204:207], v[92:95], v[228:231], v[204:207]
    ds_read_b64_tr_b16 v[92:93], v25
    ds_read_b64_tr_b16 v[94:95], v25 offset:4096
    s_waitcnt vmcnt(1) lgkmcnt(14)
    v_mfma_f32_16x16x32_bf16 v[176:179], v[64:67], v[232:235], v[176:179]
    v_add_u32 v18, 0xffffc000, v18
    v_add_u32 v19, 0xffffc000, v19
    v_add_u32 v20, 0xffffc000, v20
    v_add_u32 v21, 0xffffc000, v21
    v_add_u32 v22, 0xffffc000, v22
    v_add_u32 v23, 0xffffc000, v23
    v_add_u32 v24, 0xffffc000, v24
    v_add_u32 v25, 0xffffc000, v25
    ds_read_b64_tr_b16 v[64:65], v18
    ds_read_b64_tr_b16 v[66:67], v18 offset:4096
    s_waitcnt lgkmcnt(14)
    v_mfma_f32_16x16x32_bf16 v[180:183], v[68:71], v[232:235], v[180:183]
    ds_read_b64_tr_b16 v[68:69], v19
    ds_read_b64_tr_b16 v[70:71], v19 offset:4096
    s_waitcnt lgkmcnt(14)
    v_mfma_f32_16x16x32_bf16 v[184:187], v[72:75], v[232:235], v[184:187]
    ds_read_b64_tr_b16 v[72:73], v20
    ds_read_b64_tr_b16 v[74:75], v20 offset:4096
    s_waitcnt lgkmcnt(14)
    v_mfma_f32_16x16x32_bf16 v[188:191], v[76:79], v[232:235], v[188:191]
    ds_read_b64_tr_b16 v[76:77], v21
    ds_read_b64_tr_b16 v[78:79], v21 offset:4096
    s_waitcnt lgkmcnt(14)
    v_mfma_f32_16x16x32_bf16 v[192:195], v[80:83], v[232:235], v[192:195]
    ds_read_b64_tr_b16 v[80:81], v22
    ds_read_b64_tr_b16 v[82:83], v22 offset:4096
    s_waitcnt lgkmcnt(14)
    v_mfma_f32_16x16x32_bf16 v[196:199], v[84:87], v[232:235], v[196:199]
    ds_read_b64_tr_b16 v[84:85], v23
    ds_read_b64_tr_b16 v[86:87], v23 offset:4096
    s_waitcnt lgkmcnt(14)
    v_mfma_f32_16x16x32_bf16 v[200:203], v[88:91], v[232:235], v[200:203]
    ds_read_b64_tr_b16 v[88:89], v24
    ds_read_b64_tr_b16 v[90:91], v24 offset:4096
    s_waitcnt lgkmcnt(14)
    v_mfma_f32_16x16x32_bf16 v[204:207], v[92:95], v[232:235], v[204:207]
    ds_read_b64_tr_b16 v[92:93], v25
    ds_read_b64_tr_b16 v[94:95], v25 offset:4096
    s_waitcnt vmcnt(0) lgkmcnt(14)
    v_mfma_f32_16x16x32_bf16 v[176:179], v[64:67], v[236:239], v[176:179]
    s_waitcnt lgkmcnt(12)
    v_mfma_f32_16x16x32_bf16 v[180:183], v[68:71], v[236:239], v[180:183]
    s_waitcnt lgkmcnt(10)
    v_mfma_f32_16x16x32_bf16 v[184:187], v[72:75], v[236:239], v[184:187]
    s_waitcnt lgkmcnt(8)
    v_mfma_f32_16x16x32_bf16 v[188:191], v[76:79], v[236:239], v[188:191]
    s_waitcnt lgkmcnt(6)
    v_mfma_f32_16x16x32_bf16 v[192:195], v[80:83], v[236:239], v[192:195]
    s_waitcnt lgkmcnt(4)
    v_mfma_f32_16x16x32_bf16 v[196:199], v[84:87], v[236:239], v[196:199]
    s_waitcnt lgkmcnt(2)
    v_mfma_f32_16x16x32_bf16 v[200:203], v[88:91], v[236:239], v[200:203]
    s_waitcnt lgkmcnt(0)
    v_mfma_f32_16x16x32_bf16 v[204:207], v[92:95], v[236:239], v[204:207]
    s_lshl_b32 s6, s4, 12
    v_add_u32 v37, s6, v26
    v_xor_b32 v38, 4096, v37
    ds_write_b128 v37, v[192:195] offset:16384
    ds_write_b128 v37, v[196:199] offset:17408
    ds_write_b128 v37, v[200:203] offset:18432
    s_nop 1
    ds_write_b128 v37, v[204:207] offset:19456
    s_waitcnt lgkmcnt(0)
    s_barrier
    ds_read_b128 v[240:243], v38 offset:16384
    ds_read_b128 v[244:247], v38 offset:17408
    ds_read_b128 v[248:251], v38 offset:18432
    ds_read_b128 v[252:255], v38 offset:19456
    s_waitcnt lgkmcnt(3)
    v_add_f32 v176, v176, v240
    v_add_f32 v177, v177, v241
    v_add_f32 v178, v178, v242
    v_add_f32 v179, v179, v243
    s_waitcnt lgkmcnt(2)
    v_add_f32 v180, v180, v244
    v_add_f32 v181, v181, v245
    v_add_f32 v182, v182, v246
    v_add_f32 v183, v183, v247
    s_waitcnt lgkmcnt(1)
    v_add_f32 v184, v184, v248
    v_add_f32 v185, v185, v249
    v_add_f32 v186, v186, v250
    v_add_f32 v187, v187, v251
    s_waitcnt lgkmcnt(0)
    v_add_f32 v188, v188, v252
    v_add_f32 v189, v189, v253
    v_add_f32 v190, v190, v254
    v_add_f32 v191, v191, v255
    v_cvt_pk_bf16_f32 v64, v176, v177
    v_cvt_pk_bf16_f32 v65, v178, v179
    v_cvt_pk_bf16_f32 v66, v180, v181
    v_cvt_pk_bf16_f32 v67, v182, v183
    v_cvt_pk_bf16_f32 v68, v184, v185
    v_cvt_pk_bf16_f32 v69, v186, v187
    v_cvt_pk_bf16_f32 v70, v188, v189
    v_cvt_pk_bf16_f32 v71, v190, v191
    s_mul_i32 s70, s60, 40960
    s_lshl_b32 s5, s4, 11
    s_add_u32 s70, s70, s5
    s_add_u32 s70, s70, 32768
    buffer_store_dwordx4 v[64:67], v26, s[48:51], s70 offen sc1
    buffer_store_dwordx4 v[68:71], v26, s[48:51], s70 offen offset:1024 sc1
    s_lshl_b32 s70, s61, 2
    s_add_u32 s70, s70, s57
    s_lshl_b32 s70, s70, 12
    s_add_u32 s70, s70, 65536
    s_lshl_b32 s5, s60, 3
    s_add_u32 s5, s5, s70
    s_add_u32 s5, s5, s65
    s_waitcnt vmcnt(0)
    s_nop 0
    s_atomic_swap_x2 s[68:69], s[22:23], s5 offset:256
    s_nop 0
    s_atomic_swap_x2 s[68:69], s[22:23], s5 offset:768
    s_cmp_eq_u32 s4, 1
    s_cbranch_scc0 L_hend
    s_lshl_b32 s5, s60, 9
    s_add_u32 s70, s70, s5
    s_add_u32 s70, s70, 256
    s_mov_b32 s71, 0
L_p2h_loop:
    s_load_dwordx16 s[24:39], s[22:23], s70 glc
    s_waitcnt lgkmcnt(0)
    s_xor_b64 s[24:25], s[24:25], s[68:69]
    s_xor_b64 s[26:27], s[26:27], s[68:69]
    s_xor_b64 s[28:29], s[28:29], s[68:69]
    s_xor_b64 s[30:31], s[30:31], s[68:69]
    s_xor_b64 s[32:33], s[32:33], s[68:69]
    s_xor_b64 s[34:35], s[34:35], s[68:69]
    s_xor_b64 s[36:37], s[36:37], s[68:69]
    s_xor_b64 s[38:39], s[38:39], s[68:69]
    s_or_b64 s[24:25], s[24:25], s[26:27]
    s_or_b64 s[24:25], s[24:25], s[28:29]
    s_or_b64 s[24:25], s[24:25], s[30:31]
    s_or_b64 s[24:25], s[24:25], s[32:33]
    s_or_b64 s[24:25], s[24:25], s[34:35]
    s_or_b64 s[24:25], s[24:25], s[36:37]
    s_or_b64 s[24:25], s[24:25], s[38:39]
    s_cmp_eq_u64 s[24:25], 0
    s_cbranch_scc1 L_p2h_ok
    s_add_u32 s71, s71, 1
    s_cmp_lt_u32 s71, 200000
    s_cbranch_scc1 L_p2h_loop
L_p2h_ok:
    s_lshl_b32 s6, s60, 10
    s_add_u32 s6, s6, 32768
    v_and_b32 v30, 15, v0
    v_lshlrev_b32 v30, 10, v30
    v_lshrrev_b32 v32, 4, v0
    v_lshl_add_u32 v30, v32, 3, v30
    s_add_u32 s7, s6, 0
    buffer_load_dwordx4 v[64:67], v26, s[48:51], s7 offen sc1
    s_add_u32 s7, s6, 40960
    buffer_load_dwordx4 v[68:71], v26, s[48:51], s7 offen sc1
    s_add_u32 s7, s6, 81920
    buffer_load_dwordx4 v[72:75], v26, s[48:51], s7 offen sc1
    s_add_u32 s7, s6, 122880
    buffer_load_dwordx4 v[76:79], v26, s[48:51], s7 offen sc1
    s_add_u32 s7, s6, 163840
    buffer_load_dwordx4 v[80:83], v26, s[48:51], s7 offen sc1
    s_add_u32 s7, s6, 204800
    buffer_load_dwordx4 v[84:87], v26, s[48:51], s7 offen sc1
    s_add_u32 s7, s6, 245760
    buffer_load_dwordx4 v[88:91], v26, s[48:51], s7 offen sc1
    s_add_u32 s7, s6, 286720
    buffer_load_dwordx4 v[92:95], v26, s[48:51], s7 offen sc1
    s_waitcnt vmcnt(7)
    v_lshlrev_b32 v112, 16, v64
    v_and_b32 v113, 0xffff0000, v64
    v_lshlrev_b32 v114, 16, v65
    v_and_b32 v115, 0xffff0000, v65
    v_lshlrev_b32 v116, 16, v66
    v_and_b32 v117, 0xffff0000, v66
    v_lshlrev_b32 v118, 16, v67
    v_and_b32 v119, 0xffff0000, v67
    s_waitcnt vmcnt(6)
    v_lshlrev_b32 v120, 16, v68
    v_and_b32 v121, 0xffff0000, v68
    v_add_f32 v112, v112, v120
    v_add_f32 v113, v113, v121
    v_lshlrev_b32 v120, 16, v69
    v_and_b32 v121, 0xffff0000, v69
    v_add_f32 v114, v114, v120
    v_add_f32 v115, v115, v121
    v_lshlrev_b32 v120, 16, v70
    v_and_b32 v121, 0xffff0000, v70
    v_add_f32 v116, v116, v120
    v_add_f32 v117, v117, v121
    v_lshlrev_b32 v120, 16, v71
    v_and_b32 v121, 0xffff0000, v71
    v_add_f32 v118, v118, v120
    v_add_f32 v119, v119, v121
    s_waitcnt vmcnt(5)
    v_lshlrev_b32 v120, 16, v72
    v_and_b32 v121, 0xffff0000, v72
    v_add_f32 v112, v112, v120
    v_add_f32 v113, v113, v121
    v_lshlrev_b32 v120, 16, v73
    v_and_b32 v121, 0xffff0000, v73
    v_add_f32 v114, v114, v120
    v_add_f32 v115, v115, v121
    v_lshlrev_b32 v120, 16, v74
    v_and_b32 v121, 0xffff0000, v74
    v_add_f32 v116, v116, v120
    v_add_f32 v117, v117, v121
    v_lshlrev_b32 v120, 16, v75
    v_and_b32 v121, 0xffff0000, v75
    v_add_f32 v118, v118, v120
    v_add_f32 v119, v119, v121
    s_waitcnt vmcnt(4)
    v_lshlrev_b32 v120, 16, v76
    v_and_b32 v121, 0xffff0000, v76
    v_add_f32 v112, v112, v120
    v_add_f32 v113, v113, v121
    v_lshlrev_b32 v120, 16, v77
    v_and_b32 v121, 0xffff0000, v77
    v_add_f32 v114, v114, v120
    v_add_f32 v115, v115, v121
    v_lshlrev_b32 v120, 16, v78
    v_and_b32 v121, 0xffff0000, v78
    v_add_f32 v116, v116, v120
    v_add_f32 v117, v117, v121
    v_lshlrev_b32 v120, 16, v79
    v_and_b32 v121, 0xffff0000, v79
    v_add_f32 v118, v118, v120
    v_add_f32 v119, v119, v121
    s_waitcnt vmcnt(3)
    v_lshlrev_b32 v120, 16, v80
    v_and_b32 v121, 0xffff0000, v80
    v_add_f32 v112, v112, v120
    v_add_f32 v113, v113, v121
    v_lshlrev_b32 v120, 16, v81
    v_and_b32 v121, 0xffff0000, v81
    v_add_f32 v114, v114, v120
    v_add_f32 v115, v115, v121
    v_lshlrev_b32 v120, 16, v82
    v_and_b32 v121, 0xffff0000, v82
    v_add_f32 v116, v116, v120
    v_add_f32 v117, v117, v121
    v_lshlrev_b32 v120, 16, v83
    v_and_b32 v121, 0xffff0000, v83
    v_add_f32 v118, v118, v120
    v_add_f32 v119, v119, v121
    s_waitcnt vmcnt(2)
    v_lshlrev_b32 v120, 16, v84
    v_and_b32 v121, 0xffff0000, v84
    v_add_f32 v112, v112, v120
    v_add_f32 v113, v113, v121
    v_lshlrev_b32 v120, 16, v85
    v_and_b32 v121, 0xffff0000, v85
    v_add_f32 v114, v114, v120
    v_add_f32 v115, v115, v121
    v_lshlrev_b32 v120, 16, v86
    v_and_b32 v121, 0xffff0000, v86
    v_add_f32 v116, v116, v120
    v_add_f32 v117, v117, v121
    v_lshlrev_b32 v120, 16, v87
    v_and_b32 v121, 0xffff0000, v87
    v_add_f32 v118, v118, v120
    v_add_f32 v119, v119, v121
    s_waitcnt vmcnt(1)
    v_lshlrev_b32 v120, 16, v88
    v_and_b32 v121, 0xffff0000, v88
    v_add_f32 v112, v112, v120
    v_add_f32 v113, v113, v121
    v_lshlrev_b32 v120, 16, v89
    v_and_b32 v121, 0xffff0000, v89
    v_add_f32 v114, v114, v120
    v_add_f32 v115, v115, v121
    v_lshlrev_b32 v120, 16, v90
    v_and_b32 v121, 0xffff0000, v90
    v_add_f32 v116, v116, v120
    v_add_f32 v117, v117, v121
    v_lshlrev_b32 v120, 16, v91
    v_and_b32 v121, 0xffff0000, v91
    v_add_f32 v118, v118, v120
    v_add_f32 v119, v119, v121
    s_waitcnt vmcnt(0)
    v_lshlrev_b32 v120, 16, v92
    v_and_b32 v121, 0xffff0000, v92
    v_add_f32 v112, v112, v120
    v_add_f32 v113, v113, v121
    v_lshlrev_b32 v120, 16, v93
    v_and_b32 v121, 0xffff0000, v93
    v_add_f32 v114, v114, v120
    v_add_f32 v115, v115, v121
    v_lshlrev_b32 v120, 16, v94
    v_and_b32 v121, 0xffff0000, v94
    v_add_f32 v116, v116, v120
    v_add_f32 v117, v117, v121
    v_lshlrev_b32 v120, 16, v95
    v_and_b32 v121, 0xffff0000, v95
    v_add_f32 v118, v118, v120
    v_add_f32 v119, v119, v121
    v_cvt_pk_bf16_f32 v64, v112, v113
    v_cvt_pk_bf16_f32 v65, v114, v115
    v_cvt_pk_bf16_f32 v66, v116, v117
    v_cvt_pk_bf16_f32 v67, v118, v119
    s_lshr_b32 s5, s60, 2
    s_lshl_b32 s5, s5, 14
    s_add_u32 s5, s5, 131072
    s_and_b32 s6, s60, 3
    s_lshl_b32 s6, s6, 6
    s_add_u32 s5, s5, s6
    s_lshl_b32 s6, s57, 8
    s_add_u32 s5, s5, s6
    buffer_store_dwordx2 v[64:65], v30, s[52:55], s5 offen
    buffer_store_dwordx2 v[66:67], v30, s[52:55], s5 offen offset:32
L_hend:
    s_endpgm
L_main:
    s_getpc_b64 s[6:7]
L_pc:
    s_sub_u32 s6, s6, L_pc-standalone__mha_block_cached__near_ridge_kernel
    s_subb_u32 s7, s7, 0
    s_lshr_b32 s5, s2, 3
    s_lshl_b32 s5, s5, 2
    s_add_u32 s5, s5, s4
    s_lshl_b32 s5, s5, 9
    v_and_b32 v40, 7, v0
    v_lshlrev_b32 v40, 6, v40
    v_add_u32 v40, s5, v40
    v_min_u32 v40, L_end-standalone__mha_block_cached__near_ridge_kernel, v40
    global_load_dword v41, v40, s[6:7]
    s_waitcnt lgkmcnt(0)
    s_lshl_b32 s5, s61, 5
    s_add_u32 s5, s5, s63
    s_lshl_b32 s5, s5, 17
    s_add_u32 s32, s10, s5
    s_addc_u32 s33, s11, 0
    s_mov_b32 s34, 131072
    s_mov_b32 s35, 0x20000
    s_lshl_b32 s5, s61, 3
    s_add_u32 s5, s5, s60
    s_mul_i32 s5, s5, 163840
    s_add_u32 s5, s5, 2097152
    s_add_u32 s44, s22, s5
    s_addc_u32 s45, s23, 0
    s_mov_b32 s46, 163840
    s_mov_b32 s47, 0x20000
    s_lshl_b32 s5, s61, 2
    s_add_u32 s5, s5, s57
    s_mul_i32 s5, s5, 327680
    s_add_u32 s5, s5, 14680064
    s_add_u32 s48, s22, s5
    s_addc_u32 s49, s23, 0
    s_mov_b32 s50, 327680
    s_mov_b32 s51, 0x20000
    s_mul_i32 s5, s61, 163840
    s_add_u32 s52, s18, s5
    s_addc_u32 s53, s19, 0
    s_mov_b32 s54, 163840
    s_mov_b32 s55, 0x20000
    s_or_b32 s5, s2, s3
    s_cmp_eq_u32 s5, 0
    s_cbranch_scc0 L_nononce
    s_memrealtime s[6:7]
    s_waitcnt lgkmcnt(0)
    s_or_b32 s6, s6, 1
    v_mov_b32 v44, s6
    v_mov_b32 v45, s7
    v_mov_b32 v46, 0
    global_store_dwordx2 v46, v[44:45], s[20:21] sc1
L_nononce:
    s_waitcnt vmcnt(0)
L_restart_main:
    v_lshrrev_b32 v32, 4, v0
    v_bfe_u32 v33, v0, 2, 2
    v_and_b32 v34, 3, v0
    v_bfe_u32 v35, v0, 4, 1
    v_and_b32 v36, 15, v0
    v_lshrrev_b32 v37, 1, v32
    v_lshl_add_u32 v37, v37, 3, v33
    v_lshlrev_b32 v37, 8, v37
    v_xor_b32 v38, s4, v33
    v_lshl_add_u32 v37, v38, 6, v37
    v_lshl_add_u32 v37, v34, 4, v37
    v_mul_u32_u24 v38, 8200, v35
    v_add_u32 v69, v37, v38
    v_xor_b32 v70, 64, v69
    v_xor_b32 v71, 128, v69
    v_xor_b32 v72, 192, v69
    v_lshrrev_b32 v37, 2, v0
    v_lshlrev_b32 v37, 8, v37
    v_lshl_add_u32 v37, v33, 6, v37
    v_lshl_add_u32 v37, v35, 5, v37
    v_lshl_add_u32 v1, v34, 3, v37
    v_xor_b32 v2, 32, v1
    v_xor_b32 v3, 64, v1
    v_xor_b32 v4, 96, v1
    v_xor_b32 v5, 128, v1
    v_xor_b32 v6, 160, v1
    v_xor_b32 v7, 192, v1
    v_xor_b32 v8, 224, v1
    v_lshrrev_b32 v37, 1, v36
    v_xor_b32 v37, v37, v32
    v_lshlrev_b32 v37, 4, v37
    v_lshl_add_u32 v37, v36, 7, v37
    s_lshl_b32 s5, s4, 12
    v_add_u32 v64, s5, v37
    v_xor_b32 v65, 64, v64
    v_add_u32 v66, 16384, v37
    v_xor_b32 v67, 64, v66
    s_lshl_b32 s5, s4, 2
    v_add_u32 v37, s5, v32
    v_xor_b32 v37, v37, v36
    v_lshlrev_b32 v37, 4, v37
    v_lshl_add_u32 v37, v36, 8, v37
    v_add_u32 v9, 98304, v37
    v_xor_b32 v10, 64, v9
    v_xor_b32 v11, 128, v9
    v_xor_b32 v12, 192, v9
    v_lshlrev_b32 v17, 4, v0
    s_lshl_b32 s5, s4, 11
    v_add_u32 v68, s5, v17
    v_mov_b32 v20, 0x3f803f80
    v_mov_b32 v21, 0x3f803f80
    v_mov_b32 v22, 0x3f803f80
    v_mov_b32 v23, 0x3f803f80
    s_barrier
    ds_read_b128 v[208:211], v64
    ds_read_b64_tr_b16 v[32:33], v69 offset:20480
    ds_read_b64_tr_b16 v[34:35], v69 offset:21504
    ds_read_b128 v[212:215], v64 offset:2048
    s_waitcnt lgkmcnt(1)
    v_mfma_f32_16x16x32_bf16 v[128:131], v[32:35], v[208:211], 0
    s_waitcnt lgkmcnt(0)
    ds_read_b128 v[224:227], v66
    ds_read_b128 v[228:231], v66 offset:2048
    v_mfma_f32_16x16x32_bf16 v[136:139], v[32:35], v[212:215], 0
    s_waitcnt lgkmcnt(1)
    ds_read_b64_tr_b16 v[36:37], v69 offset:20488
    ds_read_b64_tr_b16 v[38:39], v69 offset:21512
    v_mfma_f32_16x16x32_bf16 v[192:195], v[32:35], v[224:227], 0
    s_waitcnt lgkmcnt(2)
    ds_read_b64_tr_b16 v[40:41], v70 offset:20480
    ds_read_b64_tr_b16 v[42:43], v70 offset:21504
    v_mfma_f32_16x16x32_bf16 v[200:203], v[32:35], v[228:231], 0
    s_waitcnt lgkmcnt(2)
    ds_read_b64_tr_b16 v[44:45], v70 offset:20488
    ds_read_b64_tr_b16 v[46:47], v70 offset:21512
    v_mfma_f32_16x16x32_bf16 v[132:135], v[36:39], v[208:211], 0
    ds_read_b64_tr_b16 v[48:49], v71 offset:20480
    ds_read_b64_tr_b16 v[50:51], v71 offset:21504
    v_mfma_f32_16x16x32_bf16 v[140:143], v[36:39], v[212:215], 0
    ds_read_b64_tr_b16 v[52:53], v71 offset:20488
    ds_read_b64_tr_b16 v[54:55], v71 offset:21512
    v_mfma_f32_16x16x32_bf16 v[196:199], v[36:39], v[224:227], 0
    ds_read_b64_tr_b16 v[56:57], v72 offset:20480
    ds_read_b64_tr_b16 v[58:59], v72 offset:21504
    v_mfma_f32_16x16x32_bf16 v[204:207], v[36:39], v[228:231], 0
    s_waitcnt lgkmcnt(8)
    ds_read_b64_tr_b16 v[60:61], v72 offset:20488
    ds_read_b64_tr_b16 v[62:63], v72 offset:21512
    v_mfma_f32_16x16x32_bf16 v[144:147], v[40:43], v[208:211], 0
    ds_read_b128 v[216:219], v65
    ds_read_b64_tr_b16 v[32:33], v69 offset:24576
    v_mfma_f32_16x16x32_bf16 v[152:155], v[40:43], v[212:215], 0
    s_waitcnt lgkmcnt(10)
    ds_read_b64_tr_b16 v[34:35], v69 offset:25600
    ds_read_b128 v[220:223], v65 offset:2048
    v_mfma_f32_16x16x32_bf16 v[148:151], v[44:47], v[208:211], 0
    ds_read_b128 v[232:235], v67
    v_mfma_f32_16x16x32_bf16 v[156:159], v[44:47], v[212:215], 0
    s_waitcnt lgkmcnt(11)
    ds_read_b128 v[236:239], v67 offset:2048
    v_mfma_f32_16x16x32_bf16 v[160:163], v[48:51], v[208:211], 0
    ds_read_b64_tr_b16 v[36:37], v69 offset:24584
    v_mfma_f32_16x16x32_bf16 v[168:171], v[48:51], v[212:215], 0
    s_waitcnt lgkmcnt(11)
    ds_read_b64_tr_b16 v[38:39], v69 offset:25608
    v_mfma_f32_16x16x32_bf16 v[164:167], v[52:55], v[208:211], 0
    ds_read_b64_tr_b16 v[40:41], v70 offset:24576
    v_mfma_f32_16x16x32_bf16 v[172:175], v[52:55], v[212:215], 0
    s_waitcnt lgkmcnt(11)
    ds_read_b64_tr_b16 v[42:43], v70 offset:25600
    v_mfma_f32_16x16x32_bf16 v[176:179], v[56:59], v[208:211], 0
    ds_read_b64_tr_b16 v[44:45], v70 offset:24584
    v_mfma_f32_16x16x32_bf16 v[184:187], v[56:59], v[212:215], 0
    s_waitcnt lgkmcnt(11)
    ds_read_b64_tr_b16 v[46:47], v70 offset:25608
    v_mfma_f32_16x16x32_bf16 v[180:183], v[60:63], v[208:211], 0
    ds_read_b64_tr_b16 v[48:49], v71 offset:24576
    v_mfma_f32_16x16x32_bf16 v[188:191], v[60:63], v[212:215], 0
    s_waitcnt lgkmcnt(10)
    ds_read_b64_tr_b16 v[50:51], v71 offset:25600
    v_mfma_f32_16x16x32_bf16 v[128:131], v[32:35], v[216:219], v[128:131]
    s_waitcnt lgkmcnt(10)
    ds_read_b64_tr_b16 v[52:53], v71 offset:24584
    v_mfma_f32_16x16x32_bf16 v[136:139], v[32:35], v[220:223], v[136:139]
    s_waitcnt lgkmcnt(10)
    ds_read_b64_tr_b16 v[54:55], v71 offset:25608
    v_mfma_f32_16x16x32_bf16 v[192:195], v[32:35], v[232:235], v[192:195]
    s_waitcnt lgkmcnt(10)
    ds_read_b64_tr_b16 v[56:57], v72 offset:24576
    v_mfma_f32_16x16x32_bf16 v[200:203], v[32:35], v[236:239], v[200:203]
    s_waitcnt lgkmcnt(9)
    ds_read_b64_tr_b16 v[58:59], v72 offset:25600
    v_mfma_f32_16x16x32_bf16 v[132:135], v[36:39], v[216:219], v[132:135]
    ds_read_b64_tr_b16 v[60:61], v72 offset:24584
    v_mfma_f32_16x16x32_bf16 v[140:143], v[36:39], v[220:223], v[140:143]
    ds_read_b64_tr_b16 v[62:63], v72 offset:25608
    v_mfma_f32_16x16x32_bf16 v[196:199], v[36:39], v[232:235], v[196:199]
    v_mfma_f32_16x16x32_bf16 v[204:207], v[36:39], v[236:239], v[204:207]
    s_waitcnt lgkmcnt(10)
    v_mfma_f32_16x16x32_bf16 v[144:147], v[40:43], v[216:219], v[144:147]
    v_mfma_f32_16x16x32_bf16 v[152:155], v[40:43], v[220:223], v[152:155]
    s_waitcnt lgkmcnt(8)
    s_waitcnt lgkmcnt(0)
    s_barrier
    v_mfma_f32_16x16x32_bf16 v[148:151], v[44:47], v[216:219], v[148:151]
    ds_read_b128 v[208:211], v64 offset:37120
    ds_read_b64_tr_b16 v[32:33], v69 offset:57600
    v_mfma_f32_16x16x32_bf16 v[156:159], v[44:47], v[220:223], v[156:159]
    ds_read_b64_tr_b16 v[34:35], v69 offset:58624
    ds_read_b128 v[212:215], v64 offset:39168
    v_add_u32 v64, 0x12200, v64
    v_mfma_f32_16x16x32_bf16 v[160:163], v[48:51], v[216:219], v[160:163]
    ds_read_b128 v[224:227], v66 offset:37120
    ds_read_b128 v[228:231], v66 offset:39168
    v_add_u32 v66, 0x12200, v66
    v_mfma_f32_16x16x32_bf16 v[168:171], v[48:51], v[220:223], v[168:171]
    ds_read_b64_tr_b16 v[36:37], v69 offset:57608
    ds_read_b64_tr_b16 v[38:39], v69 offset:58632
    v_mfma_f32_16x16x32_bf16 v[164:167], v[52:55], v[216:219], v[164:167]
    ds_read_b64_tr_b16 v[40:41], v70 offset:57600
    v_mfma_f32_16x16x32_bf16 v[172:175], v[52:55], v[220:223], v[172:175]
    ds_read_b64_tr_b16 v[42:43], v70 offset:58624
    v_mfma_f32_16x16x32_bf16 v[176:179], v[56:59], v[216:219], v[176:179]
    ds_read_b64_tr_b16 v[44:45], v70 offset:57608
    v_mfma_f32_16x16x32_bf16 v[184:187], v[56:59], v[220:223], v[184:187]
    ds_read_b64_tr_b16 v[46:47], v70 offset:58632
    v_mfma_f32_16x16x32_bf16 v[180:183], v[60:63], v[216:219], v[180:183]
    ds_read_b64_tr_b16 v[48:49], v71 offset:57600
    v_mfma_f32_16x16x32_bf16 v[188:191], v[60:63], v[220:223], v[188:191]
    s_waitcnt lgkmcnt(10)
    ds_read_b64_tr_b16 v[50:51], v71 offset:58624
    v_mfma_f32_16x16x32_bf16 v[128:131], v[32:35], v[208:211], v[128:131]
    s_waitcnt lgkmcnt(10)
    ds_read_b64_tr_b16 v[52:53], v71 offset:57608
    v_mfma_f32_16x16x32_bf16 v[136:139], v[32:35], v[212:215], v[136:139]
    s_waitcnt lgkmcnt(10)
    ds_read_b64_tr_b16 v[54:55], v71 offset:58632
    v_mfma_f32_16x16x32_bf16 v[192:195], v[32:35], v[224:227], v[192:195]
    s_waitcnt lgkmcnt(10)
    ds_read_b64_tr_b16 v[56:57], v72 offset:57600
    v_mfma_f32_16x16x32_bf16 v[200:203], v[32:35], v[228:231], v[200:203]
    s_waitcnt lgkmcnt(9)
    ds_read_b64_tr_b16 v[58:59], v72 offset:58624
    v_mfma_f32_16x16x32_bf16 v[132:135], v[36:39], v[208:211], v[132:135]
    ds_read_b64_tr_b16 v[60:61], v72 offset:57608
    v_mfma_f32_16x16x32_bf16 v[140:143], v[36:39], v[212:215], v[140:143]
    ds_read_b64_tr_b16 v[62:63], v72 offset:58632
    v_mfma_f32_16x16x32_bf16 v[196:199], v[36:39], v[224:227], v[196:199]
    ds_read_b128 v[216:219], v65 offset:37120
    v_mfma_f32_16x16x32_bf16 v[204:207], v[36:39], v[228:231], v[204:207]
    s_waitcnt lgkmcnt(11)
    ds_read_b64_tr_b16 v[32:33], v69 offset:61696
    v_mfma_f32_16x16x32_bf16 v[144:147], v[40:43], v[208:211], v[144:147]
    ds_read_b64_tr_b16 v[34:35], v69 offset:62720
    v_mfma_f32_16x16x32_bf16 v[152:155], v[40:43], v[212:215], v[152:155]
    s_waitcnt lgkmcnt(11)
    ds_read_b128 v[220:223], v65 offset:39168
    v_add_u32 v65, 0x12200, v65
    v_mfma_f32_16x16x32_bf16 v[148:151], v[44:47], v[208:211], v[148:151]
    ds_read_b128 v[232:235], v67 offset:37120
    v_mfma_f32_16x16x32_bf16 v[156:159], v[44:47], v[212:215], v[156:159]
    s_waitcnt lgkmcnt(11)
    ds_read_b128 v[236:239], v67 offset:39168
    v_add_u32 v67, 0x12200, v67
    v_mfma_f32_16x16x32_bf16 v[160:163], v[48:51], v[208:211], v[160:163]
    ds_read_b64_tr_b16 v[36:37], v69 offset:61704
    v_mfma_f32_16x16x32_bf16 v[168:171], v[48:51], v[212:215], v[168:171]
    s_waitcnt lgkmcnt(11)
    ds_read_b64_tr_b16 v[38:39], v69 offset:62728
    v_add_u32 v69, 0x12200, v69
    v_mfma_f32_16x16x32_bf16 v[164:167], v[52:55], v[208:211], v[164:167]
    ds_read_b64_tr_b16 v[40:41], v70 offset:61696
    v_mfma_f32_16x16x32_bf16 v[172:175], v[52:55], v[212:215], v[172:175]
    s_waitcnt lgkmcnt(11)
    ds_read_b64_tr_b16 v[42:43], v70 offset:62720
    v_mfma_f32_16x16x32_bf16 v[176:179], v[56:59], v[208:211], v[176:179]
    ds_read_b64_tr_b16 v[44:45], v70 offset:61704
    v_mfma_f32_16x16x32_bf16 v[184:187], v[56:59], v[212:215], v[184:187]
    s_waitcnt lgkmcnt(11)
    ds_read_b64_tr_b16 v[46:47], v70 offset:62728
    v_add_u32 v70, 0x12200, v70
    v_mfma_f32_16x16x32_bf16 v[180:183], v[60:63], v[208:211], v[180:183]
    ds_read_b64_tr_b16 v[48:49], v71 offset:61696
    v_mfma_f32_16x16x32_bf16 v[188:191], v[60:63], v[212:215], v[188:191]
    s_waitcnt lgkmcnt(10)
    ds_read_b64_tr_b16 v[50:51], v71 offset:62720
    v_mfma_f32_16x16x32_bf16 v[128:131], v[32:35], v[216:219], v[128:131]
    s_waitcnt lgkmcnt(10)
    ds_read_b64_tr_b16 v[52:53], v71 offset:61704
    v_mfma_f32_16x16x32_bf16 v[136:139], v[32:35], v[220:223], v[136:139]
    s_waitcnt lgkmcnt(10)
    ds_read_b64_tr_b16 v[54:55], v71 offset:62728
    v_add_u32 v71, 0x12200, v71
    v_mfma_f32_16x16x32_bf16 v[192:195], v[32:35], v[232:235], v[192:195]
    s_waitcnt lgkmcnt(10)
    ds_read_b64_tr_b16 v[56:57], v72 offset:61696
    v_mfma_f32_16x16x32_bf16 v[200:203], v[32:35], v[236:239], v[200:203]
    s_waitcnt lgkmcnt(9)
    ds_read_b64_tr_b16 v[58:59], v72 offset:62720
    v_mfma_f32_16x16x32_bf16 v[132:135], v[36:39], v[216:219], v[132:135]
    ds_read_b64_tr_b16 v[60:61], v72 offset:61704
    v_mfma_f32_16x16x32_bf16 v[140:143], v[36:39], v[220:223], v[140:143]
    ds_read_b64_tr_b16 v[62:63], v72 offset:62728
    v_add_u32 v72, 0x12200, v72
    v_mfma_f32_16x16x32_bf16 v[196:199], v[36:39], v[232:235], v[196:199]
    v_mfma_f32_16x16x32_bf16 v[204:207], v[36:39], v[236:239], v[204:207]
    s_waitcnt lgkmcnt(10)
    v_mfma_f32_16x16x32_bf16 v[144:147], v[40:43], v[216:219], v[144:147]
    v_mfma_f32_16x16x32_bf16 v[152:155], v[40:43], v[220:223], v[152:155]
    s_waitcnt lgkmcnt(8)
    s_waitcnt lgkmcnt(0)
    s_barrier
    v_mfma_f32_16x16x32_bf16 v[148:151], v[44:47], v[216:219], v[148:151]
    ds_read_b128 v[208:211], v64
    ds_read_b64_tr_b16 v[32:33], v69 offset:20480
    v_mfma_f32_16x16x32_bf16 v[156:159], v[44:47], v[220:223], v[156:159]
    ds_read_b64_tr_b16 v[34:35], v69 offset:21504
    ds_read_b128 v[212:215], v64 offset:2048
    v_add_u32 v64, 0xfffede00, v64
    v_mfma_f32_16x16x32_bf16 v[160:163], v[48:51], v[216:219], v[160:163]
    ds_read_b128 v[224:227], v66
    ds_read_b128 v[228:231], v66 offset:2048
    v_add_u32 v66, 0xfffede00, v66
    v_mfma_f32_16x16x32_bf16 v[168:171], v[48:51], v[220:223], v[168:171]
    ds_read_b64_tr_b16 v[36:37], v69 offset:20488
    ds_read_b64_tr_b16 v[38:39], v69 offset:21512
    v_mfma_f32_16x16x32_bf16 v[164:167], v[52:55], v[216:219], v[164:167]
    ds_read_b64_tr_b16 v[40:41], v70 offset:20480
    v_mfma_f32_16x16x32_bf16 v[172:175], v[52:55], v[220:223], v[172:175]
    ds_read_b64_tr_b16 v[42:43], v70 offset:21504
    v_mfma_f32_16x16x32_bf16 v[176:179], v[56:59], v[216:219], v[176:179]
    ds_read_b64_tr_b16 v[44:45], v70 offset:20488
    v_mfma_f32_16x16x32_bf16 v[184:187], v[56:59], v[220:223], v[184:187]
    ds_read_b64_tr_b16 v[46:47], v70 offset:21512
    v_mfma_f32_16x16x32_bf16 v[180:183], v[60:63], v[216:219], v[180:183]
    ds_read_b64_tr_b16 v[48:49], v71 offset:20480
    v_mfma_f32_16x16x32_bf16 v[188:191], v[60:63], v[220:223], v[188:191]
    s_waitcnt lgkmcnt(10)
    ds_read_b64_tr_b16 v[50:51], v71 offset:21504
    v_mfma_f32_16x16x32_bf16 v[128:131], v[32:35], v[208:211], v[128:131]
    s_waitcnt lgkmcnt(10)
    ds_read_b64_tr_b16 v[52:53], v71 offset:20488
    v_mfma_f32_16x16x32_bf16 v[136:139], v[32:35], v[212:215], v[136:139]
    s_waitcnt lgkmcnt(10)
    ds_read_b64_tr_b16 v[54:55], v71 offset:21512
    v_mfma_f32_16x16x32_bf16 v[192:195], v[32:35], v[224:227], v[192:195]
    s_waitcnt lgkmcnt(10)
    ds_read_b64_tr_b16 v[56:57], v72 offset:20480
    v_mfma_f32_16x16x32_bf16 v[200:203], v[32:35], v[228:231], v[200:203]
    s_waitcnt lgkmcnt(9)
    ds_read_b64_tr_b16 v[58:59], v72 offset:21504
    v_mfma_f32_16x16x32_bf16 v[132:135], v[36:39], v[208:211], v[132:135]
    ds_read_b64_tr_b16 v[60:61], v72 offset:20488
    v_mfma_f32_16x16x32_bf16 v[140:143], v[36:39], v[212:215], v[140:143]
    ds_read_b64_tr_b16 v[62:63], v72 offset:21512
    v_mfma_f32_16x16x32_bf16 v[196:199], v[36:39], v[224:227], v[196:199]
    ds_read_b128 v[216:219], v65
    v_mfma_f32_16x16x32_bf16 v[204:207], v[36:39], v[228:231], v[204:207]
    s_waitcnt lgkmcnt(11)
    ds_read_b64_tr_b16 v[32:33], v69 offset:24576
    v_mfma_f32_16x16x32_bf16 v[144:147], v[40:43], v[208:211], v[144:147]
    ds_read_b64_tr_b16 v[34:35], v69 offset:25600
    v_mfma_f32_16x16x32_bf16 v[152:155], v[40:43], v[212:215], v[152:155]
    s_waitcnt lgkmcnt(11)
    ds_read_b128 v[220:223], v65 offset:2048
    v_add_u32 v65, 0xfffede00, v65
    v_mfma_f32_16x16x32_bf16 v[148:151], v[44:47], v[208:211], v[148:151]
    ds_read_b128 v[232:235], v67
    v_mfma_f32_16x16x32_bf16 v[156:159], v[44:47], v[212:215], v[156:159]
    s_waitcnt lgkmcnt(11)
    ds_read_b128 v[236:239], v67 offset:2048
    v_add_u32 v67, 0xfffede00, v67
    v_mfma_f32_16x16x32_bf16 v[160:163], v[48:51], v[208:211], v[160:163]
    ds_read_b64_tr_b16 v[36:37], v69 offset:24584
    v_mfma_f32_16x16x32_bf16 v[168:171], v[48:51], v[212:215], v[168:171]
    s_waitcnt lgkmcnt(11)
    ds_read_b64_tr_b16 v[38:39], v69 offset:25608
    v_add_u32 v69, 0xfffede00, v69
    v_mfma_f32_16x16x32_bf16 v[164:167], v[52:55], v[208:211], v[164:167]
    ds_read_b64_tr_b16 v[40:41], v70 offset:24576
    v_mfma_f32_16x16x32_bf16 v[172:175], v[52:55], v[212:215], v[172:175]
    s_waitcnt lgkmcnt(11)
    ds_read_b64_tr_b16 v[42:43], v70 offset:25600
    v_mfma_f32_16x16x32_bf16 v[176:179], v[56:59], v[208:211], v[176:179]
    ds_read_b64_tr_b16 v[44:45], v70 offset:24584
    v_mfma_f32_16x16x32_bf16 v[184:187], v[56:59], v[212:215], v[184:187]
    s_waitcnt lgkmcnt(11)
    ds_read_b64_tr_b16 v[46:47], v70 offset:25608
    v_add_u32 v70, 0xfffede00, v70
    v_mfma_f32_16x16x32_bf16 v[180:183], v[60:63], v[208:211], v[180:183]
    ds_read_b64_tr_b16 v[48:49], v71 offset:24576
    v_mfma_f32_16x16x32_bf16 v[188:191], v[60:63], v[212:215], v[188:191]
    s_waitcnt lgkmcnt(10)
    ds_read_b64_tr_b16 v[50:51], v71 offset:25600
    v_mfma_f32_16x16x32_bf16 v[128:131], v[32:35], v[216:219], v[128:131]
    s_waitcnt lgkmcnt(10)
    ds_read_b64_tr_b16 v[52:53], v71 offset:24584
    v_mfma_f32_16x16x32_bf16 v[136:139], v[32:35], v[220:223], v[136:139]
    s_waitcnt lgkmcnt(10)
    ds_read_b64_tr_b16 v[54:55], v71 offset:25608
    v_add_u32 v71, 0xfffede00, v71
    v_mfma_f32_16x16x32_bf16 v[192:195], v[32:35], v[232:235], v[192:195]
    s_waitcnt lgkmcnt(10)
    ds_read_b64_tr_b16 v[56:57], v72 offset:24576
    v_mfma_f32_16x16x32_bf16 v[200:203], v[32:35], v[236:239], v[200:203]
    s_waitcnt lgkmcnt(9)
    ds_read_b64_tr_b16 v[58:59], v72 offset:25600
    v_mfma_f32_16x16x32_bf16 v[132:135], v[36:39], v[216:219], v[132:135]
    ds_read_b64_tr_b16 v[60:61], v72 offset:24584
    v_mfma_f32_16x16x32_bf16 v[140:143], v[36:39], v[220:223], v[140:143]
    ds_read_b64_tr_b16 v[62:63], v72 offset:25608
    v_add_u32 v72, 0xfffede00, v72
    v_mfma_f32_16x16x32_bf16 v[196:199], v[36:39], v[232:235], v[196:199]
    v_mfma_f32_16x16x32_bf16 v[204:207], v[36:39], v[236:239], v[204:207]
    s_waitcnt lgkmcnt(10)
    v_mfma_f32_16x16x32_bf16 v[144:147], v[40:43], v[216:219], v[144:147]
    v_mfma_f32_16x16x32_bf16 v[152:155], v[40:43], v[220:223], v[152:155]
    s_waitcnt lgkmcnt(8)
    s_waitcnt lgkmcnt(0)
    s_barrier
    v_mfma_f32_16x16x32_bf16 v[148:151], v[44:47], v[216:219], v[148:151]
    ds_read_b128 v[208:211], v64
    ds_read_b64_tr_b16 v[32:33], v69 offset:20480
    v_mfma_f32_16x16x32_bf16 v[156:159], v[44:47], v[220:223], v[156:159]
    ds_read_b64_tr_b16 v[34:35], v69 offset:21504
    ds_read_b128 v[212:215], v64 offset:2048
    v_mfma_f32_16x16x32_bf16 v[160:163], v[48:51], v[216:219], v[160:163]
    ds_read_b128 v[224:227], v66
    ds_read_b128 v[228:231], v66 offset:2048
    v_mfma_f32_16x16x32_bf16 v[168:171], v[48:51], v[220:223], v[168:171]
    ds_read_b64_tr_b16 v[36:37], v69 offset:20488
    ds_read_b64_tr_b16 v[38:39], v69 offset:21512
    v_mfma_f32_16x16x32_bf16 v[164:167], v[52:55], v[216:219], v[164:167]
    ds_read_b64_tr_b16 v[40:41], v70 offset:20480
    v_mfma_f32_16x16x32_bf16 v[172:175], v[52:55], v[220:223], v[172:175]
    ds_read_b64_tr_b16 v[42:43], v70 offset:21504
    v_mfma_f32_16x16x32_bf16 v[176:179], v[56:59], v[216:219], v[176:179]
    ds_read_b64_tr_b16 v[44:45], v70 offset:20488
    v_mfma_f32_16x16x32_bf16 v[184:187], v[56:59], v[220:223], v[184:187]
    ds_read_b64_tr_b16 v[46:47], v70 offset:21512
    v_mfma_f32_16x16x32_bf16 v[180:183], v[60:63], v[216:219], v[180:183]
    ds_read_b64_tr_b16 v[48:49], v71 offset:20480
    v_mfma_f32_16x16x32_bf16 v[188:191], v[60:63], v[220:223], v[188:191]
    s_waitcnt lgkmcnt(10)
    ds_read_b64_tr_b16 v[50:51], v71 offset:21504
    v_mfma_f32_16x16x32_bf16 v[128:131], v[32:35], v[208:211], v[128:131]
    s_waitcnt lgkmcnt(10)
    ds_read_b64_tr_b16 v[52:53], v71 offset:20488
    v_mfma_f32_16x16x32_bf16 v[136:139], v[32:35], v[212:215], v[136:139]
    s_waitcnt lgkmcnt(10)
    ds_read_b64_tr_b16 v[54:55], v71 offset:21512
    v_mfma_f32_16x16x32_bf16 v[192:195], v[32:35], v[224:227], v[192:195]
    s_waitcnt lgkmcnt(10)
    ds_read_b64_tr_b16 v[56:57], v72 offset:20480
    v_mfma_f32_16x16x32_bf16 v[200:203], v[32:35], v[228:231], v[200:203]
    s_waitcnt lgkmcnt(9)
    ds_read_b64_tr_b16 v[58:59], v72 offset:21504
    v_mfma_f32_16x16x32_bf16 v[132:135], v[36:39], v[208:211], v[132:135]
    ds_read_b64_tr_b16 v[60:61], v72 offset:20488
    v_mfma_f32_16x16x32_bf16 v[140:143], v[36:39], v[212:215], v[140:143]
    ds_read_b64_tr_b16 v[62:63], v72 offset:21512
    v_mfma_f32_16x16x32_bf16 v[196:199], v[36:39], v[224:227], v[196:199]
    ds_read_b128 v[216:219], v65
    v_mfma_f32_16x16x32_bf16 v[204:207], v[36:39], v[228:231], v[204:207]
    s_waitcnt lgkmcnt(11)
    ds_read_b64_tr_b16 v[32:33], v69 offset:24576
    v_mfma_f32_16x16x32_bf16 v[144:147], v[40:43], v[208:211], v[144:147]
    ds_read_b64_tr_b16 v[34:35], v69 offset:25600
    v_mfma_f32_16x16x32_bf16 v[152:155], v[40:43], v[212:215], v[152:155]
    s_waitcnt lgkmcnt(11)
    ds_read_b128 v[220:223], v65 offset:2048
    v_mfma_f32_16x16x32_bf16 v[148:151], v[44:47], v[208:211], v[148:151]
    ds_read_b128 v[232:235], v67
    v_mfma_f32_16x16x32_bf16 v[156:159], v[44:47], v[212:215], v[156:159]
    s_waitcnt lgkmcnt(11)
    ds_read_b128 v[236:239], v67 offset:2048
    v_mfma_f32_16x16x32_bf16 v[160:163], v[48:51], v[208:211], v[160:163]
    ds_read_b64_tr_b16 v[36:37], v69 offset:24584
    v_mfma_f32_16x16x32_bf16 v[168:171], v[48:51], v[212:215], v[168:171]
    s_waitcnt lgkmcnt(11)
    ds_read_b64_tr_b16 v[38:39], v69 offset:25608
    v_mfma_f32_16x16x32_bf16 v[164:167], v[52:55], v[208:211], v[164:167]
    ds_read_b64_tr_b16 v[40:41], v70 offset:24576
    v_mfma_f32_16x16x32_bf16 v[172:175], v[52:55], v[212:215], v[172:175]
    s_waitcnt lgkmcnt(11)
    ds_read_b64_tr_b16 v[42:43], v70 offset:25600
    v_mfma_f32_16x16x32_bf16 v[176:179], v[56:59], v[208:211], v[176:179]
    ds_read_b64_tr_b16 v[44:45], v70 offset:24584
    v_mfma_f32_16x16x32_bf16 v[184:187], v[56:59], v[212:215], v[184:187]
    s_waitcnt lgkmcnt(11)
    ds_read_b64_tr_b16 v[46:47], v70 offset:25608
    v_mfma_f32_16x16x32_bf16 v[180:183], v[60:63], v[208:211], v[180:183]
    ds_read_b64_tr_b16 v[48:49], v71 offset:24576
    v_mfma_f32_16x16x32_bf16 v[188:191], v[60:63], v[212:215], v[188:191]
    s_waitcnt lgkmcnt(10)
    ds_read_b64_tr_b16 v[50:51], v71 offset:25600
    v_mfma_f32_16x16x32_bf16 v[128:131], v[32:35], v[216:219], v[128:131]
    s_waitcnt lgkmcnt(10)
    ds_read_b64_tr_b16 v[52:53], v71 offset:24584
    v_mfma_f32_16x16x32_bf16 v[136:139], v[32:35], v[220:223], v[136:139]
    s_waitcnt lgkmcnt(10)
    ds_read_b64_tr_b16 v[54:55], v71 offset:25608
    v_mfma_f32_16x16x32_bf16 v[192:195], v[32:35], v[232:235], v[192:195]
    s_waitcnt lgkmcnt(10)
    ds_read_b64_tr_b16 v[56:57], v72 offset:24576
    v_mfma_f32_16x16x32_bf16 v[200:203], v[32:35], v[236:239], v[200:203]
    s_waitcnt lgkmcnt(9)
    ds_read_b64_tr_b16 v[58:59], v72 offset:25600
    v_mfma_f32_16x16x32_bf16 v[132:135], v[36:39], v[216:219], v[132:135]
    ds_read_b64_tr_b16 v[60:61], v72 offset:24584
    v_mfma_f32_16x16x32_bf16 v[140:143], v[36:39], v[220:223], v[140:143]
    ds_read_b64_tr_b16 v[62:63], v72 offset:25608
    v_mfma_f32_16x16x32_bf16 v[196:199], v[36:39], v[232:235], v[196:199]
    v_mfma_f32_16x16x32_bf16 v[204:207], v[36:39], v[236:239], v[204:207]
    s_waitcnt lgkmcnt(10)
    v_mfma_f32_16x16x32_bf16 v[144:147], v[40:43], v[216:219], v[144:147]
    v_mfma_f32_16x16x32_bf16 v[152:155], v[40:43], v[220:223], v[152:155]
    s_waitcnt lgkmcnt(8)
    s_waitcnt lgkmcnt(0)
    s_barrier
    v_mfma_f32_16x16x32_bf16 v[148:151], v[44:47], v[216:219], v[148:151]
    ds_read_b128 v[208:211], v64 offset:37120
    ds_read_b64_tr_b16 v[32:33], v69 offset:57600
    v_mfma_f32_16x16x32_bf16 v[156:159], v[44:47], v[220:223], v[156:159]
    ds_read_b64_tr_b16 v[34:35], v69 offset:58624
    ds_read_b128 v[212:215], v64 offset:39168
    v_add_u32 v64, 0x12200, v64
    v_mfma_f32_16x16x32_bf16 v[160:163], v[48:51], v[216:219], v[160:163]
    ds_read_b128 v[224:227], v66 offset:37120
    ds_read_b128 v[228:231], v66 offset:39168
    v_add_u32 v66, 0x12200, v66
    v_mfma_f32_16x16x32_bf16 v[168:171], v[48:51], v[220:223], v[168:171]
    ds_read_b64_tr_b16 v[36:37], v69 offset:57608
    ds_read_b64_tr_b16 v[38:39], v69 offset:58632
    v_mfma_f32_16x16x32_bf16 v[164:167], v[52:55], v[216:219], v[164:167]
    ds_read_b64_tr_b16 v[40:41], v70 offset:57600
    v_mfma_f32_16x16x32_bf16 v[172:175], v[52:55], v[220:223], v[172:175]
    ds_read_b64_tr_b16 v[42:43], v70 offset:58624
    v_mfma_f32_16x16x32_bf16 v[176:179], v[56:59], v[216:219], v[176:179]
    ds_read_b64_tr_b16 v[44:45], v70 offset:57608
    v_mfma_f32_16x16x32_bf16 v[184:187], v[56:59], v[220:223], v[184:187]
    ds_read_b64_tr_b16 v[46:47], v70 offset:58632
    v_mfma_f32_16x16x32_bf16 v[180:183], v[60:63], v[216:219], v[180:183]
    ds_read_b64_tr_b16 v[48:49], v71 offset:57600
    v_mfma_f32_16x16x32_bf16 v[188:191], v[60:63], v[220:223], v[188:191]
    s_waitcnt lgkmcnt(10)
    ds_read_b64_tr_b16 v[50:51], v71 offset:58624
    v_mfma_f32_16x16x32_bf16 v[128:131], v[32:35], v[208:211], v[128:131]
    s_waitcnt lgkmcnt(10)
    ds_read_b64_tr_b16 v[52:53], v71 offset:57608
    v_mfma_f32_16x16x32_bf16 v[136:139], v[32:35], v[212:215], v[136:139]
    s_waitcnt lgkmcnt(10)
    ds_read_b64_tr_b16 v[54:55], v71 offset:58632
    v_mfma_f32_16x16x32_bf16 v[192:195], v[32:35], v[224:227], v[192:195]
    s_waitcnt lgkmcnt(10)
    ds_read_b64_tr_b16 v[56:57], v72 offset:57600
    v_mfma_f32_16x16x32_bf16 v[200:203], v[32:35], v[228:231], v[200:203]
    s_waitcnt lgkmcnt(9)
    ds_read_b64_tr_b16 v[58:59], v72 offset:58624
    v_mfma_f32_16x16x32_bf16 v[132:135], v[36:39], v[208:211], v[132:135]
    ds_read_b64_tr_b16 v[60:61], v72 offset:57608
    v_mfma_f32_16x16x32_bf16 v[140:143], v[36:39], v[212:215], v[140:143]
    ds_read_b64_tr_b16 v[62:63], v72 offset:58632
    v_mfma_f32_16x16x32_bf16 v[196:199], v[36:39], v[224:227], v[196:199]
    ds_read_b128 v[216:219], v65 offset:37120
    v_mfma_f32_16x16x32_bf16 v[204:207], v[36:39], v[228:231], v[204:207]
    s_waitcnt lgkmcnt(11)
    ds_read_b64_tr_b16 v[32:33], v69 offset:61696
    v_mfma_f32_16x16x32_bf16 v[144:147], v[40:43], v[208:211], v[144:147]
    ds_read_b64_tr_b16 v[34:35], v69 offset:62720
    v_mfma_f32_16x16x32_bf16 v[152:155], v[40:43], v[212:215], v[152:155]
    s_waitcnt lgkmcnt(11)
    ds_read_b128 v[220:223], v65 offset:39168
    v_add_u32 v65, 0x12200, v65
    v_mfma_f32_16x16x32_bf16 v[148:151], v[44:47], v[208:211], v[148:151]
    ds_read_b128 v[232:235], v67 offset:37120
    v_mfma_f32_16x16x32_bf16 v[156:159], v[44:47], v[212:215], v[156:159]
    s_waitcnt lgkmcnt(11)
    ds_read_b128 v[236:239], v67 offset:39168
    v_add_u32 v67, 0x12200, v67
    v_mfma_f32_16x16x32_bf16 v[160:163], v[48:51], v[208:211], v[160:163]
    ds_read_b64_tr_b16 v[36:37], v69 offset:61704
    v_mfma_f32_16x16x32_bf16 v[168:171], v[48:51], v[212:215], v[168:171]
    s_waitcnt lgkmcnt(11)
    ds_read_b64_tr_b16 v[38:39], v69 offset:62728
    v_add_u32 v69, 0x12200, v69
    v_mfma_f32_16x16x32_bf16 v[164:167], v[52:55], v[208:211], v[164:167]
    ds_read_b64_tr_b16 v[40:41], v70 offset:61696
    v_mfma_f32_16x16x32_bf16 v[172:175], v[52:55], v[212:215], v[172:175]
    s_waitcnt lgkmcnt(11)
    ds_read_b64_tr_b16 v[42:43], v70 offset:62720
    v_mfma_f32_16x16x32_bf16 v[176:179], v[56:59], v[208:211], v[176:179]
    ds_read_b64_tr_b16 v[44:45], v70 offset:61704
    v_mfma_f32_16x16x32_bf16 v[184:187], v[56:59], v[212:215], v[184:187]
    s_waitcnt lgkmcnt(11)
    ds_read_b64_tr_b16 v[46:47], v70 offset:62728
    v_add_u32 v70, 0x12200, v70
    v_mfma_f32_16x16x32_bf16 v[180:183], v[60:63], v[208:211], v[180:183]
    ds_read_b64_tr_b16 v[48:49], v71 offset:61696
    v_mfma_f32_16x16x32_bf16 v[188:191], v[60:63], v[212:215], v[188:191]
    s_waitcnt lgkmcnt(10)
    ds_read_b64_tr_b16 v[50:51], v71 offset:62720
    v_mfma_f32_16x16x32_bf16 v[128:131], v[32:35], v[216:219], v[128:131]
    s_waitcnt lgkmcnt(10)
    ds_read_b64_tr_b16 v[52:53], v71 offset:61704
    v_mfma_f32_16x16x32_bf16 v[136:139], v[32:35], v[220:223], v[136:139]
    s_waitcnt lgkmcnt(10)
    ds_read_b64_tr_b16 v[54:55], v71 offset:62728
    v_add_u32 v71, 0x12200, v71
    v_mfma_f32_16x16x32_bf16 v[192:195], v[32:35], v[232:235], v[192:195]
    s_waitcnt lgkmcnt(10)
    ds_read_b64_tr_b16 v[56:57], v72 offset:61696
    v_mfma_f32_16x16x32_bf16 v[200:203], v[32:35], v[236:239], v[200:203]
    s_waitcnt lgkmcnt(9)
    ds_read_b64_tr_b16 v[58:59], v72 offset:62720
    v_mfma_f32_16x16x32_bf16 v[132:135], v[36:39], v[216:219], v[132:135]
    ds_read_b64_tr_b16 v[60:61], v72 offset:61704
    v_mfma_f32_16x16x32_bf16 v[140:143], v[36:39], v[220:223], v[140:143]
    ds_read_b64_tr_b16 v[62:63], v72 offset:62728
    v_add_u32 v72, 0x12200, v72
    v_mfma_f32_16x16x32_bf16 v[196:199], v[36:39], v[232:235], v[196:199]
    v_mfma_f32_16x16x32_bf16 v[204:207], v[36:39], v[236:239], v[204:207]
    s_waitcnt lgkmcnt(10)
    v_mfma_f32_16x16x32_bf16 v[144:147], v[40:43], v[216:219], v[144:147]
    v_mfma_f32_16x16x32_bf16 v[152:155], v[40:43], v[220:223], v[152:155]
    s_waitcnt lgkmcnt(8)
    s_waitcnt lgkmcnt(0)
    s_barrier
    v_mfma_f32_16x16x32_bf16 v[148:151], v[44:47], v[216:219], v[148:151]
    ds_read_b128 v[208:211], v64
    ds_read_b64_tr_b16 v[32:33], v69 offset:20480
    v_mfma_f32_16x16x32_bf16 v[156:159], v[44:47], v[220:223], v[156:159]
    ds_read_b64_tr_b16 v[34:35], v69 offset:21504
    ds_read_b128 v[212:215], v64 offset:2048
    v_add_u32 v64, 0xfffede00, v64
    v_mfma_f32_16x16x32_bf16 v[160:163], v[48:51], v[216:219], v[160:163]
    ds_read_b128 v[224:227], v66
    ds_read_b128 v[228:231], v66 offset:2048
    v_add_u32 v66, 0xfffede00, v66
    v_mfma_f32_16x16x32_bf16 v[168:171], v[48:51], v[220:223], v[168:171]
    ds_read_b64_tr_b16 v[36:37], v69 offset:20488
    ds_read_b64_tr_b16 v[38:39], v69 offset:21512
    v_mfma_f32_16x16x32_bf16 v[164:167], v[52:55], v[216:219], v[164:167]
    ds_read_b64_tr_b16 v[40:41], v70 offset:20480
    v_mfma_f32_16x16x32_bf16 v[172:175], v[52:55], v[220:223], v[172:175]
    ds_read_b64_tr_b16 v[42:43], v70 offset:21504
    v_mfma_f32_16x16x32_bf16 v[176:179], v[56:59], v[216:219], v[176:179]
    ds_read_b64_tr_b16 v[44:45], v70 offset:20488
    v_mfma_f32_16x16x32_bf16 v[184:187], v[56:59], v[220:223], v[184:187]
    ds_read_b64_tr_b16 v[46:47], v70 offset:21512
    v_mfma_f32_16x16x32_bf16 v[180:183], v[60:63], v[216:219], v[180:183]
    ds_read_b64_tr_b16 v[48:49], v71 offset:20480
    v_mfma_f32_16x16x32_bf16 v[188:191], v[60:63], v[220:223], v[188:191]
    s_waitcnt lgkmcnt(10)
    ds_read_b64_tr_b16 v[50:51], v71 offset:21504
    v_mfma_f32_16x16x32_bf16 v[128:131], v[32:35], v[208:211], v[128:131]
    s_waitcnt lgkmcnt(10)
    ds_read_b64_tr_b16 v[52:53], v71 offset:20488
    v_mfma_f32_16x16x32_bf16 v[136:139], v[32:35], v[212:215], v[136:139]
    s_waitcnt lgkmcnt(10)
    ds_read_b64_tr_b16 v[54:55], v71 offset:21512
    v_mfma_f32_16x16x32_bf16 v[192:195], v[32:35], v[224:227], v[192:195]
    s_waitcnt lgkmcnt(10)
    ds_read_b64_tr_b16 v[56:57], v72 offset:20480
    v_mfma_f32_16x16x32_bf16 v[200:203], v[32:35], v[228:231], v[200:203]
    s_waitcnt lgkmcnt(9)
    ds_read_b64_tr_b16 v[58:59], v72 offset:21504
    v_mfma_f32_16x16x32_bf16 v[132:135], v[36:39], v[208:211], v[132:135]
    ds_read_b64_tr_b16 v[60:61], v72 offset:20488
    v_mfma_f32_16x16x32_bf16 v[140:143], v[36:39], v[212:215], v[140:143]
    ds_read_b64_tr_b16 v[62:63], v72 offset:21512
    v_mfma_f32_16x16x32_bf16 v[196:199], v[36:39], v[224:227], v[196:199]
    ds_read_b128 v[216:219], v65
    v_mfma_f32_16x16x32_bf16 v[204:207], v[36:39], v[228:231], v[204:207]
    s_waitcnt lgkmcnt(11)
    ds_read_b64_tr_b16 v[32:33], v69 offset:24576
    v_mfma_f32_16x16x32_bf16 v[144:147], v[40:43], v[208:211], v[144:147]
    ds_read_b64_tr_b16 v[34:35], v69 offset:25600
    v_mfma_f32_16x16x32_bf16 v[152:155], v[40:43], v[212:215], v[152:155]
    s_waitcnt lgkmcnt(11)
    ds_read_b128 v[220:223], v65 offset:2048
    v_add_u32 v65, 0xfffede00, v65
    v_mfma_f32_16x16x32_bf16 v[148:151], v[44:47], v[208:211], v[148:151]
    ds_read_b128 v[232:235], v67
    v_mfma_f32_16x16x32_bf16 v[156:159], v[44:47], v[212:215], v[156:159]
    s_waitcnt lgkmcnt(11)
    ds_read_b128 v[236:239], v67 offset:2048
    v_add_u32 v67, 0xfffede00, v67
    v_mfma_f32_16x16x32_bf16 v[160:163], v[48:51], v[208:211], v[160:163]
    ds_read_b64_tr_b16 v[36:37], v69 offset:24584
    v_mfma_f32_16x16x32_bf16 v[168:171], v[48:51], v[212:215], v[168:171]
    s_waitcnt lgkmcnt(11)
    ds_read_b64_tr_b16 v[38:39], v69 offset:25608
    v_add_u32 v69, 0xfffede00, v69
    v_mfma_f32_16x16x32_bf16 v[164:167], v[52:55], v[208:211], v[164:167]
    ds_read_b64_tr_b16 v[40:41], v70 offset:24576
    v_mfma_f32_16x16x32_bf16 v[172:175], v[52:55], v[212:215], v[172:175]
    s_waitcnt lgkmcnt(11)
    ds_read_b64_tr_b16 v[42:43], v70 offset:25600
    v_mfma_f32_16x16x32_bf16 v[176:179], v[56:59], v[208:211], v[176:179]
    ds_read_b64_tr_b16 v[44:45], v70 offset:24584
    v_mfma_f32_16x16x32_bf16 v[184:187], v[56:59], v[212:215], v[184:187]
    s_waitcnt lgkmcnt(11)
    ds_read_b64_tr_b16 v[46:47], v70 offset:25608
    v_add_u32 v70, 0xfffede00, v70
    v_mfma_f32_16x16x32_bf16 v[180:183], v[60:63], v[208:211], v[180:183]
    ds_read_b64_tr_b16 v[48:49], v71 offset:24576
    v_mfma_f32_16x16x32_bf16 v[188:191], v[60:63], v[212:215], v[188:191]
    s_waitcnt lgkmcnt(10)
    ds_read_b64_tr_b16 v[50:51], v71 offset:25600
    v_mfma_f32_16x16x32_bf16 v[128:131], v[32:35], v[216:219], v[128:131]
    s_waitcnt lgkmcnt(10)
    ds_read_b64_tr_b16 v[52:53], v71 offset:24584
    v_mfma_f32_16x16x32_bf16 v[136:139], v[32:35], v[220:223], v[136:139]
    s_waitcnt lgkmcnt(10)
    ds_read_b64_tr_b16 v[54:55], v71 offset:25608
    v_add_u32 v71, 0xfffede00, v71
    v_mfma_f32_16x16x32_bf16 v[192:195], v[32:35], v[232:235], v[192:195]
    s_waitcnt lgkmcnt(10)
    ds_read_b64_tr_b16 v[56:57], v72 offset:24576
    v_mfma_f32_16x16x32_bf16 v[200:203], v[32:35], v[236:239], v[200:203]
    s_waitcnt lgkmcnt(9)
    ds_read_b64_tr_b16 v[58:59], v72 offset:25600
    v_mfma_f32_16x16x32_bf16 v[132:135], v[36:39], v[216:219], v[132:135]
    ds_read_b64_tr_b16 v[60:61], v72 offset:24584
    v_mfma_f32_16x16x32_bf16 v[140:143], v[36:39], v[220:223], v[140:143]
    ds_read_b64_tr_b16 v[62:63], v72 offset:25608
    v_add_u32 v72, 0xfffede00, v72
    v_mfma_f32_16x16x32_bf16 v[196:199], v[36:39], v[232:235], v[196:199]
    v_mfma_f32_16x16x32_bf16 v[204:207], v[36:39], v[236:239], v[204:207]
    s_waitcnt lgkmcnt(10)
    v_mfma_f32_16x16x32_bf16 v[144:147], v[40:43], v[216:219], v[144:147]
    v_mfma_f32_16x16x32_bf16 v[152:155], v[40:43], v[220:223], v[152:155]
    s_waitcnt lgkmcnt(8)
    s_waitcnt lgkmcnt(0)
    s_barrier
    v_mfma_f32_16x16x32_bf16 v[148:151], v[44:47], v[216:219], v[148:151]
    ds_read_b128 v[208:211], v64
    ds_read_b64_tr_b16 v[32:33], v69 offset:20480
    v_mfma_f32_16x16x32_bf16 v[156:159], v[44:47], v[220:223], v[156:159]
    ds_read_b64_tr_b16 v[34:35], v69 offset:21504
    ds_read_b128 v[212:215], v64 offset:2048
    v_mfma_f32_16x16x32_bf16 v[160:163], v[48:51], v[216:219], v[160:163]
    ds_read_b128 v[224:227], v66
    ds_read_b128 v[228:231], v66 offset:2048
    v_mfma_f32_16x16x32_bf16 v[168:171], v[48:51], v[220:223], v[168:171]
    ds_read_b64_tr_b16 v[36:37], v69 offset:20488
    ds_read_b64_tr_b16 v[38:39], v69 offset:21512
    v_mfma_f32_16x16x32_bf16 v[164:167], v[52:55], v[216:219], v[164:167]
    ds_read_b64_tr_b16 v[40:41], v70 offset:20480
    v_mfma_f32_16x16x32_bf16 v[172:175], v[52:55], v[220:223], v[172:175]
    ds_read_b64_tr_b16 v[42:43], v70 offset:21504
    v_mfma_f32_16x16x32_bf16 v[176:179], v[56:59], v[216:219], v[176:179]
    ds_read_b64_tr_b16 v[44:45], v70 offset:20488
    v_mfma_f32_16x16x32_bf16 v[184:187], v[56:59], v[220:223], v[184:187]
    ds_read_b64_tr_b16 v[46:47], v70 offset:21512
    v_mfma_f32_16x16x32_bf16 v[180:183], v[60:63], v[216:219], v[180:183]
    ds_read_b64_tr_b16 v[48:49], v71 offset:20480
    v_mfma_f32_16x16x32_bf16 v[188:191], v[60:63], v[220:223], v[188:191]
    s_waitcnt lgkmcnt(10)
    ds_read_b64_tr_b16 v[50:51], v71 offset:21504
    v_mfma_f32_16x16x32_bf16 v[128:131], v[32:35], v[208:211], v[128:131]
    s_waitcnt lgkmcnt(10)
    ds_read_b64_tr_b16 v[52:53], v71 offset:20488
    v_mfma_f32_16x16x32_bf16 v[136:139], v[32:35], v[212:215], v[136:139]
    s_waitcnt lgkmcnt(10)
    ds_read_b64_tr_b16 v[54:55], v71 offset:21512
    v_mfma_f32_16x16x32_bf16 v[192:195], v[32:35], v[224:227], v[192:195]
    s_waitcnt lgkmcnt(10)
    ds_read_b64_tr_b16 v[56:57], v72 offset:20480
    v_mfma_f32_16x16x32_bf16 v[200:203], v[32:35], v[228:231], v[200:203]
    s_waitcnt lgkmcnt(9)
    ds_read_b64_tr_b16 v[58:59], v72 offset:21504
    v_mfma_f32_16x16x32_bf16 v[132:135], v[36:39], v[208:211], v[132:135]
    ds_read_b64_tr_b16 v[60:61], v72 offset:20488
    v_mfma_f32_16x16x32_bf16 v[140:143], v[36:39], v[212:215], v[140:143]
    ds_read_b64_tr_b16 v[62:63], v72 offset:21512
    v_mfma_f32_16x16x32_bf16 v[196:199], v[36:39], v[224:227], v[196:199]
    ds_read_b128 v[216:219], v65
    v_mfma_f32_16x16x32_bf16 v[204:207], v[36:39], v[228:231], v[204:207]
    s_waitcnt lgkmcnt(11)
    ds_read_b64_tr_b16 v[32:33], v69 offset:24576
    v_mfma_f32_16x16x32_bf16 v[144:147], v[40:43], v[208:211], v[144:147]
    ds_read_b64_tr_b16 v[34:35], v69 offset:25600
    v_mfma_f32_16x16x32_bf16 v[152:155], v[40:43], v[212:215], v[152:155]
    s_waitcnt lgkmcnt(11)
    ds_read_b128 v[220:223], v65 offset:2048
    v_mfma_f32_16x16x32_bf16 v[148:151], v[44:47], v[208:211], v[148:151]
    ds_read_b128 v[232:235], v67
    v_mfma_f32_16x16x32_bf16 v[156:159], v[44:47], v[212:215], v[156:159]
    s_waitcnt lgkmcnt(11)
    ds_read_b128 v[236:239], v67 offset:2048
    v_mfma_f32_16x16x32_bf16 v[160:163], v[48:51], v[208:211], v[160:163]
    ds_read_b64_tr_b16 v[36:37], v69 offset:24584
    v_mfma_f32_16x16x32_bf16 v[168:171], v[48:51], v[212:215], v[168:171]
    s_waitcnt lgkmcnt(11)
    ds_read_b64_tr_b16 v[38:39], v69 offset:25608
    v_mfma_f32_16x16x32_bf16 v[164:167], v[52:55], v[208:211], v[164:167]
    ds_read_b64_tr_b16 v[40:41], v70 offset:24576
    v_mfma_f32_16x16x32_bf16 v[172:175], v[52:55], v[212:215], v[172:175]
    s_waitcnt lgkmcnt(11)
    ds_read_b64_tr_b16 v[42:43], v70 offset:25600
    v_mfma_f32_16x16x32_bf16 v[176:179], v[56:59], v[208:211], v[176:179]
    ds_read_b64_tr_b16 v[44:45], v70 offset:24584
    v_mfma_f32_16x16x32_bf16 v[184:187], v[56:59], v[212:215], v[184:187]
    s_waitcnt lgkmcnt(11)
    ds_read_b64_tr_b16 v[46:47], v70 offset:25608
    v_mfma_f32_16x16x32_bf16 v[180:183], v[60:63], v[208:211], v[180:183]
    ds_read_b64_tr_b16 v[48:49], v71 offset:24576
    v_mfma_f32_16x16x32_bf16 v[188:191], v[60:63], v[212:215], v[188:191]
    s_waitcnt lgkmcnt(10)
    ds_read_b64_tr_b16 v[50:51], v71 offset:25600
    v_mfma_f32_16x16x32_bf16 v[128:131], v[32:35], v[216:219], v[128:131]
    s_waitcnt lgkmcnt(10)
    ds_read_b64_tr_b16 v[52:53], v71 offset:24584
    v_mfma_f32_16x16x32_bf16 v[136:139], v[32:35], v[220:223], v[136:139]
    s_waitcnt lgkmcnt(10)
    ds_read_b64_tr_b16 v[54:55], v71 offset:25608
    v_mfma_f32_16x16x32_bf16 v[192:195], v[32:35], v[232:235], v[192:195]
    s_waitcnt lgkmcnt(10)
    ds_read_b64_tr_b16 v[56:57], v72 offset:24576
    v_mfma_f32_16x16x32_bf16 v[200:203], v[32:35], v[236:239], v[200:203]
    s_waitcnt lgkmcnt(9)
    ds_read_b64_tr_b16 v[58:59], v72 offset:25600
    v_mfma_f32_16x16x32_bf16 v[132:135], v[36:39], v[216:219], v[132:135]
    ds_read_b64_tr_b16 v[60:61], v72 offset:24584
    v_mfma_f32_16x16x32_bf16 v[140:143], v[36:39], v[220:223], v[140:143]
    ds_read_b64_tr_b16 v[62:63], v72 offset:25608
    v_mfma_f32_16x16x32_bf16 v[196:199], v[36:39], v[232:235], v[196:199]
    v_mfma_f32_16x16x32_bf16 v[204:207], v[36:39], v[236:239], v[204:207]
    s_waitcnt lgkmcnt(10)
    v_mfma_f32_16x16x32_bf16 v[144:147], v[40:43], v[216:219], v[144:147]
    v_mfma_f32_16x16x32_bf16 v[152:155], v[40:43], v[220:223], v[152:155]
    s_waitcnt lgkmcnt(8)
    s_waitcnt lgkmcnt(0)
    s_barrier
    v_mfma_f32_16x16x32_bf16 v[148:151], v[44:47], v[216:219], v[148:151]
    ds_read_b128 v[208:211], v64 offset:37120
    v_mfma_f32_16x16x32_bf16 v[156:159], v[44:47], v[220:223], v[156:159]
    ds_read_b64_tr_b16 v[32:33], v69 offset:57600
    v_mfma_f32_16x16x32_bf16 v[160:163], v[48:51], v[216:219], v[160:163]
    ds_read_b64_tr_b16 v[34:35], v69 offset:58624
    v_mfma_f32_16x16x32_bf16 v[168:171], v[48:51], v[220:223], v[168:171]
    ds_read_b128 v[212:215], v64 offset:39168
    v_mfma_f32_16x16x32_bf16 v[164:167], v[52:55], v[216:219], v[164:167]
    ds_read_b128 v[224:227], v66 offset:37120
    v_mfma_f32_16x16x32_bf16 v[172:175], v[52:55], v[220:223], v[172:175]
    ds_read_b128 v[228:231], v66 offset:39168
    v_mfma_f32_16x16x32_bf16 v[176:179], v[56:59], v[216:219], v[176:179]
    ds_read_b64_tr_b16 v[36:37], v69 offset:57608
    ds_read_b64_tr_b16 v[38:39], v69 offset:58632
    v_mfma_f32_16x16x32_bf16 v[184:187], v[56:59], v[220:223], v[184:187]
    ds_read_b64_tr_b16 v[40:41], v70 offset:57600
    v_mfma_f32_16x16x32_bf16 v[180:183], v[60:63], v[216:219], v[180:183]
    ds_read_b64_tr_b16 v[42:43], v70 offset:58624
    v_mfma_f32_16x16x32_bf16 v[188:191], v[60:63], v[220:223], v[188:191]
    s_waitcnt lgkmcnt(7)
    ds_read_b64_tr_b16 v[44:45], v70 offset:57608
    v_mfma_f32_16x16x32_bf16 v[128:131], v[32:35], v[208:211], v[128:131]
    s_waitcnt lgkmcnt(7)
    ds_read_b64_tr_b16 v[46:47], v70 offset:58632
    v_mfma_f32_16x16x32_bf16 v[136:139], v[32:35], v[212:215], v[136:139]
    s_waitcnt lgkmcnt(7)
    ds_read_b64_tr_b16 v[48:49], v71 offset:57600
    v_mfma_f32_16x16x32_bf16 v[192:195], v[32:35], v[224:227], v[192:195]
    s_waitcnt lgkmcnt(7)
    ds_read_b64_tr_b16 v[50:51], v71 offset:58624
    v_mfma_f32_16x16x32_bf16 v[200:203], v[32:35], v[228:231], v[200:203]
    s_waitcnt lgkmcnt(6)
    ds_read_b64_tr_b16 v[52:53], v71 offset:57608
    v_mfma_f32_16x16x32_bf16 v[132:135], v[36:39], v[208:211], v[132:135]
    ds_read_b64_tr_b16 v[54:55], v71 offset:58632
    v_mfma_f32_16x16x32_bf16 v[140:143], v[36:39], v[212:215], v[140:143]
    ds_read_b64_tr_b16 v[56:57], v72 offset:57600
    v_mfma_f32_16x16x32_bf16 v[196:199], v[36:39], v[224:227], v[196:199]
    ds_read_b64_tr_b16 v[58:59], v72 offset:58624
    v_mfma_f32_16x16x32_bf16 v[204:207], v[36:39], v[228:231], v[204:207]
    s_waitcnt lgkmcnt(8)
    ds_read_b64_tr_b16 v[60:61], v72 offset:57608
    v_mfma_f32_16x16x32_bf16 v[144:147], v[40:43], v[208:211], v[144:147]
    ds_read_b64_tr_b16 v[62:63], v72 offset:58632
    v_mfma_f32_16x16x32_bf16 v[152:155], v[40:43], v[212:215], v[152:155]
    s_waitcnt lgkmcnt(8)
    ds_read_b128 v[216:219], v65 offset:37120
    v_mfma_f32_16x16x32_bf16 v[148:151], v[44:47], v[208:211], v[148:151]
    ds_read_b64_tr_b16 v[32:33], v69 offset:61696
    v_mfma_f32_16x16x32_bf16 v[156:159], v[44:47], v[212:215], v[156:159]
    s_waitcnt lgkmcnt(8)
    ds_read_b64_tr_b16 v[34:35], v69 offset:62720
    v_mfma_f32_16x16x32_bf16 v[160:163], v[48:51], v[208:211], v[160:163]
    ds_read_b128 v[220:223], v65 offset:39168
    v_mfma_f32_16x16x32_bf16 v[168:171], v[48:51], v[212:215], v[168:171]
    s_waitcnt lgkmcnt(8)
    ds_read_b128 v[232:235], v67 offset:37120
    v_mfma_f32_16x16x32_bf16 v[164:167], v[52:55], v[208:211], v[164:167]
    ds_read_b128 v[236:239], v67 offset:39168
    v_mfma_f32_16x16x32_bf16 v[172:175], v[52:55], v[212:215], v[172:175]
    s_waitcnt lgkmcnt(8)
    ds_read_b64_tr_b16 v[36:37], v69 offset:61704
    v_mfma_f32_16x16x32_bf16 v[176:179], v[56:59], v[208:211], v[176:179]
    ds_read_b64_tr_b16 v[38:39], v69 offset:62728
    v_mfma_f32_16x16x32_bf16 v[184:187], v[56:59], v[212:215], v[184:187]
    s_waitcnt lgkmcnt(8)
    ds_read_b64_tr_b16 v[40:41], v70 offset:61696
    v_mfma_f32_16x16x32_bf16 v[180:183], v[60:63], v[208:211], v[180:183]
    ds_read_b64_tr_b16 v[42:43], v70 offset:62720
    v_mfma_f32_16x16x32_bf16 v[188:191], v[60:63], v[212:215], v[188:191]
    s_waitcnt lgkmcnt(7)
    ds_read_b64_tr_b16 v[44:45], v70 offset:61704
    v_mfma_f32_16x16x32_bf16 v[128:131], v[32:35], v[216:219], v[128:131]
    s_waitcnt lgkmcnt(7)
    ds_read_b64_tr_b16 v[46:47], v70 offset:62728
    v_mfma_f32_16x16x32_bf16 v[136:139], v[32:35], v[220:223], v[136:139]
    s_waitcnt lgkmcnt(7)
    ds_read_b64_tr_b16 v[48:49], v71 offset:61696
    v_mfma_f32_16x16x32_bf16 v[192:195], v[32:35], v[232:235], v[192:195]
    s_waitcnt lgkmcnt(7)
    ds_read_b64_tr_b16 v[50:51], v71 offset:62720
    v_mfma_f32_16x16x32_bf16 v[200:203], v[32:35], v[236:239], v[200:203]
    s_waitcnt lgkmcnt(6)
    ds_read_b64_tr_b16 v[52:53], v71 offset:61704
    v_mfma_f32_16x16x32_bf16 v[132:135], v[36:39], v[216:219], v[132:135]
    ds_read_b64_tr_b16 v[54:55], v71 offset:62728
    v_mfma_f32_16x16x32_bf16 v[140:143], v[36:39], v[220:223], v[140:143]
    ds_read_b64_tr_b16 v[56:57], v72 offset:61696
    v_mfma_f32_16x16x32_bf16 v[196:199], v[36:39], v[232:235], v[196:199]
    ds_read_b64_tr_b16 v[58:59], v72 offset:62720
    s_mov_b32 s6, 0x3e0293ee
    s_mov_b32 s7, 0x3e0293ee
    v_mfma_f32_16x16x32_bf16 v[204:207], v[36:39], v[236:239], v[204:207]
    s_waitcnt lgkmcnt(8)
    ds_read_b64_tr_b16 v[60:61], v72 offset:61704
    v_mfma_f32_16x16x32_bf16 v[144:147], v[40:43], v[216:219], v[144:147]
    ds_read_b64_tr_b16 v[62:63], v72 offset:62728
    v_mfma_f32_16x16x32_bf16 v[152:155], v[40:43], v[220:223], v[152:155]
    s_waitcnt lgkmcnt(8)
    v_mul_f32 v192, s6, v192
    v_mul_f32 v193, s6, v193
    v_mul_f32 v194, s6, v194
    v_mfma_f32_16x16x32_bf16 v[148:151], v[44:47], v[216:219], v[148:151]
    v_mul_f32 v195, s6, v195
    v_mul_f32 v196, s6, v196
    v_mul_f32 v197, s6, v197
    v_mfma_f32_16x16x32_bf16 v[156:159], v[44:47], v[220:223], v[156:159]
    s_waitcnt lgkmcnt(6)
    v_mul_f32 v198, s6, v198
    v_mul_f32 v199, s6, v199
    v_mfma_f32_16x16x32_bf16 v[160:163], v[48:51], v[216:219], v[160:163]
    v_cvt_pk_bf16_f32 v240, v192, v193
    v_cvt_pk_bf16_f32 v241, v194, v195
    v_cvt_pk_bf16_f32 v242, v196, v197
    v_mfma_f32_16x16x32_bf16 v[168:171], v[48:51], v[220:223], v[168:171]
    s_waitcnt lgkmcnt(4)
    v_cvt_pk_bf16_f32 v243, v198, v199
    ds_write_b128 v68, v[240:243] offset:16384
    v_mfma_f32_16x16x32_bf16 v[164:167], v[52:55], v[216:219], v[164:167]
    v_mul_f32 v200, s6, v200
    v_mul_f32 v201, s6, v201
    v_mul_f32 v202, s6, v202
    v_mfma_f32_16x16x32_bf16 v[172:175], v[52:55], v[220:223], v[172:175]
    s_waitcnt lgkmcnt(3)
    v_mul_f32 v203, s6, v203
    v_mul_f32 v204, s6, v204
    v_mul_f32 v205, s6, v205
    v_mfma_f32_16x16x32_bf16 v[176:179], v[56:59], v[216:219], v[176:179]
    v_mul_f32 v206, s6, v206
    v_mul_f32 v207, s6, v207
    v_mfma_f32_16x16x32_bf16 v[184:187], v[56:59], v[220:223], v[184:187]
    s_waitcnt lgkmcnt(1)
    v_cvt_pk_bf16_f32 v244, v200, v201
    v_cvt_pk_bf16_f32 v245, v202, v203
    v_cvt_pk_bf16_f32 v246, v204, v205
    v_mfma_f32_16x16x32_bf16 v[180:183], v[60:63], v[216:219], v[180:183]
    v_cvt_pk_bf16_f32 v247, v206, v207
    ds_write_b128 v68, v[244:247] offset:17408
    v_mfma_f32_16x16x32_bf16 v[188:191], v[60:63], v[220:223], v[188:191]
    s_load_dwordx2 s[68:69], s[20:21], 0
    v_pk_mul_f32 v[128:129], v[128:129], s[6:7]
    v_pk_mul_f32 v[130:131], v[130:131], s[6:7]
    v_pk_mul_f32 v[132:133], v[132:133], s[6:7]
    v_pk_mul_f32 v[134:135], v[134:135], s[6:7]
    v_cvt_pk_bf16_f32 v96, v128, v129
    v_cvt_pk_bf16_f32 v97, v130, v131
    v_cvt_pk_bf16_f32 v98, v132, v133
    v_cvt_pk_bf16_f32 v99, v134, v135
    v_pk_mul_f32 v[136:137], v[136:137], s[6:7]
    v_pk_mul_f32 v[138:139], v[138:139], s[6:7]
    v_pk_mul_f32 v[140:141], v[140:141], s[6:7]
    v_pk_mul_f32 v[142:143], v[142:143], s[6:7]
    v_cvt_pk_bf16_f32 v100, v136, v137
    v_cvt_pk_bf16_f32 v101, v138, v139
    v_cvt_pk_bf16_f32 v102, v140, v141
    v_cvt_pk_bf16_f32 v103, v142, v143
    v_pk_mul_f32 v[144:145], v[144:145], s[6:7]
    v_pk_mul_f32 v[146:147], v[146:147], s[6:7]
    v_pk_mul_f32 v[148:149], v[148:149], s[6:7]
    v_pk_mul_f32 v[150:151], v[150:151], s[6:7]
    v_cvt_pk_bf16_f32 v104, v144, v145
    v_cvt_pk_bf16_f32 v105, v146, v147
    v_cvt_pk_bf16_f32 v106, v148, v149
    v_cvt_pk_bf16_f32 v107, v150, v151
    v_pk_mul_f32 v[152:153], v[152:153], s[6:7]
    v_pk_mul_f32 v[154:155], v[154:155], s[6:7]
    v_pk_mul_f32 v[156:157], v[156:157], s[6:7]
    v_pk_mul_f32 v[158:159], v[158:159], s[6:7]
    v_cvt_pk_bf16_f32 v108, v152, v153
    v_cvt_pk_bf16_f32 v109, v154, v155
    v_cvt_pk_bf16_f32 v110, v156, v157
    v_cvt_pk_bf16_f32 v111, v158, v159
    v_pk_mul_f32 v[160:161], v[160:161], s[6:7]
    v_pk_mul_f32 v[162:163], v[162:163], s[6:7]
    v_pk_mul_f32 v[164:165], v[164:165], s[6:7]
    v_pk_mul_f32 v[166:167], v[166:167], s[6:7]
    v_cvt_pk_bf16_f32 v112, v160, v161
    v_cvt_pk_bf16_f32 v113, v162, v163
    v_cvt_pk_bf16_f32 v114, v164, v165
    v_cvt_pk_bf16_f32 v115, v166, v167
    v_pk_mul_f32 v[168:169], v[168:169], s[6:7]
    v_pk_mul_f32 v[170:171], v[170:171], s[6:7]
    v_pk_mul_f32 v[172:173], v[172:173], s[6:7]
    v_pk_mul_f32 v[174:175], v[174:175], s[6:7]
    v_cvt_pk_bf16_f32 v116, v168, v169
    v_cvt_pk_bf16_f32 v117, v170, v171
    v_cvt_pk_bf16_f32 v118, v172, v173
    v_cvt_pk_bf16_f32 v119, v174, v175
    v_pk_mul_f32 v[176:177], v[176:177], s[6:7]
    v_pk_mul_f32 v[178:179], v[178:179], s[6:7]
    v_pk_mul_f32 v[180:181], v[180:181], s[6:7]
    v_pk_mul_f32 v[182:183], v[182:183], s[6:7]
    v_cvt_pk_bf16_f32 v120, v176, v177
    v_cvt_pk_bf16_f32 v121, v178, v179
    v_cvt_pk_bf16_f32 v122, v180, v181
    v_cvt_pk_bf16_f32 v123, v182, v183
    v_pk_mul_f32 v[184:185], v[184:185], s[6:7]
    v_pk_mul_f32 v[186:187], v[186:187], s[6:7]
    v_pk_mul_f32 v[188:189], v[188:189], s[6:7]
    v_pk_mul_f32 v[190:191], v[190:191], s[6:7]
    v_cvt_pk_bf16_f32 v124, v184, v185
    v_cvt_pk_bf16_f32 v125, v186, v187
    v_cvt_pk_bf16_f32 v126, v188, v189
    v_cvt_pk_bf16_f32 v127, v190, v191
    s_waitcnt lgkmcnt(0)
    s_barrier
    s_cmp_lg_u32 s66, 0
    s_cbranch_scc1 L_maxpass_main
L_maxpass_main_ret:
    ds_read_b128 v[32:35], v9 offset:16384
    ds_read_b128 v[36:39], v9 offset:20480
    ds_read_b128 v[40:43], v10 offset:16384
    ds_read_b128 v[44:47], v10 offset:20480
    s_waitcnt lgkmcnt(3)
    v_mfma_f32_16x16x32_bf16 v[64:67], v[32:35], v[96:99], 0
    ds_read_b128 v[48:51], v11 offset:16384
    v_mfma_f32_16x16x32_bf16 v[72:75], v[32:35], v[100:103], 0
    s_waitcnt lgkmcnt(3)
    ds_read_b128 v[52:55], v11 offset:20480
    v_mfma_f32_16x16x32_bf16 v[68:71], v[36:39], v[96:99], 0
    ds_read_b128 v[56:59], v12 offset:16384
    v_mfma_f32_16x16x32_bf16 v[76:79], v[36:39], v[100:103], 0
    s_waitcnt lgkmcnt(4)
    ds_read_b128 v[60:63], v12 offset:20480
    v_mfma_f32_16x16x32_bf16 v[64:67], v[40:43], v[104:107], v[64:67]
    ds_read_b128 v[32:35], v9 offset:24576
    v_mfma_f32_16x16x32_bf16 v[72:75], v[40:43], v[108:111], v[72:75]
    s_waitcnt lgkmcnt(5)
    ds_read_b128 v[36:39], v9 offset:28672
    v_mfma_f32_16x16x32_bf16 v[68:71], v[44:47], v[104:107], v[68:71]
    ds_read_b128 v[40:43], v10 offset:24576
    v_mfma_f32_16x16x32_bf16 v[76:79], v[44:47], v[108:111], v[76:79]
    s_waitcnt lgkmcnt(6)
    v_mfma_f32_16x16x32_bf16 v[64:67], v[48:51], v[112:115], v[64:67]
    ds_read_b128 v[44:47], v10 offset:28672
    v_mfma_f32_16x16x32_bf16 v[72:75], v[48:51], v[116:119], v[72:75]
    s_waitcnt lgkmcnt(6)
    v_mfma_f32_16x16x32_bf16 v[68:71], v[52:55], v[112:115], v[68:71]
    ds_read_b128 v[48:51], v11 offset:24576
    v_mfma_f32_16x16x32_bf16 v[76:79], v[52:55], v[116:119], v[76:79]
    s_waitcnt lgkmcnt(6)
    v_mfma_f32_16x16x32_bf16 v[64:67], v[56:59], v[120:123], v[64:67]
    ds_read_b128 v[52:55], v11 offset:28672
    v_mfma_f32_16x16x32_bf16 v[72:75], v[56:59], v[124:127], v[72:75]
    s_waitcnt lgkmcnt(6)
    v_mfma_f32_16x16x32_bf16 v[68:71], v[60:63], v[120:123], v[68:71]
    ds_read_b128 v[56:59], v12 offset:24576
    v_mfma_f32_16x16x32_bf16 v[76:79], v[60:63], v[124:127], v[76:79]
    s_waitcnt lgkmcnt(6)
    v_mfma_f32_16x16x32_bf16 v[80:83], v[32:35], v[96:99], 0
    ds_read_b128 v[60:63], v12 offset:28672
    v_mfma_f32_16x16x32_bf16 v[88:91], v[32:35], v[100:103], 0
    s_waitcnt lgkmcnt(6)
    s_barrier
    v_max3_f32 v18, v64, v65, v66
    v_max3_f32 v18, v18, v67, v68
    v_max3_f32 v18, v18, v69, v70
    v_max_f32 v18, v18, v71
    v_max3_f32 v19, v72, v73, v74
    v_mfma_f32_16x16x32_bf16 v[84:87], v[36:39], v[96:99], 0
    ds_read_b128 v[32:35], v9 offset:32768
    v_max3_f32 v19, v19, v75, v76
    v_max3_f32 v19, v19, v77, v78
    v_max_f32 v19, v19, v79
    v_mov_b32 v15, v18
    v_mov_b32 v16, v19
    v_mfma_f32_16x16x32_bf16 v[92:95], v[36:39], v[100:103], 0
    s_waitcnt lgkmcnt(6)
    s_nop 0
    v_permlane16_swap_b32 v15, v18
    v_permlane16_swap_b32 v16, v19
    v_max_f32 v18, v18, v15
    v_max_f32 v19, v19, v16
    v_mfma_f32_16x16x32_bf16 v[80:83], v[40:43], v[104:107], v[80:83]
    ds_read_b128 v[36:39], v9 offset:36864
    v_mov_b32 v15, v18
    v_mov_b32 v16, v19
    s_nop 0
    v_permlane32_swap_b32 v15, v18
    v_permlane32_swap_b32 v16, v19
    v_mfma_f32_16x16x32_bf16 v[88:91], v[40:43], v[108:111], v[88:91]
    s_waitcnt lgkmcnt(6)
    v_max_f32 v18, v18, v15
    v_max_f32 v19, v19, v16
    v_cndmask_b32 v18, v18, v13, s[66:67]
    v_cndmask_b32 v19, v19, v14, s[66:67]
    v_mfma_f32_16x16x32_bf16 v[84:87], v[44:47], v[104:107], v[84:87]
    ds_read_b128 v[40:43], v10 offset:32768
    v_sub_f32 v248, 0, v18
    v_sub_f32 v249, 0, v18
    v_sub_f32 v250, 0, v18
    v_sub_f32 v251, 0, v18
    v_sub_f32 v252, 0, v19
    v_mfma_f32_16x16x32_bf16 v[92:95], v[44:47], v[108:111], v[92:95]
    s_waitcnt lgkmcnt(6)
    v_sub_f32 v253, 0, v19
    v_sub_f32 v254, 0, v19
    v_sub_f32 v255, 0, v19
    v_sub_f32 v64, v64, v18
    v_exp_f32 v64, v64
    v_mfma_f32_16x16x32_bf16 v[80:83], v[48:51], v[112:115], v[80:83]
    ds_read_b128 v[44:47], v10 offset:36864
    v_sub_f32 v65, v65, v18
    v_exp_f32 v65, v65
    v_sub_f32 v66, v66, v18
    v_exp_f32 v66, v66
    v_sub_f32 v67, v67, v18
    v_mfma_f32_16x16x32_bf16 v[88:91], v[48:51], v[116:119], v[88:91]
    s_waitcnt lgkmcnt(6)
    v_exp_f32 v67, v67
    v_cvt_pk_bf16_f32 v128, v64, v65
    v_sub_f32 v68, v68, v18
    v_exp_f32 v68, v68
    v_sub_f32 v69, v69, v18
    v_mfma_f32_16x16x32_bf16 v[84:87], v[52:55], v[112:115], v[84:87]
    ds_read_b128 v[48:51], v11 offset:32768
    v_exp_f32 v69, v69
    v_cvt_pk_bf16_f32 v129, v66, v67
    v_sub_f32 v70, v70, v18
    v_exp_f32 v70, v70
    v_mfma_f32_16x16x32_bf16 v[92:95], v[52:55], v[116:119], v[92:95]
    s_waitcnt lgkmcnt(6)
    v_sub_f32 v71, v71, v18
    v_exp_f32 v71, v71
    v_cvt_pk_bf16_f32 v130, v68, v69
    v_sub_f32 v72, v72, v19
    v_exp_f32 v72, v72
    v_mfma_f32_16x16x32_bf16 v[80:83], v[56:59], v[120:123], v[80:83]
    ds_read_b128 v[52:55], v11 offset:36864
    v_sub_f32 v73, v73, v19
    v_exp_f32 v73, v73
    v_cvt_pk_bf16_f32 v131, v70, v71
    v_sub_f32 v74, v74, v19
    v_exp_f32 v74, v74
    v_mfma_f32_16x16x32_bf16 v[88:91], v[56:59], v[124:127], v[88:91]
    s_waitcnt lgkmcnt(6)
    v_sub_f32 v75, v75, v19
    v_exp_f32 v75, v75
    v_cvt_pk_bf16_f32 v132, v72, v73
    v_sub_f32 v76, v76, v19
    v_exp_f32 v76, v76
    v_mfma_f32_16x16x32_bf16 v[84:87], v[60:63], v[120:123], v[84:87]
    ds_read_b128 v[56:59], v12 offset:32768
    v_sub_f32 v77, v77, v19
    v_exp_f32 v77, v77
    v_cvt_pk_bf16_f32 v133, v74, v75
    v_sub_f32 v78, v78, v19
    v_exp_f32 v78, v78
    v_mfma_f32_16x16x32_bf16 v[92:95], v[60:63], v[124:127], v[92:95]
    s_waitcnt lgkmcnt(6)
    v_sub_f32 v79, v79, v19
    v_exp_f32 v79, v79
    v_cvt_pk_bf16_f32 v134, v76, v77
    v_cvt_pk_bf16_f32 v135, v78, v79
    v_mfma_f32_16x16x32_bf16 v[64:67], v[32:35], v[96:99], v[248:251]
    ds_read_b128 v[60:63], v12 offset:36864
    v_mfma_f32_16x16x32_bf16 v[72:75], v[32:35], v[100:103], v[252:255]
    s_waitcnt lgkmcnt(6)
    v_sub_f32 v80, v80, v18
    v_exp_f32 v80, v80
    v_sub_f32 v81, v81, v18
    v_exp_f32 v81, v81
    v_mfma_f32_16x16x32_bf16 v[68:71], v[36:39], v[96:99], v[248:251]
    ds_read_b128 v[32:35], v9 offset:40960
    v_cvt_pk_bf16_f32 v136, v80, v81
    v_mfma_f32_16x16x32_bf16 v[76:79], v[36:39], v[100:103], v[252:255]
    v_sub_f32 v82, v82, v18
    v_exp_f32 v82, v82
    v_mfma_f32_16x16x32_bf16 v[24:27], v[20:23], v[128:131], 0
    s_waitcnt lgkmcnt(6)
    v_sub_f32 v83, v83, v18
    v_exp_f32 v83, v83
    v_mfma_f32_16x16x32_bf16 v[64:67], v[40:43], v[104:107], v[64:67]
    ds_read_b128 v[36:39], v9 offset:45056
    v_cvt_pk_bf16_f32 v137, v82, v83
    v_mfma_f32_16x16x32_bf16 v[72:75], v[40:43], v[108:111], v[72:75]
    s_waitcnt lgkmcnt(6)
    v_sub_f32 v84, v84, v18
    v_exp_f32 v84, v84
    v_sub_f32 v85, v85, v18
    v_exp_f32 v85, v85
    v_mfma_f32_16x16x32_bf16 v[68:71], v[44:47], v[104:107], v[68:71]
    ds_read_b128 v[40:43], v10 offset:40960
    v_cvt_pk_bf16_f32 v138, v84, v85
    v_mfma_f32_16x16x32_bf16 v[76:79], v[44:47], v[108:111], v[76:79]
    s_waitcnt lgkmcnt(6)
    v_sub_f32 v86, v86, v18
    v_exp_f32 v86, v86
    v_sub_f32 v87, v87, v18
    v_exp_f32 v87, v87
    v_mfma_f32_16x16x32_bf16 v[64:67], v[48:51], v[112:115], v[64:67]
    ds_read_b128 v[44:47], v10 offset:45056
    v_cvt_pk_bf16_f32 v139, v86, v87
    v_mfma_f32_16x16x32_bf16 v[72:75], v[48:51], v[116:119], v[72:75]
    s_waitcnt lgkmcnt(6)
    v_sub_f32 v88, v88, v19
    v_exp_f32 v88, v88
    v_sub_f32 v89, v89, v19
    v_exp_f32 v89, v89
    v_mfma_f32_16x16x32_bf16 v[68:71], v[52:55], v[112:115], v[68:71]
    ds_read_b128 v[48:51], v11 offset:40960
    v_cvt_pk_bf16_f32 v140, v88, v89
    v_mfma_f32_16x16x32_bf16 v[76:79], v[52:55], v[116:119], v[76:79]
    v_sub_f32 v90, v90, v19
    v_exp_f32 v90, v90
    v_mfma_f32_16x16x32_bf16 v[28:31], v[20:23], v[132:135], 0
    s_waitcnt lgkmcnt(6)
    v_sub_f32 v91, v91, v19
    v_exp_f32 v91, v91
    v_mfma_f32_16x16x32_bf16 v[64:67], v[56:59], v[120:123], v[64:67]
    ds_read_b128 v[52:55], v11 offset:45056
    v_cvt_pk_bf16_f32 v141, v90, v91
    v_mfma_f32_16x16x32_bf16 v[72:75], v[56:59], v[124:127], v[72:75]
    s_waitcnt lgkmcnt(6)
    v_sub_f32 v92, v92, v19
    v_exp_f32 v92, v92
    v_sub_f32 v93, v93, v19
    v_exp_f32 v93, v93
    v_mfma_f32_16x16x32_bf16 v[68:71], v[60:63], v[120:123], v[68:71]
    ds_read_b128 v[56:59], v12 offset:40960
    v_cvt_pk_bf16_f32 v142, v92, v93
    v_mfma_f32_16x16x32_bf16 v[76:79], v[60:63], v[124:127], v[76:79]
    s_waitcnt lgkmcnt(6)
    v_sub_f32 v94, v94, v19
    v_exp_f32 v94, v94
    v_sub_f32 v95, v95, v19
    v_exp_f32 v95, v95
    s_nop 0
    v_cvt_pk_bf16_f32 v143, v94, v95
    v_mfma_f32_16x16x32_bf16 v[80:83], v[32:35], v[96:99], v[248:251]
    ds_read_b128 v[60:63], v12 offset:45056
    v_lshrrev_b32 v13, 2, v0
    v_lshlrev_b32 v13, 7, v13
    v_mfma_f32_16x16x32_bf16 v[88:91], v[32:35], v[100:103], v[252:255]
    s_waitcnt lgkmcnt(6)
    s_barrier
    v_exp_f32 v64, v64
    v_exp_f32 v65, v65
    v_mfma_f32_16x16x32_bf16 v[84:87], v[36:39], v[96:99], v[248:251]
    ds_read_b128 v[32:35], v9 offset:49152
    v_cvt_pk_bf16_f32 v144, v64, v65
    v_mfma_f32_16x16x32_bf16 v[92:95], v[36:39], v[100:103], v[252:255]
    v_exp_f32 v66, v66
    v_mfma_f32_16x16x32_bf16 v[24:27], v[20:23], v[136:139], v[24:27]
    s_waitcnt lgkmcnt(6)
    v_exp_f32 v67, v67
    v_mfma_f32_16x16x32_bf16 v[80:83], v[40:43], v[104:107], v[80:83]
    ds_read_b128 v[36:39], v9 offset:53248
    v_cvt_pk_bf16_f32 v145, v66, v67
    v_mfma_f32_16x16x32_bf16 v[88:91], v[40:43], v[108:111], v[88:91]
    s_waitcnt lgkmcnt(6)
    v_exp_f32 v68, v68
    v_exp_f32 v69, v69
    v_mfma_f32_16x16x32_bf16 v[84:87], v[44:47], v[104:107], v[84:87]
    ds_read_b128 v[40:43], v10 offset:49152
    v_cvt_pk_bf16_f32 v146, v68, v69
    v_mfma_f32_16x16x32_bf16 v[92:95], v[44:47], v[108:111], v[92:95]
    s_waitcnt lgkmcnt(6)
    v_exp_f32 v70, v70
    v_exp_f32 v71, v71
    v_mfma_f32_16x16x32_bf16 v[80:83], v[48:51], v[112:115], v[80:83]
    ds_read_b128 v[44:47], v10 offset:53248
    v_cvt_pk_bf16_f32 v147, v70, v71
    v_mfma_f32_16x16x32_bf16 v[88:91], v[48:51], v[116:119], v[88:91]
    s_waitcnt lgkmcnt(6)
    v_exp_f32 v72, v72
    v_exp_f32 v73, v73
    v_mfma_f32_16x16x32_bf16 v[84:87], v[52:55], v[112:115], v[84:87]
    ds_read_b128 v[48:51], v11 offset:49152
    v_cvt_pk_bf16_f32 v148, v72, v73
    v_mfma_f32_16x16x32_bf16 v[92:95], v[52:55], v[116:119], v[92:95]
    v_exp_f32 v74, v74
    v_mfma_f32_16x16x32_bf16 v[28:31], v[20:23], v[140:143], v[28:31]
    s_waitcnt lgkmcnt(6)
    v_exp_f32 v75, v75
    v_mfma_f32_16x16x32_bf16 v[80:83], v[56:59], v[120:123], v[80:83]
    ds_read_b128 v[52:55], v11 offset:53248
    v_cvt_pk_bf16_f32 v149, v74, v75
    v_mfma_f32_16x16x32_bf16 v[88:91], v[56:59], v[124:127], v[88:91]
    s_waitcnt lgkmcnt(6)
    v_exp_f32 v76, v76
    v_exp_f32 v77, v77
    v_mfma_f32_16x16x32_bf16 v[84:87], v[60:63], v[120:123], v[84:87]
    ds_read_b128 v[56:59], v12 offset:49152
    v_cvt_pk_bf16_f32 v150, v76, v77
    v_mfma_f32_16x16x32_bf16 v[92:95], v[60:63], v[124:127], v[92:95]
    s_waitcnt lgkmcnt(6)
    v_exp_f32 v78, v78
    v_exp_f32 v79, v79
    s_nop 0
    v_cvt_pk_bf16_f32 v151, v78, v79
    v_mfma_f32_16x16x32_bf16 v[64:67], v[32:35], v[96:99], v[248:251]
    ds_read_b128 v[60:63], v12 offset:53248
    v_bfe_u32 v14, v0, 3, 1
    v_lshl_add_u32 v13, v14, 6, v13
    v_mfma_f32_16x16x32_bf16 v[72:75], v[32:35], v[100:103], v[252:255]
    s_waitcnt lgkmcnt(6)
    v_exp_f32 v80, v80
    v_exp_f32 v81, v81
    v_mfma_f32_16x16x32_bf16 v[68:71], v[36:39], v[96:99], v[248:251]
    ds_read_b128 v[32:35], v9 offset:57344
    v_cvt_pk_bf16_f32 v152, v80, v81
    v_mfma_f32_16x16x32_bf16 v[76:79], v[36:39], v[100:103], v[252:255]
    v_exp_f32 v82, v82
    v_mfma_f32_16x16x32_bf16 v[24:27], v[20:23], v[144:147], v[24:27]
    s_waitcnt lgkmcnt(6)
    v_exp_f32 v83, v83
    v_mfma_f32_16x16x32_bf16 v[64:67], v[40:43], v[104:107], v[64:67]
    ds_read_b128 v[36:39], v9 offset:61440
    v_cvt_pk_bf16_f32 v153, v82, v83
    v_mfma_f32_16x16x32_bf16 v[72:75], v[40:43], v[108:111], v[72:75]
    s_waitcnt lgkmcnt(6)
    v_exp_f32 v84, v84
    v_exp_f32 v85, v85
    v_mfma_f32_16x16x32_bf16 v[68:71], v[44:47], v[104:107], v[68:71]
    ds_read_b128 v[40:43], v10 offset:57344
    v_cvt_pk_bf16_f32 v154, v84, v85
    v_mfma_f32_16x16x32_bf16 v[76:79], v[44:47], v[108:111], v[76:79]
    s_waitcnt lgkmcnt(6)
    v_exp_f32 v86, v86
    v_exp_f32 v87, v87
    v_mfma_f32_16x16x32_bf16 v[64:67], v[48:51], v[112:115], v[64:67]
    ds_read_b128 v[44:47], v10 offset:61440
    v_cvt_pk_bf16_f32 v155, v86, v87
    v_mfma_f32_16x16x32_bf16 v[72:75], v[48:51], v[116:119], v[72:75]
    s_waitcnt lgkmcnt(6)
    v_exp_f32 v88, v88
    v_exp_f32 v89, v89
    v_mfma_f32_16x16x32_bf16 v[68:71], v[52:55], v[112:115], v[68:71]
    ds_read_b128 v[48:51], v11 offset:57344
    v_cvt_pk_bf16_f32 v156, v88, v89
    v_mfma_f32_16x16x32_bf16 v[76:79], v[52:55], v[116:119], v[76:79]
    v_exp_f32 v90, v90
    v_mfma_f32_16x16x32_bf16 v[28:31], v[20:23], v[148:151], v[28:31]
    s_waitcnt lgkmcnt(6)
    v_exp_f32 v91, v91
    v_mfma_f32_16x16x32_bf16 v[64:67], v[56:59], v[120:123], v[64:67]
    ds_read_b128 v[52:55], v11 offset:61440
    v_cvt_pk_bf16_f32 v157, v90, v91
    v_mfma_f32_16x16x32_bf16 v[72:75], v[56:59], v[124:127], v[72:75]
    s_waitcnt lgkmcnt(6)
    v_exp_f32 v92, v92
    v_exp_f32 v93, v93
    v_mfma_f32_16x16x32_bf16 v[68:71], v[60:63], v[120:123], v[68:71]
    ds_read_b128 v[56:59], v12 offset:57344
    v_cvt_pk_bf16_f32 v158, v92, v93
    v_mfma_f32_16x16x32_bf16 v[76:79], v[60:63], v[124:127], v[76:79]
    s_waitcnt lgkmcnt(6)
    v_exp_f32 v94, v94
    v_exp_f32 v95, v95
    s_nop 0
    v_cvt_pk_bf16_f32 v159, v94, v95
    v_mfma_f32_16x16x32_bf16 v[80:83], v[32:35], v[96:99], v[248:251]
    ds_read_b128 v[60:63], v12 offset:61440
    v_bfe_u32 v14, v0, 4, 1
    v_lshl_add_u32 v13, v14, 5, v13
    v_mfma_f32_16x16x32_bf16 v[88:91], v[32:35], v[100:103], v[252:255]
    s_waitcnt lgkmcnt(6)
    s_barrier
    v_exp_f32 v64, v64
    v_exp_f32 v65, v65
    v_mfma_f32_16x16x32_bf16 v[84:87], v[36:39], v[96:99], v[248:251]
    ds_read_b128 v[32:35], v9
    v_cvt_pk_bf16_f32 v160, v64, v65
    v_mfma_f32_16x16x32_bf16 v[92:95], v[36:39], v[100:103], v[252:255]
    v_exp_f32 v66, v66
    v_mfma_f32_16x16x32_bf16 v[24:27], v[20:23], v[152:155], v[24:27]
    s_waitcnt lgkmcnt(6)
    v_exp_f32 v67, v67
    v_mfma_f32_16x16x32_bf16 v[80:83], v[40:43], v[104:107], v[80:83]
    ds_read_b128 v[36:39], v9 offset:4096
    v_cvt_pk_bf16_f32 v161, v66, v67
    v_mfma_f32_16x16x32_bf16 v[88:91], v[40:43], v[108:111], v[88:91]
    s_waitcnt lgkmcnt(6)
    v_exp_f32 v68, v68
    v_exp_f32 v69, v69
    v_mfma_f32_16x16x32_bf16 v[84:87], v[44:47], v[104:107], v[84:87]
    ds_read_b128 v[40:43], v10
    v_cvt_pk_bf16_f32 v162, v68, v69
    v_mfma_f32_16x16x32_bf16 v[92:95], v[44:47], v[108:111], v[92:95]
    s_waitcnt lgkmcnt(6)
    v_exp_f32 v70, v70
    v_exp_f32 v71, v71
    v_mfma_f32_16x16x32_bf16 v[80:83], v[48:51], v[112:115], v[80:83]
    ds_read_b128 v[44:47], v10 offset:4096
    v_cvt_pk_bf16_f32 v163, v70, v71
    v_mfma_f32_16x16x32_bf16 v[88:91], v[48:51], v[116:119], v[88:91]
    s_waitcnt lgkmcnt(6)
    v_exp_f32 v72, v72
    v_exp_f32 v73, v73
    v_mfma_f32_16x16x32_bf16 v[84:87], v[52:55], v[112:115], v[84:87]
    ds_read_b128 v[48:51], v11
    v_cvt_pk_bf16_f32 v164, v72, v73
    v_mfma_f32_16x16x32_bf16 v[92:95], v[52:55], v[116:119], v[92:95]
    v_exp_f32 v74, v74
    v_mfma_f32_16x16x32_bf16 v[28:31], v[20:23], v[156:159], v[28:31]
    s_waitcnt lgkmcnt(6)
    v_exp_f32 v75, v75
    v_mfma_f32_16x16x32_bf16 v[80:83], v[56:59], v[120:123], v[80:83]
    ds_read_b128 v[52:55], v11 offset:4096
    v_cvt_pk_bf16_f32 v165, v74, v75
    v_mfma_f32_16x16x32_bf16 v[88:91], v[56:59], v[124:127], v[88:91]
    s_waitcnt lgkmcnt(6)
    v_exp_f32 v76, v76
    v_exp_f32 v77, v77
    v_mfma_f32_16x16x32_bf16 v[84:87], v[60:63], v[120:123], v[84:87]
    ds_read_b128 v[56:59], v12
    v_cvt_pk_bf16_f32 v166, v76, v77
    v_mfma_f32_16x16x32_bf16 v[92:95], v[60:63], v[124:127], v[92:95]
    s_waitcnt lgkmcnt(6)
    v_exp_f32 v78, v78
    v_exp_f32 v79, v79
    s_nop 0
    v_cvt_pk_bf16_f32 v167, v78, v79
    v_mfma_f32_16x16x32_bf16 v[64:67], v[32:35], v[96:99], v[248:251]
    ds_read_b128 v[60:63], v12 offset:4096
    v_and_b32 v14, 3, v0
    v_lshl_add_u32 v13, v14, 3, v13
    v_mfma_f32_16x16x32_bf16 v[72:75], v[32:35], v[100:103], v[252:255]
    s_waitcnt lgkmcnt(6)
    v_exp_f32 v80, v80
    v_exp_f32 v81, v81
    v_mfma_f32_16x16x32_bf16 v[68:71], v[36:39], v[96:99], v[248:251]
    ds_read_b128 v[32:35], v9 offset:8192
    v_cvt_pk_bf16_f32 v168, v80, v81
    v_mfma_f32_16x16x32_bf16 v[76:79], v[36:39], v[100:103], v[252:255]
    v_exp_f32 v82, v82
    v_mfma_f32_16x16x32_bf16 v[24:27], v[20:23], v[160:163], v[24:27]
    s_waitcnt lgkmcnt(6)
    v_exp_f32 v83, v83
    v_mfma_f32_16x16x32_bf16 v[64:67], v[40:43], v[104:107], v[64:67]
    ds_read_b128 v[36:39], v9 offset:12288
    v_add_u32 v9, 0xffffc000, v9
    v_cvt_pk_bf16_f32 v169, v82, v83
    v_mfma_f32_16x16x32_bf16 v[72:75], v[40:43], v[108:111], v[72:75]
    s_waitcnt lgkmcnt(6)
    v_exp_f32 v84, v84
    v_exp_f32 v85, v85
    v_mfma_f32_16x16x32_bf16 v[68:71], v[44:47], v[104:107], v[68:71]
    ds_read_b128 v[40:43], v10 offset:8192
    v_cvt_pk_bf16_f32 v170, v84, v85
    v_mfma_f32_16x16x32_bf16 v[76:79], v[44:47], v[108:111], v[76:79]
    s_waitcnt lgkmcnt(6)
    v_exp_f32 v86, v86
    v_exp_f32 v87, v87
    v_mfma_f32_16x16x32_bf16 v[64:67], v[48:51], v[112:115], v[64:67]
    ds_read_b128 v[44:47], v10 offset:12288
    v_add_u32 v10, 0xffffc000, v10
    v_cvt_pk_bf16_f32 v171, v86, v87
    v_mfma_f32_16x16x32_bf16 v[72:75], v[48:51], v[116:119], v[72:75]
    s_waitcnt lgkmcnt(6)
    v_exp_f32 v88, v88
    v_exp_f32 v89, v89
    v_mfma_f32_16x16x32_bf16 v[68:71], v[52:55], v[112:115], v[68:71]
    ds_read_b128 v[48:51], v11 offset:8192
    v_cvt_pk_bf16_f32 v172, v88, v89
    v_mfma_f32_16x16x32_bf16 v[76:79], v[52:55], v[116:119], v[76:79]
    v_exp_f32 v90, v90
    v_mfma_f32_16x16x32_bf16 v[28:31], v[20:23], v[164:167], v[28:31]
    s_waitcnt lgkmcnt(6)
    v_exp_f32 v91, v91
    v_mfma_f32_16x16x32_bf16 v[64:67], v[56:59], v[120:123], v[64:67]
    ds_read_b128 v[52:55], v11 offset:12288
    v_add_u32 v11, 0xffffc000, v11
    v_cvt_pk_bf16_f32 v173, v90, v91
    v_mfma_f32_16x16x32_bf16 v[72:75], v[56:59], v[124:127], v[72:75]
    s_waitcnt lgkmcnt(6)
    v_exp_f32 v92, v92
    v_exp_f32 v93, v93
    v_mfma_f32_16x16x32_bf16 v[68:71], v[60:63], v[120:123], v[68:71]
    ds_read_b128 v[56:59], v12 offset:8192
    v_cvt_pk_bf16_f32 v174, v92, v93
    v_mfma_f32_16x16x32_bf16 v[76:79], v[60:63], v[124:127], v[76:79]
    s_waitcnt lgkmcnt(6)
    v_exp_f32 v94, v94
    v_exp_f32 v95, v95
    s_nop 0
    v_cvt_pk_bf16_f32 v175, v94, v95
    v_mfma_f32_16x16x32_bf16 v[80:83], v[32:35], v[96:99], v[248:251]
    ds_read_b128 v[60:63], v12 offset:12288
    v_add_u32 v12, 0xffffc000, v12
    v_add_u32 v13, 98304, v13
    v_xor_b32 v14, 32, v13
    v_mfma_f32_16x16x32_bf16 v[88:91], v[32:35], v[100:103], v[252:255]
    s_waitcnt lgkmcnt(6)
    s_barrier
    v_exp_f32 v64, v64
    v_exp_f32 v65, v65
    v_mfma_f32_16x16x32_bf16 v[84:87], v[36:39], v[96:99], v[248:251]
    ds_read_b128 v[32:35], v9
    v_cvt_pk_bf16_f32 v176, v64, v65
    v_mfma_f32_16x16x32_bf16 v[92:95], v[36:39], v[100:103], v[252:255]
    v_exp_f32 v66, v66
    v_mfma_f32_16x16x32_bf16 v[24:27], v[20:23], v[168:171], v[24:27]
    s_waitcnt lgkmcnt(6)
    v_exp_f32 v67, v67
    v_mfma_f32_16x16x32_bf16 v[80:83], v[40:43], v[104:107], v[80:83]
    ds_read_b128 v[36:39], v9 offset:4096
    v_cvt_pk_bf16_f32 v177, v66, v67
    v_mfma_f32_16x16x32_bf16 v[88:91], v[40:43], v[108:111], v[88:91]
    s_waitcnt lgkmcnt(6)
    v_exp_f32 v68, v68
    v_exp_f32 v69, v69
    v_mfma_f32_16x16x32_bf16 v[84:87], v[44:47], v[104:107], v[84:87]
    ds_read_b128 v[40:43], v10
    v_cvt_pk_bf16_f32 v178, v68, v69
    v_mfma_f32_16x16x32_bf16 v[92:95], v[44:47], v[108:111], v[92:95]
    s_waitcnt lgkmcnt(6)
    v_exp_f32 v70, v70
    v_exp_f32 v71, v71
    v_mfma_f32_16x16x32_bf16 v[80:83], v[48:51], v[112:115], v[80:83]
    ds_read_b128 v[44:47], v10 offset:4096
    v_cvt_pk_bf16_f32 v179, v70, v71
    v_mfma_f32_16x16x32_bf16 v[88:91], v[48:51], v[116:119], v[88:91]
    s_waitcnt lgkmcnt(6)
    v_exp_f32 v72, v72
    v_exp_f32 v73, v73
    v_mfma_f32_16x16x32_bf16 v[84:87], v[52:55], v[112:115], v[84:87]
    ds_read_b128 v[48:51], v11
    v_cvt_pk_bf16_f32 v180, v72, v73
    v_mfma_f32_16x16x32_bf16 v[92:95], v[52:55], v[116:119], v[92:95]
    v_exp_f32 v74, v74
    v_mfma_f32_16x16x32_bf16 v[28:31], v[20:23], v[172:175], v[28:31]
    s_waitcnt lgkmcnt(6)
    v_exp_f32 v75, v75
    v_mfma_f32_16x16x32_bf16 v[80:83], v[56:59], v[120:123], v[80:83]
    ds_read_b128 v[52:55], v11 offset:4096
    v_cvt_pk_bf16_f32 v181, v74, v75
    v_mfma_f32_16x16x32_bf16 v[88:91], v[56:59], v[124:127], v[88:91]
    s_waitcnt lgkmcnt(6)
    v_exp_f32 v76, v76
    v_exp_f32 v77, v77
    v_mfma_f32_16x16x32_bf16 v[84:87], v[60:63], v[120:123], v[84:87]
    ds_read_b128 v[56:59], v12
    v_cvt_pk_bf16_f32 v182, v76, v77
    v_mfma_f32_16x16x32_bf16 v[92:95], v[60:63], v[124:127], v[92:95]
    s_waitcnt lgkmcnt(6)
    v_exp_f32 v78, v78
    v_exp_f32 v79, v79
    s_nop 0
    v_cvt_pk_bf16_f32 v183, v78, v79
    v_mfma_f32_16x16x32_bf16 v[64:67], v[32:35], v[96:99], v[248:251]
    ds_read_b128 v[60:63], v12 offset:4096
    v_xor_b32 v15, 64, v13
    v_xor_b32 v16, 0x60, v13
    v_mfma_f32_16x16x32_bf16 v[72:75], v[32:35], v[100:103], v[252:255]
    s_waitcnt lgkmcnt(6)
    v_exp_f32 v80, v80
    v_exp_f32 v81, v81
    v_mfma_f32_16x16x32_bf16 v[68:71], v[36:39], v[96:99], v[248:251]
    ds_read_b128 v[32:35], v9 offset:8192
    v_cvt_pk_bf16_f32 v184, v80, v81
    v_mfma_f32_16x16x32_bf16 v[76:79], v[36:39], v[100:103], v[252:255]
    v_exp_f32 v82, v82
    v_mfma_f32_16x16x32_bf16 v[24:27], v[20:23], v[176:179], v[24:27]
    s_waitcnt lgkmcnt(6)
    v_exp_f32 v83, v83
    v_mfma_f32_16x16x32_bf16 v[64:67], v[40:43], v[104:107], v[64:67]
    ds_read_b128 v[36:39], v9 offset:12288
    v_cvt_pk_bf16_f32 v185, v82, v83
    v_mfma_f32_16x16x32_bf16 v[72:75], v[40:43], v[108:111], v[72:75]
    s_waitcnt lgkmcnt(6)
    v_exp_f32 v84, v84
    v_exp_f32 v85, v85
    v_mfma_f32_16x16x32_bf16 v[68:71], v[44:47], v[104:107], v[68:71]
    ds_read_b128 v[40:43], v10 offset:8192
    v_cvt_pk_bf16_f32 v186, v84, v85
    v_mfma_f32_16x16x32_bf16 v[76:79], v[44:47], v[108:111], v[76:79]
    s_waitcnt lgkmcnt(6)
    v_exp_f32 v86, v86
    v_exp_f32 v87, v87
    v_mfma_f32_16x16x32_bf16 v[64:67], v[48:51], v[112:115], v[64:67]
    ds_read_b128 v[44:47], v10 offset:12288
    v_cvt_pk_bf16_f32 v187, v86, v87
    v_mfma_f32_16x16x32_bf16 v[72:75], v[48:51], v[116:119], v[72:75]
    s_waitcnt lgkmcnt(6)
    v_exp_f32 v88, v88
    v_exp_f32 v89, v89
    v_mfma_f32_16x16x32_bf16 v[68:71], v[52:55], v[112:115], v[68:71]
    ds_read_b128 v[48:51], v11 offset:8192
    v_cvt_pk_bf16_f32 v188, v88, v89
    v_mfma_f32_16x16x32_bf16 v[76:79], v[52:55], v[116:119], v[76:79]
    v_exp_f32 v90, v90
    v_mfma_f32_16x16x32_bf16 v[28:31], v[20:23], v[180:183], v[28:31]
    s_waitcnt lgkmcnt(6)
    v_exp_f32 v91, v91
    v_mfma_f32_16x16x32_bf16 v[64:67], v[56:59], v[120:123], v[64:67]
    ds_read_b128 v[52:55], v11 offset:12288
    v_cvt_pk_bf16_f32 v189, v90, v91
    v_mfma_f32_16x16x32_bf16 v[72:75], v[56:59], v[124:127], v[72:75]
    s_waitcnt lgkmcnt(6)
    v_exp_f32 v92, v92
    v_exp_f32 v93, v93
    v_mfma_f32_16x16x32_bf16 v[68:71], v[60:63], v[120:123], v[68:71]
    ds_read_b128 v[56:59], v12 offset:8192
    v_cvt_pk_bf16_f32 v190, v92, v93
    v_mfma_f32_16x16x32_bf16 v[76:79], v[60:63], v[124:127], v[76:79]
    s_waitcnt lgkmcnt(6)
    v_exp_f32 v94, v94
    v_exp_f32 v95, v95
    s_nop 0
    v_cvt_pk_bf16_f32 v191, v94, v95
    v_mfma_f32_16x16x32_bf16 v[80:83], v[32:35], v[96:99], v[248:251]
    ds_read_b128 v[60:63], v12 offset:12288
    v_mfma_f32_16x16x32_bf16 v[88:91], v[32:35], v[100:103], v[252:255]
    s_waitcnt lgkmcnt(6)
    s_barrier
    v_exp_f32 v64, v64
    v_exp_f32 v65, v65
    v_mfma_f32_16x16x32_bf16 v[84:87], v[36:39], v[96:99], v[248:251]
    ds_read_b128 v[32:35], v9 offset:32768
    v_cvt_pk_bf16_f32 v192, v64, v65
    v_mfma_f32_16x16x32_bf16 v[92:95], v[36:39], v[100:103], v[252:255]
    v_exp_f32 v66, v66
    v_mfma_f32_16x16x32_bf16 v[24:27], v[20:23], v[184:187], v[24:27]
    s_waitcnt lgkmcnt(6)
    v_exp_f32 v67, v67
    v_mfma_f32_16x16x32_bf16 v[80:83], v[40:43], v[104:107], v[80:83]
    ds_read_b128 v[36:39], v9 offset:36864
    v_cvt_pk_bf16_f32 v193, v66, v67
    v_mfma_f32_16x16x32_bf16 v[88:91], v[40:43], v[108:111], v[88:91]
    s_waitcnt lgkmcnt(6)
    v_exp_f32 v68, v68
    v_exp_f32 v69, v69
    v_mfma_f32_16x16x32_bf16 v[84:87], v[44:47], v[104:107], v[84:87]
    ds_read_b128 v[40:43], v10 offset:32768
    v_cvt_pk_bf16_f32 v194, v68, v69
    v_mfma_f32_16x16x32_bf16 v[92:95], v[44:47], v[108:111], v[92:95]
    s_waitcnt lgkmcnt(6)
    v_exp_f32 v70, v70
    v_exp_f32 v71, v71
    v_mfma_f32_16x16x32_bf16 v[80:83], v[48:51], v[112:115], v[80:83]
    ds_read_b128 v[44:47], v10 offset:36864
    v_cvt_pk_bf16_f32 v195, v70, v71
    v_mfma_f32_16x16x32_bf16 v[88:91], v[48:51], v[116:119], v[88:91]
    s_waitcnt lgkmcnt(6)
    v_exp_f32 v72, v72
    v_exp_f32 v73, v73
    v_mfma_f32_16x16x32_bf16 v[84:87], v[52:55], v[112:115], v[84:87]
    ds_read_b128 v[48:51], v11 offset:32768
    v_cvt_pk_bf16_f32 v196, v72, v73
    v_mfma_f32_16x16x32_bf16 v[92:95], v[52:55], v[116:119], v[92:95]
    v_exp_f32 v74, v74
    v_mfma_f32_16x16x32_bf16 v[28:31], v[20:23], v[188:191], v[28:31]
    s_waitcnt lgkmcnt(6)
    v_exp_f32 v75, v75
    v_mfma_f32_16x16x32_bf16 v[80:83], v[56:59], v[120:123], v[80:83]
    ds_read_b128 v[52:55], v11 offset:36864
    v_cvt_pk_bf16_f32 v197, v74, v75
    v_mfma_f32_16x16x32_bf16 v[88:91], v[56:59], v[124:127], v[88:91]
    s_waitcnt lgkmcnt(6)
    v_exp_f32 v76, v76
    v_exp_f32 v77, v77
    v_mfma_f32_16x16x32_bf16 v[84:87], v[60:63], v[120:123], v[84:87]
    ds_read_b128 v[56:59], v12 offset:32768
    v_cvt_pk_bf16_f32 v198, v76, v77
    v_mfma_f32_16x16x32_bf16 v[92:95], v[60:63], v[124:127], v[92:95]
    s_waitcnt lgkmcnt(6)
    v_exp_f32 v78, v78
    v_exp_f32 v79, v79
    s_nop 0
    v_cvt_pk_bf16_f32 v199, v78, v79
    v_mfma_f32_16x16x32_bf16 v[64:67], v[32:35], v[96:99], v[248:251]
    ds_read_b128 v[60:63], v12 offset:36864
    v_mfma_f32_16x16x32_bf16 v[72:75], v[32:35], v[100:103], v[252:255]
    s_waitcnt lgkmcnt(6)
    v_exp_f32 v80, v80
    v_exp_f32 v81, v81
    v_mfma_f32_16x16x32_bf16 v[68:71], v[36:39], v[96:99], v[248:251]
    ds_read_b128 v[32:35], v9 offset:40960
    v_cvt_pk_bf16_f32 v200, v80, v81
    v_mfma_f32_16x16x32_bf16 v[76:79], v[36:39], v[100:103], v[252:255]
    v_exp_f32 v82, v82
    v_mfma_f32_16x16x32_bf16 v[24:27], v[20:23], v[192:195], v[24:27]
    s_waitcnt lgkmcnt(6)
    v_exp_f32 v83, v83
    v_mfma_f32_16x16x32_bf16 v[64:67], v[40:43], v[104:107], v[64:67]
    ds_read_b128 v[36:39], v9 offset:45056
    v_cvt_pk_bf16_f32 v201, v82, v83
    v_mfma_f32_16x16x32_bf16 v[72:75], v[40:43], v[108:111], v[72:75]
    s_waitcnt lgkmcnt(6)
    v_exp_f32 v84, v84
    v_exp_f32 v85, v85
    v_mfma_f32_16x16x32_bf16 v[68:71], v[44:47], v[104:107], v[68:71]
    ds_read_b128 v[40:43], v10 offset:40960
    v_cvt_pk_bf16_f32 v202, v84, v85
    v_mfma_f32_16x16x32_bf16 v[76:79], v[44:47], v[108:111], v[76:79]
    s_waitcnt lgkmcnt(6)
    v_exp_f32 v86, v86
    v_exp_f32 v87, v87
    v_mfma_f32_16x16x32_bf16 v[64:67], v[48:51], v[112:115], v[64:67]
    ds_read_b128 v[44:47], v10 offset:45056
    v_cvt_pk_bf16_f32 v203, v86, v87
    v_mfma_f32_16x16x32_bf16 v[72:75], v[48:51], v[116:119], v[72:75]
    s_waitcnt lgkmcnt(6)
    v_exp_f32 v88, v88
    v_exp_f32 v89, v89
    v_mfma_f32_16x16x32_bf16 v[68:71], v[52:55], v[112:115], v[68:71]
    ds_read_b128 v[48:51], v11 offset:40960
    v_cvt_pk_bf16_f32 v204, v88, v89
    v_mfma_f32_16x16x32_bf16 v[76:79], v[52:55], v[116:119], v[76:79]
    v_exp_f32 v90, v90
    v_mfma_f32_16x16x32_bf16 v[28:31], v[20:23], v[196:199], v[28:31]
    s_waitcnt lgkmcnt(6)
    v_exp_f32 v91, v91
    v_mfma_f32_16x16x32_bf16 v[64:67], v[56:59], v[120:123], v[64:67]
    ds_read_b128 v[52:55], v11 offset:45056
    v_cvt_pk_bf16_f32 v205, v90, v91
    v_mfma_f32_16x16x32_bf16 v[72:75], v[56:59], v[124:127], v[72:75]
    s_waitcnt lgkmcnt(6)
    v_exp_f32 v92, v92
    v_exp_f32 v93, v93
    v_mfma_f32_16x16x32_bf16 v[68:71], v[60:63], v[120:123], v[68:71]
    ds_read_b128 v[56:59], v12 offset:40960
    v_cvt_pk_bf16_f32 v206, v92, v93
    v_mfma_f32_16x16x32_bf16 v[76:79], v[60:63], v[124:127], v[76:79]
    s_waitcnt lgkmcnt(6)
    v_exp_f32 v94, v94
    v_exp_f32 v95, v95
    s_nop 0
    v_cvt_pk_bf16_f32 v207, v94, v95
    v_mfma_f32_16x16x32_bf16 v[80:83], v[32:35], v[96:99], v[248:251]
    ds_read_b128 v[60:63], v12 offset:45056
    v_mfma_f32_16x16x32_bf16 v[88:91], v[32:35], v[100:103], v[252:255]
    s_waitcnt lgkmcnt(6)
    s_barrier
    v_exp_f32 v64, v64
    v_exp_f32 v65, v65
    v_mfma_f32_16x16x32_bf16 v[84:87], v[36:39], v[96:99], v[248:251]
    ds_read_b128 v[32:35], v9 offset:49152
    v_cvt_pk_bf16_f32 v208, v64, v65
    v_mfma_f32_16x16x32_bf16 v[92:95], v[36:39], v[100:103], v[252:255]
    v_exp_f32 v66, v66
    v_mfma_f32_16x16x32_bf16 v[24:27], v[20:23], v[200:203], v[24:27]
    s_waitcnt lgkmcnt(6)
    v_exp_f32 v67, v67
    v_mfma_f32_16x16x32_bf16 v[80:83], v[40:43], v[104:107], v[80:83]
    ds_read_b128 v[36:39], v9 offset:53248
    v_cvt_pk_bf16_f32 v209, v66, v67
    v_mfma_f32_16x16x32_bf16 v[88:91], v[40:43], v[108:111], v[88:91]
    s_waitcnt lgkmcnt(6)
    v_exp_f32 v68, v68
    v_exp_f32 v69, v69
    v_mfma_f32_16x16x32_bf16 v[84:87], v[44:47], v[104:107], v[84:87]
    ds_read_b128 v[40:43], v10 offset:49152
    v_cvt_pk_bf16_f32 v210, v68, v69
    v_mfma_f32_16x16x32_bf16 v[92:95], v[44:47], v[108:111], v[92:95]
    s_waitcnt lgkmcnt(6)
    v_exp_f32 v70, v70
    v_exp_f32 v71, v71
    v_mfma_f32_16x16x32_bf16 v[80:83], v[48:51], v[112:115], v[80:83]
    ds_read_b128 v[44:47], v10 offset:53248
    v_cvt_pk_bf16_f32 v211, v70, v71
    v_mfma_f32_16x16x32_bf16 v[88:91], v[48:51], v[116:119], v[88:91]
    s_waitcnt lgkmcnt(6)
    v_exp_f32 v72, v72
    v_exp_f32 v73, v73
    v_mfma_f32_16x16x32_bf16 v[84:87], v[52:55], v[112:115], v[84:87]
    ds_read_b128 v[48:51], v11 offset:49152
    v_cvt_pk_bf16_f32 v212, v72, v73
    v_mfma_f32_16x16x32_bf16 v[92:95], v[52:55], v[116:119], v[92:95]
    v_exp_f32 v74, v74
    v_mfma_f32_16x16x32_bf16 v[28:31], v[20:23], v[204:207], v[28:31]
    s_waitcnt lgkmcnt(6)
    v_exp_f32 v75, v75
    v_mfma_f32_16x16x32_bf16 v[80:83], v[56:59], v[120:123], v[80:83]
    ds_read_b128 v[52:55], v11 offset:53248
    v_cvt_pk_bf16_f32 v213, v74, v75
    v_mfma_f32_16x16x32_bf16 v[88:91], v[56:59], v[124:127], v[88:91]
    s_waitcnt lgkmcnt(6)
    v_exp_f32 v76, v76
    v_exp_f32 v77, v77
    v_mfma_f32_16x16x32_bf16 v[84:87], v[60:63], v[120:123], v[84:87]
    ds_read_b128 v[56:59], v12 offset:49152
    v_cvt_pk_bf16_f32 v214, v76, v77
    v_mfma_f32_16x16x32_bf16 v[92:95], v[60:63], v[124:127], v[92:95]
    s_waitcnt lgkmcnt(6)
    v_exp_f32 v78, v78
    v_exp_f32 v79, v79
    s_nop 0
    v_cvt_pk_bf16_f32 v215, v78, v79
    v_mfma_f32_16x16x32_bf16 v[64:67], v[32:35], v[96:99], v[248:251]
    ds_read_b128 v[60:63], v12 offset:53248
    v_mfma_f32_16x16x32_bf16 v[72:75], v[32:35], v[100:103], v[252:255]
    s_waitcnt lgkmcnt(6)
    v_exp_f32 v80, v80
    v_exp_f32 v81, v81
    v_mfma_f32_16x16x32_bf16 v[68:71], v[36:39], v[96:99], v[248:251]
    ds_read_b128 v[32:35], v9 offset:57344
    v_cvt_pk_bf16_f32 v216, v80, v81
    v_mfma_f32_16x16x32_bf16 v[76:79], v[36:39], v[100:103], v[252:255]
    v_exp_f32 v82, v82
    v_mfma_f32_16x16x32_bf16 v[24:27], v[20:23], v[208:211], v[24:27]
    s_waitcnt lgkmcnt(6)
    v_exp_f32 v83, v83
    v_mfma_f32_16x16x32_bf16 v[64:67], v[40:43], v[104:107], v[64:67]
    ds_read_b128 v[36:39], v9 offset:61440
    v_add_u32 v9, 0x4000, v9
    v_cvt_pk_bf16_f32 v217, v82, v83
    v_mfma_f32_16x16x32_bf16 v[72:75], v[40:43], v[108:111], v[72:75]
    s_waitcnt lgkmcnt(6)
    v_exp_f32 v84, v84
    v_exp_f32 v85, v85
    v_mfma_f32_16x16x32_bf16 v[68:71], v[44:47], v[104:107], v[68:71]
    ds_read_b128 v[40:43], v10 offset:57344
    v_cvt_pk_bf16_f32 v218, v84, v85
    v_mfma_f32_16x16x32_bf16 v[76:79], v[44:47], v[108:111], v[76:79]
    s_waitcnt lgkmcnt(6)
    v_exp_f32 v86, v86
    v_exp_f32 v87, v87
    v_mfma_f32_16x16x32_bf16 v[64:67], v[48:51], v[112:115], v[64:67]
    ds_read_b128 v[44:47], v10 offset:61440
    v_add_u32 v10, 0x4000, v10
    v_cvt_pk_bf16_f32 v219, v86, v87
    v_mfma_f32_16x16x32_bf16 v[72:75], v[48:51], v[116:119], v[72:75]
    s_waitcnt lgkmcnt(6)
    v_exp_f32 v88, v88
    v_exp_f32 v89, v89
    v_mfma_f32_16x16x32_bf16 v[68:71], v[52:55], v[112:115], v[68:71]
    ds_read_b128 v[48:51], v11 offset:57344
    v_cvt_pk_bf16_f32 v220, v88, v89
    v_mfma_f32_16x16x32_bf16 v[76:79], v[52:55], v[116:119], v[76:79]
    v_exp_f32 v90, v90
    v_mfma_f32_16x16x32_bf16 v[28:31], v[20:23], v[212:215], v[28:31]
    s_waitcnt lgkmcnt(6)
    v_exp_f32 v91, v91
    v_mfma_f32_16x16x32_bf16 v[64:67], v[56:59], v[120:123], v[64:67]
    ds_read_b128 v[52:55], v11 offset:61440
    v_add_u32 v11, 0x4000, v11
    v_cvt_pk_bf16_f32 v221, v90, v91
    v_mfma_f32_16x16x32_bf16 v[72:75], v[56:59], v[124:127], v[72:75]
    s_waitcnt lgkmcnt(6)
    v_exp_f32 v92, v92
    v_exp_f32 v93, v93
    v_mfma_f32_16x16x32_bf16 v[68:71], v[60:63], v[120:123], v[68:71]
    ds_read_b128 v[56:59], v12 offset:57344
    v_cvt_pk_bf16_f32 v222, v92, v93
    v_mfma_f32_16x16x32_bf16 v[76:79], v[60:63], v[124:127], v[76:79]
    s_waitcnt lgkmcnt(6)
    v_exp_f32 v94, v94
    v_exp_f32 v95, v95
    s_nop 0
    v_cvt_pk_bf16_f32 v223, v94, v95
    v_mfma_f32_16x16x32_bf16 v[80:83], v[32:35], v[96:99], v[248:251]
    ds_read_b128 v[60:63], v12 offset:61440
    v_add_u32 v12, 0x4000, v12
    v_mfma_f32_16x16x32_bf16 v[88:91], v[32:35], v[100:103], v[252:255]
    s_waitcnt lgkmcnt(6)
    s_barrier
    v_exp_f32 v64, v64
    v_exp_f32 v65, v65
    v_mfma_f32_16x16x32_bf16 v[84:87], v[36:39], v[96:99], v[248:251]
    ds_read_b128 v[32:35], v9 offset:49152
    v_cvt_pk_bf16_f32 v224, v64, v65
    v_mfma_f32_16x16x32_bf16 v[92:95], v[36:39], v[100:103], v[252:255]
    v_exp_f32 v66, v66
    v_mfma_f32_16x16x32_bf16 v[24:27], v[20:23], v[216:219], v[24:27]
    s_waitcnt lgkmcnt(6)
    v_exp_f32 v67, v67
    v_mfma_f32_16x16x32_bf16 v[80:83], v[40:43], v[104:107], v[80:83]
    ds_read_b128 v[36:39], v9 offset:53248
    v_cvt_pk_bf16_f32 v225, v66, v67
    v_mfma_f32_16x16x32_bf16 v[88:91], v[40:43], v[108:111], v[88:91]
    s_waitcnt lgkmcnt(6)
    v_exp_f32 v68, v68
    v_exp_f32 v69, v69
    v_mfma_f32_16x16x32_bf16 v[84:87], v[44:47], v[104:107], v[84:87]
    ds_read_b128 v[40:43], v10 offset:49152
    v_cvt_pk_bf16_f32 v226, v68, v69
    v_mfma_f32_16x16x32_bf16 v[92:95], v[44:47], v[108:111], v[92:95]
    s_waitcnt lgkmcnt(6)
    v_exp_f32 v70, v70
    v_exp_f32 v71, v71
    v_mfma_f32_16x16x32_bf16 v[80:83], v[48:51], v[112:115], v[80:83]
    ds_read_b128 v[44:47], v10 offset:53248
    v_cvt_pk_bf16_f32 v227, v70, v71
    v_mfma_f32_16x16x32_bf16 v[88:91], v[48:51], v[116:119], v[88:91]
    s_waitcnt lgkmcnt(6)
    v_exp_f32 v72, v72
    v_exp_f32 v73, v73
    v_mfma_f32_16x16x32_bf16 v[84:87], v[52:55], v[112:115], v[84:87]
    ds_read_b128 v[48:51], v11 offset:49152
    v_cvt_pk_bf16_f32 v228, v72, v73
    v_mfma_f32_16x16x32_bf16 v[92:95], v[52:55], v[116:119], v[92:95]
    v_exp_f32 v74, v74
    v_mfma_f32_16x16x32_bf16 v[28:31], v[20:23], v[220:223], v[28:31]
    s_waitcnt lgkmcnt(6)
    v_exp_f32 v75, v75
    v_mfma_f32_16x16x32_bf16 v[80:83], v[56:59], v[120:123], v[80:83]
    ds_read_b128 v[52:55], v11 offset:53248
    v_cvt_pk_bf16_f32 v229, v74, v75
    v_mfma_f32_16x16x32_bf16 v[88:91], v[56:59], v[124:127], v[88:91]
    s_waitcnt lgkmcnt(6)
    v_exp_f32 v76, v76
    v_exp_f32 v77, v77
    v_mfma_f32_16x16x32_bf16 v[84:87], v[60:63], v[120:123], v[84:87]
    ds_read_b128 v[56:59], v12 offset:49152
    v_cvt_pk_bf16_f32 v230, v76, v77
    v_mfma_f32_16x16x32_bf16 v[92:95], v[60:63], v[124:127], v[92:95]
    s_waitcnt lgkmcnt(6)
    v_exp_f32 v78, v78
    v_exp_f32 v79, v79
    s_nop 0
    v_cvt_pk_bf16_f32 v231, v78, v79
    v_mfma_f32_16x16x32_bf16 v[64:67], v[32:35], v[96:99], v[248:251]
    ds_read_b128 v[60:63], v12 offset:53248
    v_mfma_f32_16x16x32_bf16 v[72:75], v[32:35], v[100:103], v[252:255]
    s_waitcnt lgkmcnt(6)
    v_exp_f32 v80, v80
    v_exp_f32 v81, v81
    v_mfma_f32_16x16x32_bf16 v[68:71], v[36:39], v[96:99], v[248:251]
    ds_read_b128 v[32:35], v9 offset:57344
    v_cvt_pk_bf16_f32 v232, v80, v81
    v_mfma_f32_16x16x32_bf16 v[76:79], v[36:39], v[100:103], v[252:255]
    v_exp_f32 v82, v82
    v_mfma_f32_16x16x32_bf16 v[24:27], v[20:23], v[224:227], v[24:27]
    s_waitcnt lgkmcnt(6)
    v_exp_f32 v83, v83
    v_mfma_f32_16x16x32_bf16 v[64:67], v[40:43], v[104:107], v[64:67]
    ds_read_b128 v[36:39], v9 offset:61440
    v_cvt_pk_bf16_f32 v233, v82, v83
    v_mfma_f32_16x16x32_bf16 v[72:75], v[40:43], v[108:111], v[72:75]
    s_waitcnt lgkmcnt(6)
    v_exp_f32 v84, v84
    v_exp_f32 v85, v85
    v_mfma_f32_16x16x32_bf16 v[68:71], v[44:47], v[104:107], v[68:71]
    ds_read_b128 v[40:43], v10 offset:57344
    v_cvt_pk_bf16_f32 v234, v84, v85
    v_mfma_f32_16x16x32_bf16 v[76:79], v[44:47], v[108:111], v[76:79]
    s_waitcnt lgkmcnt(6)
    v_exp_f32 v86, v86
    v_exp_f32 v87, v87
    v_mfma_f32_16x16x32_bf16 v[64:67], v[48:51], v[112:115], v[64:67]
    ds_read_b128 v[44:47], v10 offset:61440
    v_cvt_pk_bf16_f32 v235, v86, v87
    v_mfma_f32_16x16x32_bf16 v[72:75], v[48:51], v[116:119], v[72:75]
    s_waitcnt lgkmcnt(6)
    v_exp_f32 v88, v88
    v_exp_f32 v89, v89
    v_mfma_f32_16x16x32_bf16 v[68:71], v[52:55], v[112:115], v[68:71]
    ds_read_b128 v[48:51], v11 offset:57344
    v_cvt_pk_bf16_f32 v236, v88, v89
    v_mfma_f32_16x16x32_bf16 v[76:79], v[52:55], v[116:119], v[76:79]
    v_exp_f32 v90, v90
    v_mfma_f32_16x16x32_bf16 v[28:31], v[20:23], v[228:231], v[28:31]
    s_waitcnt lgkmcnt(6)
    v_exp_f32 v91, v91
    v_mfma_f32_16x16x32_bf16 v[64:67], v[56:59], v[120:123], v[64:67]
    ds_read_b128 v[52:55], v11 offset:61440
    v_cvt_pk_bf16_f32 v237, v90, v91
    v_mfma_f32_16x16x32_bf16 v[72:75], v[56:59], v[124:127], v[72:75]
    s_waitcnt lgkmcnt(6)
    v_exp_f32 v92, v92
    v_exp_f32 v93, v93
    v_mfma_f32_16x16x32_bf16 v[68:71], v[60:63], v[120:123], v[68:71]
    ds_read_b128 v[56:59], v12 offset:57344
    v_cvt_pk_bf16_f32 v238, v92, v93
    v_mfma_f32_16x16x32_bf16 v[76:79], v[60:63], v[124:127], v[76:79]
    s_waitcnt lgkmcnt(6)
    v_exp_f32 v94, v94
    v_exp_f32 v95, v95
    s_nop 0
    v_cvt_pk_bf16_f32 v239, v94, v95
    v_mfma_f32_16x16x32_bf16 v[80:83], v[32:35], v[96:99], v[248:251]
    ds_read_b128 v[60:63], v12 offset:61440
    v_mfma_f32_16x16x32_bf16 v[88:91], v[32:35], v[100:103], v[252:255]
    s_waitcnt lgkmcnt(6)
    s_barrier
    v_exp_f32 v64, v64
    v_exp_f32 v65, v65
    v_mfma_f32_16x16x32_bf16 v[84:87], v[36:39], v[96:99], v[248:251]
    ds_read_b64_tr_b16 v[32:33], v13
    v_cvt_pk_bf16_f32 v240, v64, v65
    v_mfma_f32_16x16x32_bf16 v[92:95], v[36:39], v[100:103], v[252:255]
    ds_read_b64_tr_b16 v[34:35], v13 offset:2048
    v_exp_f32 v66, v66
    v_mfma_f32_16x16x32_bf16 v[24:27], v[20:23], v[232:235], v[24:27]
    s_waitcnt lgkmcnt(7)
    v_exp_f32 v67, v67
    v_mfma_f32_16x16x32_bf16 v[80:83], v[40:43], v[104:107], v[80:83]
    ds_read_b64_tr_b16 v[36:37], v14
    v_cvt_pk_bf16_f32 v241, v66, v67
    v_mfma_f32_16x16x32_bf16 v[88:91], v[40:43], v[108:111], v[88:91]
    s_waitcnt lgkmcnt(7)
    ds_read_b64_tr_b16 v[38:39], v14 offset:2048
    v_exp_f32 v68, v68
    v_exp_f32 v69, v69
    v_mfma_f32_16x16x32_bf16 v[84:87], v[44:47], v[104:107], v[84:87]
    ds_read_b64_tr_b16 v[40:41], v15
    v_cvt_pk_bf16_f32 v242, v68, v69
    v_mfma_f32_16x16x32_bf16 v[92:95], v[44:47], v[108:111], v[92:95]
    s_waitcnt lgkmcnt(8)
    ds_read_b64_tr_b16 v[42:43], v15 offset:2048
    v_exp_f32 v70, v70
    v_exp_f32 v71, v71
    v_mfma_f32_16x16x32_bf16 v[80:83], v[48:51], v[112:115], v[80:83]
    ds_read_b64_tr_b16 v[44:45], v16
    v_cvt_pk_bf16_f32 v243, v70, v71
    v_mfma_f32_16x16x32_bf16 v[88:91], v[48:51], v[116:119], v[88:91]
    s_waitcnt lgkmcnt(9)
    ds_read_b64_tr_b16 v[46:47], v16 offset:2048
    v_exp_f32 v72, v72
    v_exp_f32 v73, v73
    v_mfma_f32_16x16x32_bf16 v[84:87], v[52:55], v[112:115], v[84:87]
    ds_read_b64_tr_b16 v[48:49], v13 offset:4096
    v_cvt_pk_bf16_f32 v244, v72, v73
    v_mfma_f32_16x16x32_bf16 v[92:95], v[52:55], v[116:119], v[92:95]
    ds_read_b64_tr_b16 v[50:51], v13 offset:6144
    v_exp_f32 v74, v74
    v_mfma_f32_16x16x32_bf16 v[28:31], v[20:23], v[236:239], v[28:31]
    s_waitcnt lgkmcnt(11)
    v_exp_f32 v75, v75
    v_mfma_f32_16x16x32_bf16 v[80:83], v[56:59], v[120:123], v[80:83]
    ds_read_b64_tr_b16 v[52:53], v14 offset:4096
    v_cvt_pk_bf16_f32 v245, v74, v75
    v_mfma_f32_16x16x32_bf16 v[88:91], v[56:59], v[124:127], v[88:91]
    s_waitcnt lgkmcnt(11)
    ds_read_b64_tr_b16 v[54:55], v14 offset:6144
    v_exp_f32 v76, v76
    v_exp_f32 v77, v77
    v_mfma_f32_16x16x32_bf16 v[84:87], v[60:63], v[120:123], v[84:87]
    ds_read_b64_tr_b16 v[56:57], v15 offset:4096
    v_cvt_pk_bf16_f32 v246, v76, v77
    v_mfma_f32_16x16x32_bf16 v[92:95], v[60:63], v[124:127], v[92:95]
    s_waitcnt lgkmcnt(11)
    ds_read_b64_tr_b16 v[58:59], v15 offset:6144
    v_exp_f32 v78, v78
    v_exp_f32 v79, v79
    s_nop 0
    v_cvt_pk_bf16_f32 v247, v78, v79
    v_mfma_f32_16x16x32_bf16 v[96:99], v[32:35], v[128:131], 0
    ds_read_b64_tr_b16 v[60:61], v16 offset:4096
    v_mfma_f32_16x16x32_bf16 v[24:27], v[20:23], v[240:243], v[24:27]
    v_mfma_f32_16x16x32_bf16 v[28:31], v[20:23], v[244:247], v[28:31]
    v_mfma_f32_16x16x32_bf16 v[104:107], v[32:35], v[132:135], 0
    s_waitcnt lgkmcnt(11)
    ds_read_b64_tr_b16 v[62:63], v16 offset:6144
    v_exp_f32 v80, v80
    v_mfma_f32_16x16x32_bf16 v[100:103], v[36:39], v[128:131], 0
    ds_read_b64_tr_b16 v[32:33], v13 offset:8192
    v_exp_f32 v81, v81
    v_mfma_f32_16x16x32_bf16 v[108:111], v[36:39], v[132:135], 0
    s_waitcnt lgkmcnt(11)
    ds_read_b64_tr_b16 v[34:35], v13 offset:10240
    v_mfma_f32_16x16x32_bf16 v[112:115], v[40:43], v[128:131], 0
    ds_read_b64_tr_b16 v[36:37], v14 offset:8192
    v_exp_f32 v82, v82
    v_mfma_f32_16x16x32_bf16 v[120:123], v[40:43], v[132:135], 0
    s_waitcnt lgkmcnt(11)
    ds_read_b64_tr_b16 v[38:39], v14 offset:10240
    v_mfma_f32_16x16x32_bf16 v[116:119], v[44:47], v[128:131], 0
    ds_read_b64_tr_b16 v[40:41], v15 offset:8192
    v_exp_f32 v83, v83
    v_mfma_f32_16x16x32_bf16 v[124:127], v[44:47], v[132:135], 0
    s_waitcnt lgkmcnt(11)
    ds_read_b64_tr_b16 v[42:43], v15 offset:10240
    v_cvt_pk_bf16_f32 v248, v80, v81
    v_mfma_f32_16x16x32_bf16 v[96:99], v[48:51], v[136:139], v[96:99]
    ds_read_b64_tr_b16 v[44:45], v16 offset:8192
    v_mfma_f32_16x16x32_bf16 v[104:107], v[48:51], v[140:143], v[104:107]
    s_waitcnt lgkmcnt(11)
    ds_read_b64_tr_b16 v[46:47], v16 offset:10240
    v_exp_f32 v84, v84
    v_mfma_f32_16x16x32_bf16 v[100:103], v[52:55], v[136:139], v[100:103]
    ds_read_b64_tr_b16 v[48:49], v13 offset:12288
    v_mfma_f32_16x16x32_bf16 v[108:111], v[52:55], v[140:143], v[108:111]
    s_waitcnt lgkmcnt(11)
    ds_read_b64_tr_b16 v[50:51], v13 offset:14336
    v_add_u32 v13, 0xffffc000, v13
    v_exp_f32 v85, v85
    v_mfma_f32_16x16x32_bf16 v[112:115], v[56:59], v[136:139], v[112:115]
    ds_read_b64_tr_b16 v[52:53], v14 offset:12288
    v_cvt_pk_bf16_f32 v249, v82, v83
    v_mfma_f32_16x16x32_bf16 v[120:123], v[56:59], v[140:143], v[120:123]
    s_waitcnt lgkmcnt(11)
    ds_read_b64_tr_b16 v[54:55], v14 offset:14336
    v_add_u32 v14, 0xffffc000, v14
    v_mfma_f32_16x16x32_bf16 v[116:119], v[60:63], v[136:139], v[116:119]
    ds_read_b64_tr_b16 v[56:57], v15 offset:12288
    v_exp_f32 v86, v86
    v_mfma_f32_16x16x32_bf16 v[124:127], v[60:63], v[140:143], v[124:127]
    s_waitcnt lgkmcnt(11)
    ds_read_b64_tr_b16 v[58:59], v15 offset:14336
    v_add_u32 v15, 0xffffc000, v15
    v_mfma_f32_16x16x32_bf16 v[96:99], v[32:35], v[144:147], v[96:99]
    ds_read_b64_tr_b16 v[60:61], v16 offset:12288
    v_exp_f32 v87, v87
    v_mfma_f32_16x16x32_bf16 v[104:107], v[32:35], v[148:151], v[104:107]
    s_waitcnt lgkmcnt(11)
    ds_read_b64_tr_b16 v[62:63], v16 offset:14336
    v_add_u32 v16, 0xffffc000, v16
    s_barrier
    v_cvt_pk_bf16_f32 v250, v84, v85
    v_mfma_f32_16x16x32_bf16 v[100:103], v[36:39], v[144:147], v[100:103]
    ds_read_b64_tr_b16 v[32:33], v13
    v_mfma_f32_16x16x32_bf16 v[108:111], v[36:39], v[148:151], v[108:111]
    s_waitcnt lgkmcnt(11)
    ds_read_b64_tr_b16 v[34:35], v13 offset:2048
    v_exp_f32 v88, v88
    v_mfma_f32_16x16x32_bf16 v[112:115], v[40:43], v[144:147], v[112:115]
    ds_read_b64_tr_b16 v[36:37], v14
    v_mfma_f32_16x16x32_bf16 v[120:123], v[40:43], v[148:151], v[120:123]
    s_waitcnt lgkmcnt(11)
    ds_read_b64_tr_b16 v[38:39], v14 offset:2048
    v_exp_f32 v89, v89
    v_mfma_f32_16x16x32_bf16 v[116:119], v[44:47], v[144:147], v[116:119]
    ds_read_b64_tr_b16 v[40:41], v15
    v_cvt_pk_bf16_f32 v251, v86, v87
    v_mfma_f32_16x16x32_bf16 v[124:127], v[44:47], v[148:151], v[124:127]
    s_waitcnt lgkmcnt(11)
    ds_read_b64_tr_b16 v[42:43], v15 offset:2048
    v_mfma_f32_16x16x32_bf16 v[96:99], v[48:51], v[152:155], v[96:99]
    ds_read_b64_tr_b16 v[44:45], v16
    v_exp_f32 v90, v90
    v_mfma_f32_16x16x32_bf16 v[104:107], v[48:51], v[156:159], v[104:107]
    s_waitcnt lgkmcnt(11)
    ds_read_b64_tr_b16 v[46:47], v16 offset:2048
    v_mfma_f32_16x16x32_bf16 v[100:103], v[52:55], v[152:155], v[100:103]
    ds_read_b64_tr_b16 v[48:49], v13 offset:4096
    v_exp_f32 v91, v91
    v_mfma_f32_16x16x32_bf16 v[108:111], v[52:55], v[156:159], v[108:111]
    s_waitcnt lgkmcnt(11)
    ds_read_b64_tr_b16 v[50:51], v13 offset:6144
    v_cvt_pk_bf16_f32 v252, v88, v89
    v_mfma_f32_16x16x32_bf16 v[112:115], v[56:59], v[152:155], v[112:115]
    ds_read_b64_tr_b16 v[52:53], v14 offset:4096
    v_mfma_f32_16x16x32_bf16 v[120:123], v[56:59], v[156:159], v[120:123]
    s_waitcnt lgkmcnt(11)
    ds_read_b64_tr_b16 v[54:55], v14 offset:6144
    v_exp_f32 v92, v92
    v_mfma_f32_16x16x32_bf16 v[116:119], v[60:63], v[152:155], v[116:119]
    ds_read_b64_tr_b16 v[56:57], v15 offset:4096
    v_mfma_f32_16x16x32_bf16 v[124:127], v[60:63], v[156:159], v[124:127]
    s_waitcnt lgkmcnt(11)
    ds_read_b64_tr_b16 v[58:59], v15 offset:6144
    v_exp_f32 v93, v93
    v_mfma_f32_16x16x32_bf16 v[96:99], v[32:35], v[160:163], v[96:99]
    ds_read_b64_tr_b16 v[60:61], v16 offset:4096
    v_cvt_pk_bf16_f32 v253, v90, v91
    v_mfma_f32_16x16x32_bf16 v[104:107], v[32:35], v[164:167], v[104:107]
    s_waitcnt lgkmcnt(11)
    ds_read_b64_tr_b16 v[62:63], v16 offset:6144
    v_mfma_f32_16x16x32_bf16 v[100:103], v[36:39], v[160:163], v[100:103]
    ds_read_b64_tr_b16 v[32:33], v13 offset:8192
    v_exp_f32 v94, v94
    v_mfma_f32_16x16x32_bf16 v[108:111], v[36:39], v[164:167], v[108:111]
    s_waitcnt lgkmcnt(11)
    ds_read_b64_tr_b16 v[34:35], v13 offset:10240
    v_mfma_f32_16x16x32_bf16 v[112:115], v[40:43], v[160:163], v[112:115]
    ds_read_b64_tr_b16 v[36:37], v14 offset:8192
    v_exp_f32 v95, v95
    v_mfma_f32_16x16x32_bf16 v[120:123], v[40:43], v[164:167], v[120:123]
    s_waitcnt lgkmcnt(11)
    ds_read_b64_tr_b16 v[38:39], v14 offset:10240
    v_cvt_pk_bf16_f32 v254, v92, v93
    v_mfma_f32_16x16x32_bf16 v[116:119], v[44:47], v[160:163], v[116:119]
    ds_read_b64_tr_b16 v[40:41], v15 offset:8192
    v_mfma_f32_16x16x32_bf16 v[124:127], v[44:47], v[164:167], v[124:127]
    s_waitcnt lgkmcnt(11)
    ds_read_b64_tr_b16 v[42:43], v15 offset:10240
    v_cvt_pk_bf16_f32 v255, v94, v95
    v_mfma_f32_16x16x32_bf16 v[96:99], v[48:51], v[168:171], v[96:99]
    ds_read_b64_tr_b16 v[44:45], v16 offset:8192
    v_mfma_f32_16x16x32_bf16 v[104:107], v[48:51], v[172:175], v[104:107]
    s_waitcnt lgkmcnt(11)
    ds_read_b64_tr_b16 v[46:47], v16 offset:10240
    v_mfma_f32_16x16x32_bf16 v[100:103], v[52:55], v[168:171], v[100:103]
    ds_read_b64_tr_b16 v[48:49], v13 offset:12288
    v_mfma_f32_16x16x32_bf16 v[108:111], v[52:55], v[172:175], v[108:111]
    ds_read_b64_tr_b16 v[50:51], v13 offset:14336
    v_mfma_f32_16x16x32_bf16 v[24:27], v[20:23], v[248:251], v[24:27]
    v_mfma_f32_16x16x32_bf16 v[28:31], v[20:23], v[252:255], v[28:31]
    s_waitcnt lgkmcnt(12)
    v_mfma_f32_16x16x32_bf16 v[112:115], v[56:59], v[168:171], v[112:115]
    ds_read_b64_tr_b16 v[52:53], v14 offset:12288
    v_mfma_f32_16x16x32_bf16 v[120:123], v[56:59], v[172:175], v[120:123]
    s_waitcnt lgkmcnt(11)
    ds_read_b64_tr_b16 v[54:55], v14 offset:14336
    v_mfma_f32_16x16x32_bf16 v[116:119], v[60:63], v[168:171], v[116:119]
    ds_read_b64_tr_b16 v[56:57], v15 offset:12288
    v_mfma_f32_16x16x32_bf16 v[124:127], v[60:63], v[172:175], v[124:127]
    s_waitcnt lgkmcnt(11)
    ds_read_b64_tr_b16 v[58:59], v15 offset:14336
    v_mfma_f32_16x16x32_bf16 v[96:99], v[32:35], v[176:179], v[96:99]
    ds_read_b64_tr_b16 v[60:61], v16 offset:12288
    v_rcp_f32 v18, v24
    v_mfma_f32_16x16x32_bf16 v[104:107], v[32:35], v[180:183], v[104:107]
    s_waitcnt lgkmcnt(11)
    ds_read_b64_tr_b16 v[62:63], v16 offset:14336
    s_barrier
    v_rcp_f32 v19, v28
    v_mfma_f32_16x16x32_bf16 v[100:103], v[36:39], v[176:179], v[100:103]
    ds_read_b64_tr_b16 v[32:33], v13 offset:32768
    v_add_f32 v24, v24, v28
    v_mfma_f32_16x16x32_bf16 v[108:111], v[36:39], v[180:183], v[108:111]
    s_waitcnt lgkmcnt(11)
    ds_read_b64_tr_b16 v[34:35], v13 offset:34816
    v_mov_b32 v10, 0x4b800000
    v_mfma_f32_16x16x32_bf16 v[112:115], v[40:43], v[176:179], v[112:115]
    ds_read_b64_tr_b16 v[36:37], v14 offset:32768
    v_cmp_nle_f32 vcc, v24, v10
    v_mfma_f32_16x16x32_bf16 v[120:123], v[40:43], v[180:183], v[120:123]
    s_waitcnt lgkmcnt(11)
    ds_read_b64_tr_b16 v[38:39], v14 offset:34816
    s_cmp_lg_u64 vcc, 0
    v_mfma_f32_16x16x32_bf16 v[116:119], v[44:47], v[176:179], v[116:119]
    ds_read_b64_tr_b16 v[40:41], v15 offset:32768
    v_mfma_f32_16x16x32_bf16 v[124:127], v[44:47], v[180:183], v[124:127]
    s_waitcnt lgkmcnt(11)
    ds_read_b64_tr_b16 v[42:43], v15 offset:34816
    s_cselect_b32 s5, 1, 0
    v_mfma_f32_16x16x32_bf16 v[96:99], v[48:51], v[184:187], v[96:99]
    ds_read_b64_tr_b16 v[44:45], v16 offset:32768
    s_lshl_b32 s6, s3, 2
    v_mfma_f32_16x16x32_bf16 v[104:107], v[48:51], v[188:191], v[104:107]
    s_waitcnt lgkmcnt(11)
    ds_read_b64_tr_b16 v[46:47], v16 offset:34816
    v_mov_b32 v9, s6
    v_mfma_f32_16x16x32_bf16 v[100:103], v[52:55], v[184:187], v[100:103]
    ds_read_b64_tr_b16 v[48:49], v13 offset:36864
    v_mov_b32 v10, s5
    v_mfma_f32_16x16x32_bf16 v[108:111], v[52:55], v[188:191], v[108:111]
    s_waitcnt lgkmcnt(11)
    ds_read_b64_tr_b16 v[50:51], v13 offset:38912
    ds_write_b32 v9, v10 offset:28672
    v_mfma_f32_16x16x32_bf16 v[112:115], v[56:59], v[184:187], v[112:115]
    ds_read_b64_tr_b16 v[52:53], v14 offset:36864
    v_mfma_f32_16x16x32_bf16 v[120:123], v[56:59], v[188:191], v[120:123]
    s_waitcnt lgkmcnt(12)
    ds_read_b64_tr_b16 v[54:55], v14 offset:38912
    v_mfma_f32_16x16x32_bf16 v[116:119], v[60:63], v[184:187], v[116:119]
    ds_read_b64_tr_b16 v[56:57], v15 offset:36864
    v_mfma_f32_16x16x32_bf16 v[124:127], v[60:63], v[188:191], v[124:127]
    s_waitcnt lgkmcnt(12)
    ds_read_b64_tr_b16 v[58:59], v15 offset:38912
    v_mfma_f32_16x16x32_bf16 v[96:99], v[32:35], v[192:195], v[96:99]
    ds_read_b64_tr_b16 v[60:61], v16 offset:36864
    v_mfma_f32_16x16x32_bf16 v[104:107], v[32:35], v[196:199], v[104:107]
    s_waitcnt lgkmcnt(12)
    ds_read_b64_tr_b16 v[62:63], v16 offset:38912
    v_mfma_f32_16x16x32_bf16 v[100:103], v[36:39], v[192:195], v[100:103]
    ds_read_b64_tr_b16 v[32:33], v13 offset:40960
    v_mfma_f32_16x16x32_bf16 v[108:111], v[36:39], v[196:199], v[108:111]
    s_waitcnt lgkmcnt(12)
    ds_read_b64_tr_b16 v[34:35], v13 offset:43008
    v_mfma_f32_16x16x32_bf16 v[112:115], v[40:43], v[192:195], v[112:115]
    ds_read_b64_tr_b16 v[36:37], v14 offset:40960
    v_mfma_f32_16x16x32_bf16 v[120:123], v[40:43], v[196:199], v[120:123]
    s_waitcnt lgkmcnt(12)
    ds_read_b64_tr_b16 v[38:39], v14 offset:43008
    v_mfma_f32_16x16x32_bf16 v[116:119], v[44:47], v[192:195], v[116:119]
    ds_read_b64_tr_b16 v[40:41], v15 offset:40960
    v_mfma_f32_16x16x32_bf16 v[124:127], v[44:47], v[196:199], v[124:127]
    s_waitcnt lgkmcnt(12)
    ds_read_b64_tr_b16 v[42:43], v15 offset:43008
    v_mfma_f32_16x16x32_bf16 v[96:99], v[48:51], v[200:203], v[96:99]
    ds_read_b64_tr_b16 v[44:45], v16 offset:40960
    v_mfma_f32_16x16x32_bf16 v[104:107], v[48:51], v[204:207], v[104:107]
    s_waitcnt lgkmcnt(11)
    ds_read_b64_tr_b16 v[46:47], v16 offset:43008
    v_mfma_f32_16x16x32_bf16 v[100:103], v[52:55], v[200:203], v[100:103]
    ds_read_b64_tr_b16 v[48:49], v13 offset:45056
    v_mfma_f32_16x16x32_bf16 v[108:111], v[52:55], v[204:207], v[108:111]
    s_waitcnt lgkmcnt(11)
    ds_read_b64_tr_b16 v[50:51], v13 offset:47104
    v_mfma_f32_16x16x32_bf16 v[112:115], v[56:59], v[200:203], v[112:115]
    ds_read_b64_tr_b16 v[52:53], v14 offset:45056
    v_mfma_f32_16x16x32_bf16 v[120:123], v[56:59], v[204:207], v[120:123]
    s_waitcnt lgkmcnt(11)
    ds_read_b64_tr_b16 v[54:55], v14 offset:47104
    v_mfma_f32_16x16x32_bf16 v[116:119], v[60:63], v[200:203], v[116:119]
    ds_read_b64_tr_b16 v[56:57], v15 offset:45056
    v_mfma_f32_16x16x32_bf16 v[124:127], v[60:63], v[204:207], v[124:127]
    s_waitcnt lgkmcnt(11)
    ds_read_b64_tr_b16 v[58:59], v15 offset:47104
    v_mfma_f32_16x16x32_bf16 v[96:99], v[32:35], v[208:211], v[96:99]
    ds_read_b64_tr_b16 v[60:61], v16 offset:45056
    v_mfma_f32_16x16x32_bf16 v[104:107], v[32:35], v[212:215], v[104:107]
    s_waitcnt lgkmcnt(11)
    ds_read_b64_tr_b16 v[62:63], v16 offset:47104
    s_barrier
    v_mfma_f32_16x16x32_bf16 v[100:103], v[36:39], v[208:211], v[100:103]
    ds_read_b64_tr_b16 v[32:33], v13 offset:49152
    v_mfma_f32_16x16x32_bf16 v[108:111], v[36:39], v[212:215], v[108:111]
    s_waitcnt lgkmcnt(11)
    ds_read_b64_tr_b16 v[34:35], v13 offset:51200
    v_mfma_f32_16x16x32_bf16 v[112:115], v[40:43], v[208:211], v[112:115]
    ds_read_b64_tr_b16 v[36:37], v14 offset:49152
    v_mfma_f32_16x16x32_bf16 v[120:123], v[40:43], v[212:215], v[120:123]
    s_waitcnt lgkmcnt(11)
    ds_read_b64_tr_b16 v[38:39], v14 offset:51200
    v_mfma_f32_16x16x32_bf16 v[116:119], v[44:47], v[208:211], v[116:119]
    ds_read_b64_tr_b16 v[40:41], v15 offset:49152
    v_mfma_f32_16x16x32_bf16 v[124:127], v[44:47], v[212:215], v[124:127]
    s_waitcnt lgkmcnt(11)
    ds_read_b64_tr_b16 v[42:43], v15 offset:51200
    v_mfma_f32_16x16x32_bf16 v[96:99], v[48:51], v[216:219], v[96:99]
    ds_read_b64_tr_b16 v[44:45], v16 offset:49152
    v_mfma_f32_16x16x32_bf16 v[104:107], v[48:51], v[220:223], v[104:107]
    s_waitcnt lgkmcnt(11)
    ds_read_b64_tr_b16 v[46:47], v16 offset:51200
    v_mfma_f32_16x16x32_bf16 v[100:103], v[52:55], v[216:219], v[100:103]
    ds_read_b64_tr_b16 v[48:49], v13 offset:53248
    v_mfma_f32_16x16x32_bf16 v[108:111], v[52:55], v[220:223], v[108:111]
    s_waitcnt lgkmcnt(11)
    ds_read_b64_tr_b16 v[50:51], v13 offset:55296
    v_mfma_f32_16x16x32_bf16 v[112:115], v[56:59], v[216:219], v[112:115]
    ds_read_b64_tr_b16 v[52:53], v14 offset:53248
    v_mfma_f32_16x16x32_bf16 v[120:123], v[56:59], v[220:223], v[120:123]
    s_waitcnt lgkmcnt(11)
    ds_read_b64_tr_b16 v[54:55], v14 offset:55296
    v_mfma_f32_16x16x32_bf16 v[116:119], v[60:63], v[216:219], v[116:119]
    ds_read_b64_tr_b16 v[56:57], v15 offset:53248
    v_mfma_f32_16x16x32_bf16 v[124:127], v[60:63], v[220:223], v[124:127]
    s_waitcnt lgkmcnt(11)
    ds_read_b64_tr_b16 v[58:59], v15 offset:55296
    v_mfma_f32_16x16x32_bf16 v[96:99], v[32:35], v[224:227], v[96:99]
    ds_read_b64_tr_b16 v[60:61], v16 offset:53248
    v_mfma_f32_16x16x32_bf16 v[104:107], v[32:35], v[228:231], v[104:107]
    s_waitcnt lgkmcnt(11)
    ds_read_b64_tr_b16 v[62:63], v16 offset:55296
    v_mfma_f32_16x16x32_bf16 v[100:103], v[36:39], v[224:227], v[100:103]
    ds_read_b64_tr_b16 v[32:33], v13 offset:57344
    v_mfma_f32_16x16x32_bf16 v[108:111], v[36:39], v[228:231], v[108:111]
    s_waitcnt lgkmcnt(11)
    ds_read_b64_tr_b16 v[34:35], v13 offset:59392
    v_mfma_f32_16x16x32_bf16 v[112:115], v[40:43], v[224:227], v[112:115]
    ds_read_b64_tr_b16 v[36:37], v14 offset:57344
    v_mfma_f32_16x16x32_bf16 v[120:123], v[40:43], v[228:231], v[120:123]
    s_waitcnt lgkmcnt(11)
    ds_read_b64_tr_b16 v[38:39], v14 offset:59392
    v_mfma_f32_16x16x32_bf16 v[116:119], v[44:47], v[224:227], v[116:119]
    ds_read_b64_tr_b16 v[40:41], v15 offset:57344
    v_mfma_f32_16x16x32_bf16 v[124:127], v[44:47], v[228:231], v[124:127]
    s_waitcnt lgkmcnt(11)
    ds_read_b64_tr_b16 v[42:43], v15 offset:59392
    v_mfma_f32_16x16x32_bf16 v[96:99], v[48:51], v[232:235], v[96:99]
    ds_read_b64_tr_b16 v[44:45], v16 offset:57344
    v_mfma_f32_16x16x32_bf16 v[104:107], v[48:51], v[236:239], v[104:107]
    s_waitcnt lgkmcnt(11)
    ds_read_b64_tr_b16 v[46:47], v16 offset:59392
    v_mfma_f32_16x16x32_bf16 v[100:103], v[52:55], v[232:235], v[100:103]
    ds_read_b64_tr_b16 v[48:49], v13 offset:61440
    v_mfma_f32_16x16x32_bf16 v[108:111], v[52:55], v[236:239], v[108:111]
    s_waitcnt lgkmcnt(11)
    ds_read_b64_tr_b16 v[50:51], v13 offset:63488
    v_add_u32 v13, 0x4000, v13
    v_mfma_f32_16x16x32_bf16 v[112:115], v[56:59], v[232:235], v[112:115]
    ds_read_b64_tr_b16 v[52:53], v14 offset:61440
    v_mfma_f32_16x16x32_bf16 v[120:123], v[56:59], v[236:239], v[120:123]
    s_waitcnt lgkmcnt(11)
    ds_read_b64_tr_b16 v[54:55], v14 offset:63488
    v_add_u32 v14, 0x4000, v14
    v_mfma_f32_16x16x32_bf16 v[116:119], v[60:63], v[232:235], v[116:119]
    ds_read_b64_tr_b16 v[56:57], v15 offset:61440
    v_mfma_f32_16x16x32_bf16 v[124:127], v[60:63], v[236:239], v[124:127]
    s_waitcnt lgkmcnt(11)
    ds_read_b64_tr_b16 v[58:59], v15 offset:63488
    v_add_u32 v15, 0x4000, v15
    v_mfma_f32_16x16x32_bf16 v[96:99], v[32:35], v[240:243], v[96:99]
    ds_read_b64_tr_b16 v[60:61], v16 offset:61440
    v_mfma_f32_16x16x32_bf16 v[104:107], v[32:35], v[244:247], v[104:107]
    s_waitcnt lgkmcnt(11)
    ds_read_b64_tr_b16 v[62:63], v16 offset:63488
    v_add_u32 v16, 0x4000, v16
    s_barrier
    v_mfma_f32_16x16x32_bf16 v[100:103], v[36:39], v[240:243], v[100:103]
    ds_read_b64_tr_b16 v[32:33], v13 offset:49152
    v_mfma_f32_16x16x32_bf16 v[108:111], v[36:39], v[244:247], v[108:111]
    s_waitcnt lgkmcnt(11)
    ds_read_b64_tr_b16 v[34:35], v13 offset:51200
    v_mfma_f32_16x16x32_bf16 v[112:115], v[40:43], v[240:243], v[112:115]
    ds_read_b64_tr_b16 v[36:37], v14 offset:49152
    v_mfma_f32_16x16x32_bf16 v[120:123], v[40:43], v[244:247], v[120:123]
    s_waitcnt lgkmcnt(11)
    ds_read_b64_tr_b16 v[38:39], v14 offset:51200
    v_mfma_f32_16x16x32_bf16 v[116:119], v[44:47], v[240:243], v[116:119]
    ds_read_b64_tr_b16 v[40:41], v15 offset:49152
    v_mfma_f32_16x16x32_bf16 v[124:127], v[44:47], v[244:247], v[124:127]
    s_waitcnt lgkmcnt(11)
    ds_read_b64_tr_b16 v[42:43], v15 offset:51200
    v_mfma_f32_16x16x32_bf16 v[96:99], v[48:51], v[248:251], v[96:99]
    ds_read_b64_tr_b16 v[44:45], v16 offset:49152
    v_mfma_f32_16x16x32_bf16 v[104:107], v[48:51], v[252:255], v[104:107]
    s_waitcnt lgkmcnt(11)
    ds_read_b64_tr_b16 v[46:47], v16 offset:51200
    v_mfma_f32_16x16x32_bf16 v[100:103], v[52:55], v[248:251], v[100:103]
    ds_read_b64_tr_b16 v[48:49], v13 offset:53248
    v_and_b32 v9, 3, v0
    v_lshlrev_b32 v9, 2, v9
    ds_read_b32 v10, v9 offset:28672
    v_mfma_f32_16x16x32_bf16 v[108:111], v[52:55], v[252:255], v[108:111]
    s_waitcnt lgkmcnt(12)
    ds_read_b64_tr_b16 v[50:51], v13 offset:55296
    v_mfma_f32_16x16x32_bf16 v[112:115], v[56:59], v[248:251], v[112:115]
    ds_read_b64_tr_b16 v[52:53], v14 offset:53248
    v_mfma_f32_16x16x32_bf16 v[120:123], v[56:59], v[252:255], v[120:123]
    s_waitcnt lgkmcnt(12)
    ds_read_b64_tr_b16 v[54:55], v14 offset:55296
    v_mfma_f32_16x16x32_bf16 v[116:119], v[60:63], v[248:251], v[116:119]
    ds_read_b64_tr_b16 v[56:57], v15 offset:53248
    v_mfma_f32_16x16x32_bf16 v[124:127], v[60:63], v[252:255], v[124:127]
    s_waitcnt lgkmcnt(12)
    ds_read_b64_tr_b16 v[58:59], v15 offset:55296
    v_mfma_f32_16x16x32_bf16 v[64:67], v[32:35], v[128:131], 0
    ds_read_b64_tr_b16 v[60:61], v16 offset:53248
    s_waitcnt lgkmcnt(6)
    v_cmp_ne_u32 vcc, 0, v10
    s_nop 1
    s_andn2_b64 s[6:7], vcc, s[66:67]
    s_cbranch_scc1 L_fallback_main
    v_mfma_f32_16x16x32_bf16 v[72:75], v[32:35], v[132:135], 0
    ds_read_b64_tr_b16 v[62:63], v16 offset:55296
    v_mul_f32 v96, v96, v18
    v_mul_f32 v97, v97, v18
    v_mfma_f32_16x16x32_bf16 v[68:71], v[36:39], v[128:131], 0
    ds_read_b64_tr_b16 v[32:33], v13 offset:57344
    v_mul_f32 v98, v98, v18
    v_mul_f32 v99, v99, v18
    v_mfma_f32_16x16x32_bf16 v[76:79], v[36:39], v[132:135], 0
    ds_read_b64_tr_b16 v[34:35], v13 offset:59392
    v_mul_f32 v100, v100, v18
    v_mfma_f32_16x16x32_bf16 v[80:83], v[40:43], v[128:131], 0
    ds_read_b64_tr_b16 v[36:37], v14 offset:57344
    v_mul_f32 v101, v101, v18
    v_mul_f32 v102, v102, v18
    v_mfma_f32_16x16x32_bf16 v[88:91], v[40:43], v[132:135], 0
    ds_read_b64_tr_b16 v[38:39], v14 offset:59392
    v_mul_f32 v103, v103, v18
    v_cvt_pk_bf16_f32 v96, v96, v97
    v_mfma_f32_16x16x32_bf16 v[84:87], v[44:47], v[128:131], 0
    ds_read_b64_tr_b16 v[40:41], v15 offset:57344
    v_cvt_pk_bf16_f32 v97, v98, v99
    v_mfma_f32_16x16x32_bf16 v[92:95], v[44:47], v[132:135], 0
    s_waitcnt lgkmcnt(11)
    ds_read_b64_tr_b16 v[42:43], v15 offset:59392
    v_cvt_pk_bf16_f32 v98, v100, v101
    v_cvt_pk_bf16_f32 v99, v102, v103
    v_mfma_f32_16x16x32_bf16 v[64:67], v[48:51], v[136:139], v[64:67]
    ds_read_b64_tr_b16 v[44:45], v16 offset:57344
    s_mul_i32 s70, s58, 40960
    s_lshl2_add_u32 s70, s65, s70
    s_add_u32 s70, s70, 0
    v_mul_f32 v104, v104, v19
    v_mfma_f32_16x16x32_bf16 v[72:75], v[48:51], v[140:143], v[72:75]
    s_waitcnt lgkmcnt(11)
    ds_read_b64_tr_b16 v[46:47], v16 offset:59392
    v_mul_f32 v105, v105, v19
    v_mfma_f32_16x16x32_bf16 v[68:71], v[52:55], v[136:139], v[68:71]
    ds_read_b64_tr_b16 v[48:49], v13 offset:61440
    v_mul_f32 v106, v106, v19
    v_mul_f32 v107, v107, v19
    v_mfma_f32_16x16x32_bf16 v[76:79], v[52:55], v[140:143], v[76:79]
    s_waitcnt lgkmcnt(11)
    ds_read_b64_tr_b16 v[50:51], v13 offset:63488
    v_mul_f32 v108, v108, v19
    v_mfma_f32_16x16x32_bf16 v[80:83], v[56:59], v[136:139], v[80:83]
    ds_read_b64_tr_b16 v[52:53], v14 offset:61440
    v_mul_f32 v109, v109, v19
    v_mul_f32 v110, v110, v19
    v_mfma_f32_16x16x32_bf16 v[88:91], v[56:59], v[140:143], v[88:91]
    s_waitcnt lgkmcnt(11)
    ds_read_b64_tr_b16 v[54:55], v14 offset:63488
    v_mul_f32 v111, v111, v19
    v_cvt_pk_bf16_f32 v100, v104, v105
    v_mfma_f32_16x16x32_bf16 v[84:87], v[60:63], v[136:139], v[84:87]
    ds_read_b64_tr_b16 v[56:57], v15 offset:61440
    v_cvt_pk_bf16_f32 v101, v106, v107
    v_mfma_f32_16x16x32_bf16 v[92:95], v[60:63], v[140:143], v[92:95]
    s_waitcnt lgkmcnt(11)
    ds_read_b64_tr_b16 v[58:59], v15 offset:63488
    v_cvt_pk_bf16_f32 v102, v108, v109
    v_cvt_pk_bf16_f32 v103, v110, v111
    v_mfma_f32_16x16x32_bf16 v[64:67], v[32:35], v[144:147], v[64:67]
    ds_read_b64_tr_b16 v[60:61], v16 offset:61440
    v_mul_f32 v112, v112, v18
    v_mul_f32 v113, v113, v18
    v_mfma_f32_16x16x32_bf16 v[72:75], v[32:35], v[148:151], v[72:75]
    s_waitcnt lgkmcnt(11)
    ds_read_b64_tr_b16 v[62:63], v16 offset:63488
    s_barrier
    v_mul_f32 v114, v114, v18
    v_mfma_f32_16x16x32_bf16 v[68:71], v[36:39], v[144:147], v[68:71]
    ds_read_b64_tr_b16 v[32:33], v13
    v_mul_f32 v115, v115, v18
    v_mul_f32 v116, v116, v18
    buffer_store_dwordx4 v[96:99], v17, s[44:47], s70 offen sc1
    v_mfma_f32_16x16x32_bf16 v[76:79], v[36:39], v[148:151], v[76:79]
    s_waitcnt lgkmcnt(11)
    ds_read_b64_tr_b16 v[34:35], v13 offset:2048
    v_mul_f32 v117, v117, v18
    v_mul_f32 v118, v118, v18
    buffer_store_dwordx4 v[100:103], v17, s[44:47], s70 offen offset:1024 sc1
    v_mfma_f32_16x16x32_bf16 v[80:83], v[40:43], v[144:147], v[80:83]
    ds_read_b64_tr_b16 v[36:37], v14
    v_mul_f32 v119, v119, v18
    v_mfma_f32_16x16x32_bf16 v[88:91], v[40:43], v[148:151], v[88:91]
    s_waitcnt lgkmcnt(11)
    ds_read_b64_tr_b16 v[38:39], v14 offset:2048
    v_cvt_pk_bf16_f32 v104, v112, v113
    v_cvt_pk_bf16_f32 v105, v114, v115
    v_mfma_f32_16x16x32_bf16 v[84:87], v[44:47], v[144:147], v[84:87]
    ds_read_b64_tr_b16 v[40:41], v15
    v_cvt_pk_bf16_f32 v106, v116, v117
    v_mfma_f32_16x16x32_bf16 v[92:95], v[44:47], v[148:151], v[92:95]
    s_waitcnt lgkmcnt(11)
    ds_read_b64_tr_b16 v[42:43], v15 offset:2048
    v_cvt_pk_bf16_f32 v107, v118, v119
    v_mul_f32 v120, v120, v19
    v_mfma_f32_16x16x32_bf16 v[64:67], v[48:51], v[152:155], v[64:67]
    ds_read_b64_tr_b16 v[44:45], v16
    v_mul_f32 v121, v121, v19
    v_mul_f32 v122, v122, v19
    v_mfma_f32_16x16x32_bf16 v[72:75], v[48:51], v[156:159], v[72:75]
    s_waitcnt lgkmcnt(11)
    ds_read_b64_tr_b16 v[46:47], v16 offset:2048
    v_mul_f32 v123, v123, v19
    buffer_store_dwordx4 v[104:107], v17, s[44:47], s70 offen offset:2048 sc1
    v_mfma_f32_16x16x32_bf16 v[68:71], v[52:55], v[152:155], v[68:71]
    ds_read_b64_tr_b16 v[48:49], v13 offset:4096
    v_mul_f32 v124, v124, v19
    v_mul_f32 v125, v125, v19
    v_mfma_f32_16x16x32_bf16 v[76:79], v[52:55], v[156:159], v[76:79]
    s_waitcnt lgkmcnt(11)
    ds_read_b64_tr_b16 v[50:51], v13 offset:6144
    v_mul_f32 v126, v126, v19
    v_mul_f32 v127, v127, v19
    v_mfma_f32_16x16x32_bf16 v[80:83], v[56:59], v[152:155], v[80:83]
    ds_read_b64_tr_b16 v[52:53], v14 offset:4096
    v_cvt_pk_bf16_f32 v108, v120, v121
    v_mfma_f32_16x16x32_bf16 v[88:91], v[56:59], v[156:159], v[88:91]
    s_waitcnt lgkmcnt(11)
    ds_read_b64_tr_b16 v[54:55], v14 offset:6144
    v_cvt_pk_bf16_f32 v109, v122, v123
    v_cvt_pk_bf16_f32 v110, v124, v125
    v_mfma_f32_16x16x32_bf16 v[84:87], v[60:63], v[152:155], v[84:87]
    ds_read_b64_tr_b16 v[56:57], v15 offset:4096
    v_cvt_pk_bf16_f32 v111, v126, v127
    v_mfma_f32_16x16x32_bf16 v[92:95], v[60:63], v[156:159], v[92:95]
    s_waitcnt lgkmcnt(11)
    ds_read_b64_tr_b16 v[58:59], v15 offset:6144
    v_mfma_f32_16x16x32_bf16 v[64:67], v[32:35], v[160:163], v[64:67]
    ds_read_b64_tr_b16 v[60:61], v16 offset:4096
    buffer_store_dwordx4 v[108:111], v17, s[44:47], s70 offen offset:3072 sc1
    v_mfma_f32_16x16x32_bf16 v[72:75], v[32:35], v[164:167], v[72:75]
    s_waitcnt lgkmcnt(11)
    ds_read_b64_tr_b16 v[62:63], v16 offset:6144
    v_mfma_f32_16x16x32_bf16 v[68:71], v[36:39], v[160:163], v[68:71]
    ds_read_b64_tr_b16 v[32:33], v13 offset:8192
    v_mfma_f32_16x16x32_bf16 v[76:79], v[36:39], v[164:167], v[76:79]
    s_waitcnt lgkmcnt(11)
    ds_read_b64_tr_b16 v[34:35], v13 offset:10240
    v_mfma_f32_16x16x32_bf16 v[80:83], v[40:43], v[160:163], v[80:83]
    ds_read_b64_tr_b16 v[36:37], v14 offset:8192
    v_mfma_f32_16x16x32_bf16 v[88:91], v[40:43], v[164:167], v[88:91]
    s_waitcnt lgkmcnt(11)
    ds_read_b64_tr_b16 v[38:39], v14 offset:10240
    v_mfma_f32_16x16x32_bf16 v[84:87], v[44:47], v[160:163], v[84:87]
    ds_read_b64_tr_b16 v[40:41], v15 offset:8192
    v_mfma_f32_16x16x32_bf16 v[92:95], v[44:47], v[164:167], v[92:95]
    s_waitcnt lgkmcnt(11)
    ds_read_b64_tr_b16 v[42:43], v15 offset:10240
    v_mfma_f32_16x16x32_bf16 v[64:67], v[48:51], v[168:171], v[64:67]
    ds_read_b64_tr_b16 v[44:45], v16 offset:8192
    v_mfma_f32_16x16x32_bf16 v[72:75], v[48:51], v[172:175], v[72:75]
    s_waitcnt lgkmcnt(11)
    ds_read_b64_tr_b16 v[46:47], v16 offset:10240
    v_mfma_f32_16x16x32_bf16 v[68:71], v[52:55], v[168:171], v[68:71]
    ds_read_b64_tr_b16 v[48:49], v13 offset:12288
    v_mfma_f32_16x16x32_bf16 v[76:79], v[52:55], v[172:175], v[76:79]
    s_waitcnt lgkmcnt(11)
    ds_read_b64_tr_b16 v[50:51], v13 offset:14336
    v_add_u32 v13, 0xffffc000, v13
    v_mfma_f32_16x16x32_bf16 v[80:83], v[56:59], v[168:171], v[80:83]
    ds_read_b64_tr_b16 v[52:53], v14 offset:12288
    v_mfma_f32_16x16x32_bf16 v[88:91], v[56:59], v[172:175], v[88:91]
    s_waitcnt lgkmcnt(11)
    ds_read_b64_tr_b16 v[54:55], v14 offset:14336
    v_add_u32 v14, 0xffffc000, v14
    v_mfma_f32_16x16x32_bf16 v[84:87], v[60:63], v[168:171], v[84:87]
    ds_read_b64_tr_b16 v[56:57], v15 offset:12288
    v_mfma_f32_16x16x32_bf16 v[92:95], v[60:63], v[172:175], v[92:95]
    s_waitcnt lgkmcnt(11)
    ds_read_b64_tr_b16 v[58:59], v15 offset:14336
    v_add_u32 v15, 0xffffc000, v15
    v_mfma_f32_16x16x32_bf16 v[64:67], v[32:35], v[176:179], v[64:67]
    ds_read_b64_tr_b16 v[60:61], v16 offset:12288
    v_mfma_f32_16x16x32_bf16 v[72:75], v[32:35], v[180:183], v[72:75]
    s_waitcnt lgkmcnt(11)
    ds_read_b64_tr_b16 v[62:63], v16 offset:14336
    v_add_u32 v16, 0xffffc000, v16
    s_barrier
    v_mfma_f32_16x16x32_bf16 v[68:71], v[36:39], v[176:179], v[68:71]
    ds_read_b64_tr_b16 v[32:33], v13
    v_mfma_f32_16x16x32_bf16 v[76:79], v[36:39], v[180:183], v[76:79]
    s_waitcnt lgkmcnt(11)
    ds_read_b64_tr_b16 v[34:35], v13 offset:2048
    v_mfma_f32_16x16x32_bf16 v[80:83], v[40:43], v[176:179], v[80:83]
    ds_read_b64_tr_b16 v[36:37], v14
    v_mfma_f32_16x16x32_bf16 v[88:91], v[40:43], v[180:183], v[88:91]
    s_waitcnt lgkmcnt(11)
    ds_read_b64_tr_b16 v[38:39], v14 offset:2048
    v_mfma_f32_16x16x32_bf16 v[84:87], v[44:47], v[176:179], v[84:87]
    ds_read_b64_tr_b16 v[40:41], v15
    v_mfma_f32_16x16x32_bf16 v[92:95], v[44:47], v[180:183], v[92:95]
    s_waitcnt lgkmcnt(11)
    ds_read_b64_tr_b16 v[42:43], v15 offset:2048
    v_mfma_f32_16x16x32_bf16 v[64:67], v[48:51], v[184:187], v[64:67]
    ds_read_b64_tr_b16 v[44:45], v16
    v_mfma_f32_16x16x32_bf16 v[72:75], v[48:51], v[188:191], v[72:75]
    s_waitcnt lgkmcnt(11)
    ds_read_b64_tr_b16 v[46:47], v16 offset:2048
    v_mfma_f32_16x16x32_bf16 v[68:71], v[52:55], v[184:187], v[68:71]
    ds_read_b64_tr_b16 v[48:49], v13 offset:4096
    v_mfma_f32_16x16x32_bf16 v[76:79], v[52:55], v[188:191], v[76:79]
    s_waitcnt lgkmcnt(11)
    ds_read_b64_tr_b16 v[50:51], v13 offset:6144
    v_mfma_f32_16x16x32_bf16 v[80:83], v[56:59], v[184:187], v[80:83]
    ds_read_b64_tr_b16 v[52:53], v14 offset:4096
    v_mfma_f32_16x16x32_bf16 v[88:91], v[56:59], v[188:191], v[88:91]
    s_waitcnt lgkmcnt(11)
    ds_read_b64_tr_b16 v[54:55], v14 offset:6144
    v_mfma_f32_16x16x32_bf16 v[84:87], v[60:63], v[184:187], v[84:87]
    ds_read_b64_tr_b16 v[56:57], v15 offset:4096
    v_mfma_f32_16x16x32_bf16 v[92:95], v[60:63], v[188:191], v[92:95]
    s_waitcnt lgkmcnt(11)
    ds_read_b64_tr_b16 v[58:59], v15 offset:6144
    v_mfma_f32_16x16x32_bf16 v[64:67], v[32:35], v[192:195], v[64:67]
    ds_read_b64_tr_b16 v[60:61], v16 offset:4096
    v_mfma_f32_16x16x32_bf16 v[72:75], v[32:35], v[196:199], v[72:75]
    s_waitcnt lgkmcnt(11)
    ds_read_b64_tr_b16 v[62:63], v16 offset:6144
    v_mfma_f32_16x16x32_bf16 v[68:71], v[36:39], v[192:195], v[68:71]
    ds_read_b64_tr_b16 v[32:33], v13 offset:8192
    v_mfma_f32_16x16x32_bf16 v[76:79], v[36:39], v[196:199], v[76:79]
    s_waitcnt lgkmcnt(11)
    ds_read_b64_tr_b16 v[34:35], v13 offset:10240
    v_mfma_f32_16x16x32_bf16 v[80:83], v[40:43], v[192:195], v[80:83]
    ds_read_b64_tr_b16 v[36:37], v14 offset:8192
    v_mfma_f32_16x16x32_bf16 v[88:91], v[40:43], v[196:199], v[88:91]
    s_waitcnt lgkmcnt(11)
    ds_read_b64_tr_b16 v[38:39], v14 offset:10240
    v_mfma_f32_16x16x32_bf16 v[84:87], v[44:47], v[192:195], v[84:87]
    ds_read_b64_tr_b16 v[40:41], v15 offset:8192
    v_mfma_f32_16x16x32_bf16 v[92:95], v[44:47], v[196:199], v[92:95]
    s_waitcnt lgkmcnt(11)
    ds_read_b64_tr_b16 v[42:43], v15 offset:10240
    v_mfma_f32_16x16x32_bf16 v[64:67], v[48:51], v[200:203], v[64:67]
    ds_read_b64_tr_b16 v[44:45], v16 offset:8192
    v_mfma_f32_16x16x32_bf16 v[72:75], v[48:51], v[204:207], v[72:75]
    s_waitcnt lgkmcnt(11)
    ds_read_b64_tr_b16 v[46:47], v16 offset:10240
    v_mfma_f32_16x16x32_bf16 v[68:71], v[52:55], v[200:203], v[68:71]
    ds_read_b64_tr_b16 v[48:49], v13 offset:12288
    v_mfma_f32_16x16x32_bf16 v[76:79], v[52:55], v[204:207], v[76:79]
    s_waitcnt lgkmcnt(11)
    ds_read_b64_tr_b16 v[50:51], v13 offset:14336
    v_mfma_f32_16x16x32_bf16 v[80:83], v[56:59], v[200:203], v[80:83]
    ds_read_b64_tr_b16 v[52:53], v14 offset:12288
    v_mfma_f32_16x16x32_bf16 v[88:91], v[56:59], v[204:207], v[88:91]
    s_waitcnt lgkmcnt(11)
    ds_read_b64_tr_b16 v[54:55], v14 offset:14336
    v_mfma_f32_16x16x32_bf16 v[84:87], v[60:63], v[200:203], v[84:87]
    ds_read_b64_tr_b16 v[56:57], v15 offset:12288
    v_mfma_f32_16x16x32_bf16 v[92:95], v[60:63], v[204:207], v[92:95]
    s_waitcnt lgkmcnt(11)
    ds_read_b64_tr_b16 v[58:59], v15 offset:14336
    v_mfma_f32_16x16x32_bf16 v[64:67], v[32:35], v[208:211], v[64:67]
    ds_read_b64_tr_b16 v[60:61], v16 offset:12288
    v_mfma_f32_16x16x32_bf16 v[72:75], v[32:35], v[212:215], v[72:75]
    s_waitcnt lgkmcnt(11)
    ds_read_b64_tr_b16 v[62:63], v16 offset:14336
    s_waitcnt vmcnt(0)
    s_barrier
    v_mfma_f32_16x16x32_bf16 v[68:71], v[36:39], v[208:211], v[68:71]
    ds_read_b64_tr_b16 v[32:33], v13 offset:32768
    v_mfma_f32_16x16x32_bf16 v[76:79], v[36:39], v[212:215], v[76:79]
    s_waitcnt lgkmcnt(11)
    ds_read_b64_tr_b16 v[34:35], v13 offset:34816
    v_mfma_f32_16x16x32_bf16 v[80:83], v[40:43], v[208:211], v[80:83]
    ds_read_b64_tr_b16 v[36:37], v14 offset:32768
    v_mfma_f32_16x16x32_bf16 v[88:91], v[40:43], v[212:215], v[88:91]
    s_waitcnt lgkmcnt(11)
    ds_read_b64_tr_b16 v[38:39], v14 offset:34816
    v_mfma_f32_16x16x32_bf16 v[84:87], v[44:47], v[208:211], v[84:87]
    ds_read_b64_tr_b16 v[40:41], v15 offset:32768
    v_mfma_f32_16x16x32_bf16 v[92:95], v[44:47], v[212:215], v[92:95]
    s_waitcnt lgkmcnt(11)
    ds_read_b64_tr_b16 v[42:43], v15 offset:34816
    v_mfma_f32_16x16x32_bf16 v[64:67], v[48:51], v[216:219], v[64:67]
    ds_read_b64_tr_b16 v[44:45], v16 offset:32768
    v_mfma_f32_16x16x32_bf16 v[72:75], v[48:51], v[220:223], v[72:75]
    s_waitcnt lgkmcnt(11)
    ds_read_b64_tr_b16 v[46:47], v16 offset:34816
    v_mfma_f32_16x16x32_bf16 v[68:71], v[52:55], v[216:219], v[68:71]
    ds_read_b64_tr_b16 v[48:49], v13 offset:36864
    v_mfma_f32_16x16x32_bf16 v[76:79], v[52:55], v[220:223], v[76:79]
    s_waitcnt lgkmcnt(11)
    ds_read_b64_tr_b16 v[50:51], v13 offset:38912
    v_mfma_f32_16x16x32_bf16 v[80:83], v[56:59], v[216:219], v[80:83]
    ds_read_b64_tr_b16 v[52:53], v14 offset:36864
    v_mfma_f32_16x16x32_bf16 v[88:91], v[56:59], v[220:223], v[88:91]
    s_waitcnt lgkmcnt(11)
    ds_read_b64_tr_b16 v[54:55], v14 offset:38912
    v_mfma_f32_16x16x32_bf16 v[84:87], v[60:63], v[216:219], v[84:87]
    ds_read_b64_tr_b16 v[56:57], v15 offset:36864
    v_mfma_f32_16x16x32_bf16 v[92:95], v[60:63], v[220:223], v[92:95]
    s_waitcnt lgkmcnt(11)
    ds_read_b64_tr_b16 v[58:59], v15 offset:38912
    v_mfma_f32_16x16x32_bf16 v[64:67], v[32:35], v[224:227], v[64:67]
    ds_read_b64_tr_b16 v[60:61], v16 offset:36864
    v_mfma_f32_16x16x32_bf16 v[72:75], v[32:35], v[228:231], v[72:75]
    s_waitcnt lgkmcnt(11)
    ds_read_b64_tr_b16 v[62:63], v16 offset:38912
    v_mfma_f32_16x16x32_bf16 v[68:71], v[36:39], v[224:227], v[68:71]
    ds_read_b64_tr_b16 v[32:33], v13 offset:40960
    v_mfma_f32_16x16x32_bf16 v[76:79], v[36:39], v[228:231], v[76:79]
    s_waitcnt lgkmcnt(11)
    ds_read_b64_tr_b16 v[34:35], v13 offset:43008
    v_mfma_f32_16x16x32_bf16 v[80:83], v[40:43], v[224:227], v[80:83]
    ds_read_b64_tr_b16 v[36:37], v14 offset:40960
    v_mfma_f32_16x16x32_bf16 v[88:91], v[40:43], v[228:231], v[88:91]
    s_waitcnt lgkmcnt(11)
    ds_read_b64_tr_b16 v[38:39], v14 offset:43008
    v_mfma_f32_16x16x32_bf16 v[84:87], v[44:47], v[224:227], v[84:87]
    ds_read_b64_tr_b16 v[40:41], v15 offset:40960
    v_mfma_f32_16x16x32_bf16 v[92:95], v[44:47], v[228:231], v[92:95]
    s_waitcnt lgkmcnt(11)
    ds_read_b64_tr_b16 v[42:43], v15 offset:43008
    v_mfma_f32_16x16x32_bf16 v[64:67], v[48:51], v[232:235], v[64:67]
    ds_read_b64_tr_b16 v[44:45], v16 offset:40960
    v_mfma_f32_16x16x32_bf16 v[72:75], v[48:51], v[236:239], v[72:75]
    s_waitcnt lgkmcnt(11)
    ds_read_b64_tr_b16 v[46:47], v16 offset:43008
    v_mfma_f32_16x16x32_bf16 v[68:71], v[52:55], v[232:235], v[68:71]
    ds_read_b64_tr_b16 v[48:49], v13 offset:45056
    v_mfma_f32_16x16x32_bf16 v[76:79], v[52:55], v[236:239], v[76:79]
    s_waitcnt lgkmcnt(11)
    ds_read_b64_tr_b16 v[50:51], v13 offset:47104
    v_mfma_f32_16x16x32_bf16 v[80:83], v[56:59], v[232:235], v[80:83]
    ds_read_b64_tr_b16 v[52:53], v14 offset:45056
    v_mfma_f32_16x16x32_bf16 v[88:91], v[56:59], v[236:239], v[88:91]
    s_waitcnt lgkmcnt(11)
    ds_read_b64_tr_b16 v[54:55], v14 offset:47104
    v_mfma_f32_16x16x32_bf16 v[84:87], v[60:63], v[232:235], v[84:87]
    ds_read_b64_tr_b16 v[56:57], v15 offset:45056
    v_mfma_f32_16x16x32_bf16 v[92:95], v[60:63], v[236:239], v[92:95]
    s_waitcnt lgkmcnt(11)
    ds_read_b64_tr_b16 v[58:59], v15 offset:47104
    v_mfma_f32_16x16x32_bf16 v[64:67], v[32:35], v[240:243], v[64:67]
    ds_read_b64_tr_b16 v[60:61], v16 offset:45056
    v_mfma_f32_16x16x32_bf16 v[72:75], v[32:35], v[244:247], v[72:75]
    s_waitcnt lgkmcnt(11)
    ds_read_b64_tr_b16 v[62:63], v16 offset:47104
    s_barrier
    v_mfma_f32_16x16x32_bf16 v[68:71], v[36:39], v[240:243], v[68:71]
    ds_read_b64_tr_b16 v[32:33], v1
    v_mfma_f32_16x16x32_bf16 v[76:79], v[36:39], v[244:247], v[76:79]
    s_waitcnt lgkmcnt(11)
    ds_read_b64_tr_b16 v[34:35], v1 offset:4096
    v_mfma_f32_16x16x32_bf16 v[80:83], v[40:43], v[240:243], v[80:83]
    ds_read_b64_tr_b16 v[36:37], v2
    v_mfma_f32_16x16x32_bf16 v[88:91], v[40:43], v[244:247], v[88:91]
    s_waitcnt lgkmcnt(11)
    ds_read_b64_tr_b16 v[38:39], v2 offset:4096
    v_mfma_f32_16x16x32_bf16 v[84:87], v[44:47], v[240:243], v[84:87]
    ds_read_b64_tr_b16 v[40:41], v3
    v_mfma_f32_16x16x32_bf16 v[92:95], v[44:47], v[244:247], v[92:95]
    s_waitcnt lgkmcnt(11)
    ds_read_b64_tr_b16 v[42:43], v3 offset:4096
    v_mfma_f32_16x16x32_bf16 v[64:67], v[48:51], v[248:251], v[64:67]
    ds_read_b64_tr_b16 v[44:45], v4
    v_mfma_f32_16x16x32_bf16 v[72:75], v[48:51], v[252:255], v[72:75]
    s_waitcnt lgkmcnt(11)
    ds_read_b64_tr_b16 v[46:47], v4 offset:4096
    v_mfma_f32_16x16x32_bf16 v[68:71], v[52:55], v[248:251], v[68:71]
    ds_read_b64_tr_b16 v[48:49], v5
    v_mfma_f32_16x16x32_bf16 v[76:79], v[52:55], v[252:255], v[76:79]
    s_waitcnt lgkmcnt(11)
    ds_read_b64_tr_b16 v[50:51], v5 offset:4096
    v_mfma_f32_16x16x32_bf16 v[80:83], v[56:59], v[248:251], v[80:83]
    ds_read_b64_tr_b16 v[52:53], v6
    v_mfma_f32_16x16x32_bf16 v[88:91], v[56:59], v[252:255], v[88:91]
    s_waitcnt lgkmcnt(11)
    ds_read_b64_tr_b16 v[54:55], v6 offset:4096
    v_mfma_f32_16x16x32_bf16 v[84:87], v[60:63], v[248:251], v[84:87]
    ds_read_b64_tr_b16 v[56:57], v7
    s_barrier
    v_mfma_f32_16x16x32_bf16 v[92:95], v[60:63], v[252:255], v[92:95]
    s_waitcnt lgkmcnt(11)
    ds_read_b64_tr_b16 v[58:59], v7 offset:4096
    v_mfma_f32_16x16x32_bf16 v[128:131], v[32:35], v[96:99], 0
    ds_read_b64_tr_b16 v[60:61], v8
    v_mfma_f32_16x16x32_bf16 v[136:139], v[32:35], v[100:103], 0
    s_waitcnt lgkmcnt(11)
    ds_read_b64_tr_b16 v[62:63], v8 offset:4096
    v_mul_f32 v64, v64, v18
    v_mul_f32 v65, v65, v18
    v_mul_f32 v66, v66, v18
    v_mfma_f32_16x16x32_bf16 v[132:135], v[36:39], v[96:99], 0
    ds_read_b64_tr_b16 v[32:33], v1 offset:8192
    v_mul_f32 v67, v67, v18
    v_mul_f32 v68, v68, v18
    v_mfma_f32_16x16x32_bf16 v[140:143], v[36:39], v[100:103], 0
    s_waitcnt lgkmcnt(11)
    ds_read_b64_tr_b16 v[34:35], v1 offset:12288
    v_mul_f32 v69, v69, v18
    v_mul_f32 v70, v70, v18
    v_mfma_f32_16x16x32_bf16 v[144:147], v[40:43], v[96:99], 0
    ds_read_b64_tr_b16 v[36:37], v2 offset:8192
    v_mul_f32 v71, v71, v18
    v_cvt_pk_bf16_f32 v112, v64, v65
    v_cvt_pk_bf16_f32 v113, v66, v67
    v_mfma_f32_16x16x32_bf16 v[152:155], v[40:43], v[100:103], 0
    s_waitcnt lgkmcnt(11)
    ds_read_b64_tr_b16 v[38:39], v2 offset:12288
    v_cvt_pk_bf16_f32 v114, v68, v69
    v_cvt_pk_bf16_f32 v115, v70, v71
    v_mfma_f32_16x16x32_bf16 v[148:151], v[44:47], v[96:99], 0
    ds_read_b64_tr_b16 v[40:41], v3 offset:8192
    s_mul_i32 s70, s58, 40960
    s_lshl2_add_u32 s70, s65, s70
    s_add_u32 s70, s70, 20480
    buffer_store_dwordx4 v[112:115], v17, s[44:47], s70 offen sc1
    v_mfma_f32_16x16x32_bf16 v[156:159], v[44:47], v[100:103], 0
    s_waitcnt lgkmcnt(11)
    ds_read_b64_tr_b16 v[42:43], v3 offset:12288
    v_mul_f32 v72, v72, v19
    v_mul_f32 v73, v73, v19
    v_mul_f32 v74, v74, v19
    v_mfma_f32_16x16x32_bf16 v[160:163], v[48:51], v[96:99], 0
    ds_read_b64_tr_b16 v[44:45], v4 offset:8192
    v_mul_f32 v75, v75, v19
    v_mul_f32 v76, v76, v19
    v_mfma_f32_16x16x32_bf16 v[168:171], v[48:51], v[100:103], 0
    s_waitcnt lgkmcnt(11)
    ds_read_b64_tr_b16 v[46:47], v4 offset:12288
    v_mul_f32 v77, v77, v19
    v_mul_f32 v78, v78, v19
    v_mfma_f32_16x16x32_bf16 v[164:167], v[52:55], v[96:99], 0
    ds_read_b64_tr_b16 v[48:49], v5 offset:8192
    v_mul_f32 v79, v79, v19
    v_cvt_pk_bf16_f32 v116, v72, v73
    v_cvt_pk_bf16_f32 v117, v74, v75
    v_mfma_f32_16x16x32_bf16 v[172:175], v[52:55], v[100:103], 0
    s_waitcnt lgkmcnt(11)
    ds_read_b64_tr_b16 v[50:51], v5 offset:12288
    v_cvt_pk_bf16_f32 v118, v76, v77
    v_cvt_pk_bf16_f32 v119, v78, v79
    v_mfma_f32_16x16x32_bf16 v[176:179], v[56:59], v[96:99], 0
    ds_read_b64_tr_b16 v[52:53], v6 offset:8192
    buffer_store_dwordx4 v[116:119], v17, s[44:47], s70 offen offset:1024 sc1
    v_mul_f32 v80, v80, v18
    v_mfma_f32_16x16x32_bf16 v[184:187], v[56:59], v[100:103], 0
    s_waitcnt lgkmcnt(11)
    ds_read_b64_tr_b16 v[54:55], v6 offset:12288
    v_mul_f32 v81, v81, v18
    v_mul_f32 v82, v82, v18
    v_mfma_f32_16x16x32_bf16 v[180:183], v[60:63], v[96:99], 0
    ds_read_b64_tr_b16 v[56:57], v7 offset:8192
    v_mul_f32 v83, v83, v18
    v_mul_f32 v84, v84, v18
    v_mul_f32 v85, v85, v18
    v_mfma_f32_16x16x32_bf16 v[188:191], v[60:63], v[100:103], 0
    s_waitcnt lgkmcnt(11)
    ds_read_b64_tr_b16 v[58:59], v7 offset:12288
    v_mul_f32 v86, v86, v18
    v_mul_f32 v87, v87, v18
    v_mfma_f32_16x16x32_bf16 v[128:131], v[32:35], v[104:107], v[128:131]
    ds_read_b64_tr_b16 v[60:61], v8 offset:8192
    v_cvt_pk_bf16_f32 v120, v80, v81
    v_cvt_pk_bf16_f32 v121, v82, v83
    v_mfma_f32_16x16x32_bf16 v[136:139], v[32:35], v[108:111], v[136:139]
    s_waitcnt lgkmcnt(11)
    ds_read_b64_tr_b16 v[62:63], v8 offset:12288
    v_cvt_pk_bf16_f32 v122, v84, v85
    v_cvt_pk_bf16_f32 v123, v86, v87
    buffer_store_dwordx4 v[120:123], v17, s[44:47], s70 offen offset:2048 sc1
    v_mfma_f32_16x16x32_bf16 v[132:135], v[36:39], v[104:107], v[132:135]
    ds_read_b64_tr_b16 v[32:33], v1 offset:32768
    v_mul_f32 v88, v88, v19
    v_mul_f32 v89, v89, v19
    v_mfma_f32_16x16x32_bf16 v[140:143], v[36:39], v[108:111], v[140:143]
    s_waitcnt lgkmcnt(11)
    ds_read_b64_tr_b16 v[34:35], v1 offset:36864
    v_mul_f32 v90, v90, v19
    v_mul_f32 v91, v91, v19
    v_mfma_f32_16x16x32_bf16 v[144:147], v[40:43], v[104:107], v[144:147]
    ds_read_b64_tr_b16 v[36:37], v2 offset:32768
    v_mul_f32 v92, v92, v19
    v_mul_f32 v93, v93, v19
    v_mul_f32 v94, v94, v19
    v_mfma_f32_16x16x32_bf16 v[152:155], v[40:43], v[108:111], v[152:155]
    s_waitcnt lgkmcnt(11)
    ds_read_b64_tr_b16 v[38:39], v2 offset:36864
    v_mul_f32 v95, v95, v19
    v_cvt_pk_bf16_f32 v124, v88, v89
    v_mfma_f32_16x16x32_bf16 v[148:151], v[44:47], v[104:107], v[148:151]
    ds_read_b64_tr_b16 v[40:41], v3 offset:32768
    v_cvt_pk_bf16_f32 v125, v90, v91
    v_cvt_pk_bf16_f32 v126, v92, v93
    v_mfma_f32_16x16x32_bf16 v[156:159], v[44:47], v[108:111], v[156:159]
    s_waitcnt lgkmcnt(11)
    ds_read_b64_tr_b16 v[42:43], v3 offset:36864
    v_cvt_pk_bf16_f32 v127, v94, v95
    buffer_store_dwordx4 v[124:127], v17, s[44:47], s70 offen offset:3072 sc1
    v_mfma_f32_16x16x32_bf16 v[160:163], v[48:51], v[104:107], v[160:163]
    ds_read_b64_tr_b16 v[44:45], v4 offset:32768
    s_barrier
    s_add_u32 s5, s58, 1
    s_and_b32 s5, s5, 3
    s_mul_i32 s5, s5, 40960
    s_lshl2_add_u32 s5, s65, s5
    s_add_u32 s5, s5, 0
    buffer_load_dwordx4 v[192:195], v17, s[44:47], s5 offen sc1
    buffer_load_dwordx4 v[196:199], v17, s[44:47], s5 offen offset:1024 sc1
    buffer_load_dwordx4 v[200:203], v17, s[44:47], s5 offen offset:2048 sc1
    buffer_load_dwordx4 v[204:207], v17, s[44:47], s5 offen offset:3072 sc1
    v_mfma_f32_16x16x32_bf16 v[168:171], v[48:51], v[108:111], v[168:171]
    s_waitcnt lgkmcnt(11)
    ds_read_b64_tr_b16 v[46:47], v4 offset:36864
    v_mfma_f32_16x16x32_bf16 v[164:167], v[52:55], v[104:107], v[164:167]
    ds_read_b64_tr_b16 v[48:49], v5 offset:32768
    v_mfma_f32_16x16x32_bf16 v[172:175], v[52:55], v[108:111], v[172:175]
    s_waitcnt lgkmcnt(11)
    ds_read_b64_tr_b16 v[50:51], v5 offset:36864
    v_mfma_f32_16x16x32_bf16 v[176:179], v[56:59], v[104:107], v[176:179]
    ds_read_b64_tr_b16 v[52:53], v6 offset:32768
    v_mfma_f32_16x16x32_bf16 v[184:187], v[56:59], v[108:111], v[184:187]
    s_waitcnt lgkmcnt(11)
    ds_read_b64_tr_b16 v[54:55], v6 offset:36864
    v_mfma_f32_16x16x32_bf16 v[180:183], v[60:63], v[104:107], v[180:183]
    ds_read_b64_tr_b16 v[56:57], v7 offset:32768
    v_mfma_f32_16x16x32_bf16 v[188:191], v[60:63], v[108:111], v[188:191]
    s_waitcnt lgkmcnt(11)
    ds_read_b64_tr_b16 v[58:59], v7 offset:36864
    v_mfma_f32_16x16x32_bf16 v[128:131], v[32:35], v[112:115], v[128:131]
    ds_read_b64_tr_b16 v[60:61], v8 offset:32768
    v_mfma_f32_16x16x32_bf16 v[136:139], v[32:35], v[116:119], v[136:139]
    s_waitcnt lgkmcnt(11)
    ds_read_b64_tr_b16 v[62:63], v8 offset:36864
    v_mfma_f32_16x16x32_bf16 v[132:135], v[36:39], v[112:115], v[132:135]
    ds_read_b64_tr_b16 v[32:33], v1 offset:40960
    v_mfma_f32_16x16x32_bf16 v[140:143], v[36:39], v[116:119], v[140:143]
    s_waitcnt lgkmcnt(11)
    ds_read_b64_tr_b16 v[34:35], v1 offset:45056
    v_mfma_f32_16x16x32_bf16 v[144:147], v[40:43], v[112:115], v[144:147]
    ds_read_b64_tr_b16 v[36:37], v2 offset:40960
    v_mfma_f32_16x16x32_bf16 v[152:155], v[40:43], v[116:119], v[152:155]
    s_waitcnt lgkmcnt(11)
    ds_read_b64_tr_b16 v[38:39], v2 offset:45056
    v_mfma_f32_16x16x32_bf16 v[148:151], v[44:47], v[112:115], v[148:151]
    ds_read_b64_tr_b16 v[40:41], v3 offset:40960
    v_mfma_f32_16x16x32_bf16 v[156:159], v[44:47], v[116:119], v[156:159]
    s_waitcnt lgkmcnt(11)
    ds_read_b64_tr_b16 v[42:43], v3 offset:45056
    v_mfma_f32_16x16x32_bf16 v[160:163], v[48:51], v[112:115], v[160:163]
    ds_read_b64_tr_b16 v[44:45], v4 offset:40960
    v_mfma_f32_16x16x32_bf16 v[168:171], v[48:51], v[116:119], v[168:171]
    s_waitcnt lgkmcnt(11)
    ds_read_b64_tr_b16 v[46:47], v4 offset:45056
    v_mfma_f32_16x16x32_bf16 v[164:167], v[52:55], v[112:115], v[164:167]
    ds_read_b64_tr_b16 v[48:49], v5 offset:40960
    v_mfma_f32_16x16x32_bf16 v[172:175], v[52:55], v[116:119], v[172:175]
    s_waitcnt lgkmcnt(11)
    ds_read_b64_tr_b16 v[50:51], v5 offset:45056
    v_mfma_f32_16x16x32_bf16 v[176:179], v[56:59], v[112:115], v[176:179]
    ds_read_b64_tr_b16 v[52:53], v6 offset:40960
    s_add_u32 s5, s58, 2
    s_and_b32 s5, s5, 3
    s_mul_i32 s5, s5, 40960
    s_lshl2_add_u32 s5, s65, s5
    s_add_u32 s5, s5, 0
    buffer_load_dwordx4 v[208:211], v17, s[44:47], s5 offen sc1
    v_mfma_f32_16x16x32_bf16 v[184:187], v[56:59], v[116:119], v[184:187]
    s_waitcnt lgkmcnt(11)
    ds_read_b64_tr_b16 v[54:55], v6 offset:45056
    v_mfma_f32_16x16x32_bf16 v[180:183], v[60:63], v[112:115], v[180:183]
    ds_read_b64_tr_b16 v[56:57], v7 offset:40960
    buffer_load_dwordx4 v[212:215], v17, s[44:47], s5 offen offset:1024 sc1
    v_mfma_f32_16x16x32_bf16 v[188:191], v[60:63], v[116:119], v[188:191]
    s_waitcnt lgkmcnt(11)
    ds_read_b64_tr_b16 v[58:59], v7 offset:45056
    v_mfma_f32_16x16x32_bf16 v[128:131], v[32:35], v[120:123], v[128:131]
    ds_read_b64_tr_b16 v[60:61], v8 offset:40960
    buffer_load_dwordx4 v[216:219], v17, s[44:47], s5 offen offset:2048 sc1
    v_mfma_f32_16x16x32_bf16 v[136:139], v[32:35], v[124:127], v[136:139]
    s_waitcnt lgkmcnt(11)
    ds_read_b64_tr_b16 v[62:63], v8 offset:45056
    v_mfma_f32_16x16x32_bf16 v[132:135], v[36:39], v[120:123], v[132:135]
    ds_read_b64_tr_b16 v[32:33], v1 offset:49152
    buffer_load_dwordx4 v[220:223], v17, s[44:47], s5 offen offset:3072 sc1
    v_mfma_f32_16x16x32_bf16 v[140:143], v[36:39], v[124:127], v[140:143]
    s_waitcnt lgkmcnt(11)
    ds_read_b64_tr_b16 v[34:35], v1 offset:53248
    v_mfma_f32_16x16x32_bf16 v[144:147], v[40:43], v[120:123], v[144:147]
    ds_read_b64_tr_b16 v[36:37], v2 offset:49152
    v_mfma_f32_16x16x32_bf16 v[152:155], v[40:43], v[124:127], v[152:155]
    s_waitcnt lgkmcnt(11)
    ds_read_b64_tr_b16 v[38:39], v2 offset:53248
    v_mfma_f32_16x16x32_bf16 v[148:151], v[44:47], v[120:123], v[148:151]
    ds_read_b64_tr_b16 v[40:41], v3 offset:49152
    v_mfma_f32_16x16x32_bf16 v[156:159], v[44:47], v[124:127], v[156:159]
    s_waitcnt lgkmcnt(11)
    ds_read_b64_tr_b16 v[42:43], v3 offset:53248
    v_mfma_f32_16x16x32_bf16 v[160:163], v[48:51], v[120:123], v[160:163]
    ds_read_b64_tr_b16 v[44:45], v4 offset:49152
    s_waitcnt vmcnt(8)
    s_barrier
    v_mfma_f32_16x16x32_bf16 v[168:171], v[48:51], v[124:127], v[168:171]
    s_waitcnt lgkmcnt(11)
    ds_read_b64_tr_b16 v[46:47], v4 offset:53248
    v_mfma_f32_16x16x32_bf16 v[164:167], v[52:55], v[120:123], v[164:167]
    ds_read_b64_tr_b16 v[48:49], v5 offset:49152
    v_mfma_f32_16x16x32_bf16 v[172:175], v[52:55], v[124:127], v[172:175]
    s_waitcnt lgkmcnt(11)
    ds_read_b64_tr_b16 v[50:51], v5 offset:53248
    v_mfma_f32_16x16x32_bf16 v[176:179], v[56:59], v[120:123], v[176:179]
    ds_read_b64_tr_b16 v[52:53], v6 offset:49152
    v_mfma_f32_16x16x32_bf16 v[184:187], v[56:59], v[124:127], v[184:187]
    s_waitcnt lgkmcnt(11)
    ds_read_b64_tr_b16 v[54:55], v6 offset:53248
    v_mfma_f32_16x16x32_bf16 v[180:183], v[60:63], v[120:123], v[180:183]
    ds_read_b64_tr_b16 v[56:57], v7 offset:49152
    v_mfma_f32_16x16x32_bf16 v[188:191], v[60:63], v[124:127], v[188:191]
    s_waitcnt lgkmcnt(11)
    ds_read_b64_tr_b16 v[58:59], v7 offset:53248
    s_waitcnt vmcnt(7)
    v_mfma_f32_16x16x32_bf16 v[128:131], v[32:35], v[192:195], v[128:131]
    ds_read_b64_tr_b16 v[60:61], v8 offset:49152
    s_add_u32 s5, s58, 3
    s_and_b32 s5, s5, 3
    s_mul_i32 s5, s5, 40960
    s_lshl2_add_u32 s5, s65, s5
    s_add_u32 s5, s5, 0
    buffer_load_dwordx4 v[224:227], v17, s[44:47], s5 offen sc1
    s_waitcnt vmcnt(7)
    v_mfma_f32_16x16x32_bf16 v[136:139], v[32:35], v[196:199], v[136:139]
    s_waitcnt lgkmcnt(11)
    ds_read_b64_tr_b16 v[62:63], v8 offset:53248
    v_mfma_f32_16x16x32_bf16 v[132:135], v[36:39], v[192:195], v[132:135]
    ds_read_b64_tr_b16 v[32:33], v1 offset:57344
    buffer_load_dwordx4 v[228:231], v17, s[44:47], s5 offen offset:1024 sc1
    v_mfma_f32_16x16x32_bf16 v[140:143], v[36:39], v[196:199], v[140:143]
    s_waitcnt lgkmcnt(11)
    ds_read_b64_tr_b16 v[34:35], v1 offset:61440
    v_add_u32 v1, 0x8000, v1
    v_mfma_f32_16x16x32_bf16 v[144:147], v[40:43], v[192:195], v[144:147]
    ds_read_b64_tr_b16 v[36:37], v2 offset:57344
    buffer_load_dwordx4 v[232:235], v17, s[44:47], s5 offen offset:2048 sc1
    v_mfma_f32_16x16x32_bf16 v[152:155], v[40:43], v[196:199], v[152:155]
    s_waitcnt lgkmcnt(11)
    ds_read_b64_tr_b16 v[38:39], v2 offset:61440
    v_add_u32 v2, 0x8000, v2
    v_mfma_f32_16x16x32_bf16 v[148:151], v[44:47], v[192:195], v[148:151]
    ds_read_b64_tr_b16 v[40:41], v3 offset:57344
    buffer_load_dwordx4 v[236:239], v17, s[44:47], s5 offen offset:3072 sc1
    v_mfma_f32_16x16x32_bf16 v[156:159], v[44:47], v[196:199], v[156:159]
    s_waitcnt lgkmcnt(11)
    ds_read_b64_tr_b16 v[42:43], v3 offset:61440
    v_add_u32 v3, 0x8000, v3
    v_mfma_f32_16x16x32_bf16 v[160:163], v[48:51], v[192:195], v[160:163]
    ds_read_b64_tr_b16 v[44:45], v4 offset:57344
    v_mfma_f32_16x16x32_bf16 v[168:171], v[48:51], v[196:199], v[168:171]
    s_waitcnt lgkmcnt(11)
    ds_read_b64_tr_b16 v[46:47], v4 offset:61440
    v_add_u32 v4, 0x8000, v4
    v_mfma_f32_16x16x32_bf16 v[164:167], v[52:55], v[192:195], v[164:167]
    ds_read_b64_tr_b16 v[48:49], v5 offset:57344
    v_mfma_f32_16x16x32_bf16 v[172:175], v[52:55], v[196:199], v[172:175]
    s_waitcnt lgkmcnt(11)
    ds_read_b64_tr_b16 v[50:51], v5 offset:61440
    v_add_u32 v5, 0x8000, v5
    v_mfma_f32_16x16x32_bf16 v[176:179], v[56:59], v[192:195], v[176:179]
    ds_read_b64_tr_b16 v[52:53], v6 offset:57344
    v_mfma_f32_16x16x32_bf16 v[184:187], v[56:59], v[196:199], v[184:187]
    s_waitcnt lgkmcnt(11)
    ds_read_b64_tr_b16 v[54:55], v6 offset:61440
    v_add_u32 v6, 0x8000, v6
    v_mfma_f32_16x16x32_bf16 v[180:183], v[60:63], v[192:195], v[180:183]
    ds_read_b64_tr_b16 v[56:57], v7 offset:57344
    v_mfma_f32_16x16x32_bf16 v[188:191], v[60:63], v[196:199], v[188:191]
    s_waitcnt lgkmcnt(11)
    ds_read_b64_tr_b16 v[58:59], v7 offset:61440
    v_add_u32 v7, 0x8000, v7
    s_waitcnt vmcnt(9)
    v_mfma_f32_16x16x32_bf16 v[128:131], v[32:35], v[200:203], v[128:131]
    ds_read_b64_tr_b16 v[60:61], v8 offset:57344
    s_waitcnt vmcnt(8)
    v_mfma_f32_16x16x32_bf16 v[136:139], v[32:35], v[204:207], v[136:139]
    s_waitcnt lgkmcnt(11)
    ds_read_b64_tr_b16 v[62:63], v8 offset:61440
    v_add_u32 v8, 0x8000, v8
    v_mfma_f32_16x16x32_bf16 v[132:135], v[36:39], v[200:203], v[132:135]
    ds_read_b64_tr_b16 v[32:33], v1 offset:32768
    v_mfma_f32_16x16x32_bf16 v[140:143], v[36:39], v[204:207], v[140:143]
    s_waitcnt lgkmcnt(11)
    ds_read_b64_tr_b16 v[34:35], v1 offset:36864
    v_mfma_f32_16x16x32_bf16 v[144:147], v[40:43], v[200:203], v[144:147]
    ds_read_b64_tr_b16 v[36:37], v2 offset:32768
    v_mfma_f32_16x16x32_bf16 v[152:155], v[40:43], v[204:207], v[152:155]
    s_waitcnt lgkmcnt(11)
    ds_read_b64_tr_b16 v[38:39], v2 offset:36864
    v_mfma_f32_16x16x32_bf16 v[148:151], v[44:47], v[200:203], v[148:151]
    ds_read_b64_tr_b16 v[40:41], v3 offset:32768
    v_mfma_f32_16x16x32_bf16 v[156:159], v[44:47], v[204:207], v[156:159]
    s_waitcnt lgkmcnt(11)
    ds_read_b64_tr_b16 v[42:43], v3 offset:36864
    v_mfma_f32_16x16x32_bf16 v[160:163], v[48:51], v[200:203], v[160:163]
    ds_read_b64_tr_b16 v[44:45], v4 offset:32768
    v_mfma_f32_16x16x32_bf16 v[168:171], v[48:51], v[204:207], v[168:171]
    s_waitcnt lgkmcnt(11)
    ds_read_b64_tr_b16 v[46:47], v4 offset:36864
    v_mfma_f32_16x16x32_bf16 v[164:167], v[52:55], v[200:203], v[164:167]
    ds_read_b64_tr_b16 v[48:49], v5 offset:32768
    v_mfma_f32_16x16x32_bf16 v[172:175], v[52:55], v[204:207], v[172:175]
    s_waitcnt lgkmcnt(11)
    ds_read_b64_tr_b16 v[50:51], v5 offset:36864
    v_mfma_f32_16x16x32_bf16 v[176:179], v[56:59], v[200:203], v[176:179]
    ds_read_b64_tr_b16 v[52:53], v6 offset:32768
    v_mfma_f32_16x16x32_bf16 v[184:187], v[56:59], v[204:207], v[184:187]
    s_waitcnt lgkmcnt(11)
    ds_read_b64_tr_b16 v[54:55], v6 offset:36864
    v_mfma_f32_16x16x32_bf16 v[180:183], v[60:63], v[200:203], v[180:183]
    ds_read_b64_tr_b16 v[56:57], v7 offset:32768
    v_mfma_f32_16x16x32_bf16 v[188:191], v[60:63], v[204:207], v[188:191]
    s_waitcnt lgkmcnt(11)
    ds_read_b64_tr_b16 v[58:59], v7 offset:36864
    s_waitcnt vmcnt(7)
    v_mfma_f32_16x16x32_bf16 v[128:131], v[32:35], v[208:211], v[128:131]
    ds_read_b64_tr_b16 v[60:61], v8 offset:32768
    s_waitcnt vmcnt(6)
    v_mfma_f32_16x16x32_bf16 v[136:139], v[32:35], v[212:215], v[136:139]
    s_waitcnt lgkmcnt(11)
    ds_read_b64_tr_b16 v[62:63], v8 offset:36864
    v_mfma_f32_16x16x32_bf16 v[132:135], v[36:39], v[208:211], v[132:135]
    ds_read_b64_tr_b16 v[32:33], v1 offset:40960
    v_mfma_f32_16x16x32_bf16 v[140:143], v[36:39], v[212:215], v[140:143]
    s_waitcnt lgkmcnt(11)
    ds_read_b64_tr_b16 v[34:35], v1 offset:45056
    v_add_u32 v1, 0xc000, v1
    v_mfma_f32_16x16x32_bf16 v[144:147], v[40:43], v[208:211], v[144:147]
    ds_read_b64_tr_b16 v[36:37], v2 offset:40960
    v_mfma_f32_16x16x32_bf16 v[152:155], v[40:43], v[212:215], v[152:155]
    s_waitcnt lgkmcnt(11)
    ds_read_b64_tr_b16 v[38:39], v2 offset:45056
    v_add_u32 v2, 0xc000, v2
    v_mfma_f32_16x16x32_bf16 v[148:151], v[44:47], v[208:211], v[148:151]
    ds_read_b64_tr_b16 v[40:41], v3 offset:40960
    v_mfma_f32_16x16x32_bf16 v[156:159], v[44:47], v[212:215], v[156:159]
    s_waitcnt lgkmcnt(11)
    ds_read_b64_tr_b16 v[42:43], v3 offset:45056
    v_add_u32 v3, 0xc000, v3
    v_mfma_f32_16x16x32_bf16 v[160:163], v[48:51], v[208:211], v[160:163]
    ds_read_b64_tr_b16 v[44:45], v4 offset:40960
    v_mfma_f32_16x16x32_bf16 v[168:171], v[48:51], v[212:215], v[168:171]
    s_waitcnt lgkmcnt(11)
    ds_read_b64_tr_b16 v[46:47], v4 offset:45056
    v_add_u32 v4, 0xc000, v4
    v_mfma_f32_16x16x32_bf16 v[164:167], v[52:55], v[208:211], v[164:167]
    ds_read_b64_tr_b16 v[48:49], v5 offset:40960
    v_mfma_f32_16x16x32_bf16 v[172:175], v[52:55], v[212:215], v[172:175]
    s_waitcnt lgkmcnt(11)
    ds_read_b64_tr_b16 v[50:51], v5 offset:45056
    v_add_u32 v5, 0xc000, v5
    v_mfma_f32_16x16x32_bf16 v[176:179], v[56:59], v[208:211], v[176:179]
    ds_read_b64_tr_b16 v[52:53], v6 offset:40960
    v_mfma_f32_16x16x32_bf16 v[184:187], v[56:59], v[212:215], v[184:187]
    s_waitcnt lgkmcnt(11)
    ds_read_b64_tr_b16 v[54:55], v6 offset:45056
    v_add_u32 v6, 0xc000, v6
    v_mfma_f32_16x16x32_bf16 v[180:183], v[60:63], v[208:211], v[180:183]
    ds_read_b64_tr_b16 v[56:57], v7 offset:40960
    v_mfma_f32_16x16x32_bf16 v[188:191], v[60:63], v[212:215], v[188:191]
    s_waitcnt lgkmcnt(11)
    ds_read_b64_tr_b16 v[58:59], v7 offset:45056
    v_add_u32 v7, 0xc000, v7
    s_waitcnt vmcnt(5)
    v_mfma_f32_16x16x32_bf16 v[128:131], v[32:35], v[216:219], v[128:131]
    ds_read_b64_tr_b16 v[60:61], v8 offset:40960
    s_waitcnt vmcnt(4)
    v_mfma_f32_16x16x32_bf16 v[136:139], v[32:35], v[220:223], v[136:139]
    s_waitcnt lgkmcnt(11)
    ds_read_b64_tr_b16 v[62:63], v8 offset:45056
    v_add_u32 v8, 0xc000, v8
    v_mfma_f32_16x16x32_bf16 v[132:135], v[36:39], v[216:219], v[132:135]
    ds_read_b64_tr_b16 v[32:33], v1 offset:49152
    v_mfma_f32_16x16x32_bf16 v[140:143], v[36:39], v[220:223], v[140:143]
    s_waitcnt lgkmcnt(11)
    ds_read_b64_tr_b16 v[34:35], v1 offset:53248
    v_mfma_f32_16x16x32_bf16 v[144:147], v[40:43], v[216:219], v[144:147]
    ds_read_b64_tr_b16 v[36:37], v2 offset:49152
    v_mfma_f32_16x16x32_bf16 v[152:155], v[40:43], v[220:223], v[152:155]
    s_waitcnt lgkmcnt(11)
    ds_read_b64_tr_b16 v[38:39], v2 offset:53248
    v_mfma_f32_16x16x32_bf16 v[148:151], v[44:47], v[216:219], v[148:151]
    ds_read_b64_tr_b16 v[40:41], v3 offset:49152
    v_mfma_f32_16x16x32_bf16 v[156:159], v[44:47], v[220:223], v[156:159]
    s_waitcnt lgkmcnt(11)
    ds_read_b64_tr_b16 v[42:43], v3 offset:53248
    v_mfma_f32_16x16x32_bf16 v[160:163], v[48:51], v[216:219], v[160:163]
    ds_read_b64_tr_b16 v[44:45], v4 offset:49152
    v_mfma_f32_16x16x32_bf16 v[168:171], v[48:51], v[220:223], v[168:171]
    s_waitcnt lgkmcnt(11)
    ds_read_b64_tr_b16 v[46:47], v4 offset:53248
    v_mfma_f32_16x16x32_bf16 v[164:167], v[52:55], v[216:219], v[164:167]
    ds_read_b64_tr_b16 v[48:49], v5 offset:49152
    v_mfma_f32_16x16x32_bf16 v[172:175], v[52:55], v[220:223], v[172:175]
    s_waitcnt lgkmcnt(11)
    ds_read_b64_tr_b16 v[50:51], v5 offset:53248
    v_mfma_f32_16x16x32_bf16 v[176:179], v[56:59], v[216:219], v[176:179]
    ds_read_b64_tr_b16 v[52:53], v6 offset:49152
    v_mfma_f32_16x16x32_bf16 v[184:187], v[56:59], v[220:223], v[184:187]
    s_waitcnt lgkmcnt(11)
    ds_read_b64_tr_b16 v[54:55], v6 offset:53248
    v_mfma_f32_16x16x32_bf16 v[180:183], v[60:63], v[216:219], v[180:183]
    ds_read_b64_tr_b16 v[56:57], v7 offset:49152
    v_mfma_f32_16x16x32_bf16 v[188:191], v[60:63], v[220:223], v[188:191]
    s_waitcnt lgkmcnt(11)
    ds_read_b64_tr_b16 v[58:59], v7 offset:53248
    s_waitcnt vmcnt(3)
    v_mfma_f32_16x16x32_bf16 v[128:131], v[32:35], v[224:227], v[128:131]
    ds_read_b64_tr_b16 v[60:61], v8 offset:49152
    s_waitcnt vmcnt(2)
    v_mfma_f32_16x16x32_bf16 v[136:139], v[32:35], v[228:231], v[136:139]
    s_waitcnt lgkmcnt(11)
    ds_read_b64_tr_b16 v[62:63], v8 offset:53248
    v_mfma_f32_16x16x32_bf16 v[132:135], v[36:39], v[224:227], v[132:135]
    ds_read_b64_tr_b16 v[32:33], v1 offset:57344
    v_mfma_f32_16x16x32_bf16 v[140:143], v[36:39], v[228:231], v[140:143]
    s_waitcnt lgkmcnt(11)
    ds_read_b64_tr_b16 v[34:35], v1 offset:61440
    v_add_u32 v1, 0x4000, v1
    v_mfma_f32_16x16x32_bf16 v[144:147], v[40:43], v[224:227], v[144:147]
    ds_read_b64_tr_b16 v[36:37], v2 offset:57344
    s_barrier
    s_add_u32 s5, s58, 1
    s_and_b32 s5, s5, 3
    s_mul_i32 s5, s5, 40960
    s_lshl2_add_u32 s5, s65, s5
    s_add_u32 s5, s5, 20480
    buffer_load_dwordx4 v[240:243], v17, s[44:47], s5 offen sc1
    buffer_load_dwordx4 v[244:247], v17, s[44:47], s5 offen offset:1024 sc1
    buffer_load_dwordx4 v[248:251], v17, s[44:47], s5 offen offset:2048 sc1
    buffer_load_dwordx4 v[252:255], v17, s[44:47], s5 offen offset:3072 sc1
    v_mfma_f32_16x16x32_bf16 v[152:155], v[40:43], v[228:231], v[152:155]
    s_waitcnt lgkmcnt(11)
    ds_read_b64_tr_b16 v[38:39], v2 offset:61440
    v_add_u32 v2, 0x4000, v2
    v_mfma_f32_16x16x32_bf16 v[148:151], v[44:47], v[224:227], v[148:151]
    ds_read_b64_tr_b16 v[40:41], v3 offset:57344
    v_mfma_f32_16x16x32_bf16 v[156:159], v[44:47], v[228:231], v[156:159]
    s_waitcnt lgkmcnt(11)
    ds_read_b64_tr_b16 v[42:43], v3 offset:61440
    v_add_u32 v3, 0x4000, v3
    v_mfma_f32_16x16x32_bf16 v[160:163], v[48:51], v[224:227], v[160:163]
    ds_read_b64_tr_b16 v[44:45], v4 offset:57344
    v_mfma_f32_16x16x32_bf16 v[168:171], v[48:51], v[228:231], v[168:171]
    s_waitcnt lgkmcnt(11)
    ds_read_b64_tr_b16 v[46:47], v4 offset:61440
    v_add_u32 v4, 0x4000, v4
    v_mfma_f32_16x16x32_bf16 v[164:167], v[52:55], v[224:227], v[164:167]
    ds_read_b64_tr_b16 v[48:49], v5 offset:57344
    v_mfma_f32_16x16x32_bf16 v[172:175], v[52:55], v[228:231], v[172:175]
    s_waitcnt lgkmcnt(11)
    ds_read_b64_tr_b16 v[50:51], v5 offset:61440
    v_add_u32 v5, 0x4000, v5
    v_mfma_f32_16x16x32_bf16 v[176:179], v[56:59], v[224:227], v[176:179]
    ds_read_b64_tr_b16 v[52:53], v6 offset:57344
    v_mfma_f32_16x16x32_bf16 v[184:187], v[56:59], v[228:231], v[184:187]
    s_waitcnt lgkmcnt(11)
    ds_read_b64_tr_b16 v[54:55], v6 offset:61440
    v_add_u32 v6, 0x4000, v6
    v_mfma_f32_16x16x32_bf16 v[180:183], v[60:63], v[224:227], v[180:183]
    ds_read_b64_tr_b16 v[56:57], v7 offset:57344
    v_mfma_f32_16x16x32_bf16 v[188:191], v[60:63], v[228:231], v[188:191]
    s_waitcnt lgkmcnt(11)
    ds_read_b64_tr_b16 v[58:59], v7 offset:61440
    v_add_u32 v7, 0x4000, v7
    s_waitcnt vmcnt(5)
    v_mfma_f32_16x16x32_bf16 v[128:131], v[32:35], v[232:235], v[128:131]
    ds_read_b64_tr_b16 v[60:61], v8 offset:57344
    s_add_u32 s5, s58, 2
    s_and_b32 s5, s5, 3
    s_mul_i32 s5, s5, 40960
    s_lshl2_add_u32 s5, s65, s5
    s_add_u32 s5, s5, 20480
    buffer_load_dwordx4 v[64:67], v17, s[44:47], s5 offen sc1
    s_waitcnt vmcnt(5)
    v_mfma_f32_16x16x32_bf16 v[136:139], v[32:35], v[236:239], v[136:139]
    s_waitcnt lgkmcnt(11)
    ds_read_b64_tr_b16 v[62:63], v8 offset:61440
    v_add_u32 v8, 0x4000, v8
    v_mfma_f32_16x16x32_bf16 v[132:135], v[36:39], v[232:235], v[132:135]
    ds_read_b64_tr_b16 v[32:33], v1 offset:49152
    buffer_load_dwordx4 v[68:71], v17, s[44:47], s5 offen offset:1024 sc1
    v_mfma_f32_16x16x32_bf16 v[140:143], v[36:39], v[236:239], v[140:143]
    s_waitcnt lgkmcnt(11)
    ds_read_b64_tr_b16 v[34:35], v1 offset:53248
    v_mfma_f32_16x16x32_bf16 v[144:147], v[40:43], v[232:235], v[144:147]
    ds_read_b64_tr_b16 v[36:37], v2 offset:49152
    buffer_load_dwordx4 v[72:75], v17, s[44:47], s5 offen offset:2048 sc1
    v_mfma_f32_16x16x32_bf16 v[152:155], v[40:43], v[236:239], v[152:155]
    s_waitcnt lgkmcnt(11)
    ds_read_b64_tr_b16 v[38:39], v2 offset:53248
    v_mfma_f32_16x16x32_bf16 v[148:151], v[44:47], v[232:235], v[148:151]
    ds_read_b64_tr_b16 v[40:41], v3 offset:49152
    buffer_load_dwordx4 v[76:79], v17, s[44:47], s5 offen offset:3072 sc1
    v_mfma_f32_16x16x32_bf16 v[156:159], v[44:47], v[236:239], v[156:159]
    s_waitcnt lgkmcnt(11)
    ds_read_b64_tr_b16 v[42:43], v3 offset:53248
    v_mfma_f32_16x16x32_bf16 v[160:163], v[48:51], v[232:235], v[160:163]
    ds_read_b64_tr_b16 v[44:45], v4 offset:49152
    v_mfma_f32_16x16x32_bf16 v[168:171], v[48:51], v[236:239], v[168:171]
    s_waitcnt lgkmcnt(11)
    ds_read_b64_tr_b16 v[46:47], v4 offset:53248
    v_mfma_f32_16x16x32_bf16 v[164:167], v[52:55], v[232:235], v[164:167]
    ds_read_b64_tr_b16 v[48:49], v5 offset:49152
    v_mfma_f32_16x16x32_bf16 v[172:175], v[52:55], v[236:239], v[172:175]
    s_waitcnt lgkmcnt(11)
    ds_read_b64_tr_b16 v[50:51], v5 offset:53248
    v_mfma_f32_16x16x32_bf16 v[176:179], v[56:59], v[232:235], v[176:179]
    ds_read_b64_tr_b16 v[52:53], v6 offset:49152
    s_add_u32 s5, s58, 3
    s_and_b32 s5, s5, 3
    s_mul_i32 s5, s5, 40960
    s_lshl2_add_u32 s5, s65, s5
    s_add_u32 s5, s5, 20480
    buffer_load_dwordx4 v[80:83], v17, s[44:47], s5 offen sc1
    v_mfma_f32_16x16x32_bf16 v[184:187], v[56:59], v[236:239], v[184:187]
    s_waitcnt lgkmcnt(11)
    ds_read_b64_tr_b16 v[54:55], v6 offset:53248
    v_mfma_f32_16x16x32_bf16 v[180:183], v[60:63], v[232:235], v[180:183]
    ds_read_b64_tr_b16 v[56:57], v7 offset:49152
    buffer_load_dwordx4 v[84:87], v17, s[44:47], s5 offen offset:1024 sc1
    v_mfma_f32_16x16x32_bf16 v[188:191], v[60:63], v[236:239], v[188:191]
    s_waitcnt lgkmcnt(11)
    ds_read_b64_tr_b16 v[58:59], v7 offset:53248
    s_waitcnt vmcnt(9)
    v_mfma_f32_16x16x32_bf16 v[128:131], v[32:35], v[240:243], v[128:131]
    ds_read_b64_tr_b16 v[60:61], v8 offset:49152
    buffer_load_dwordx4 v[88:91], v17, s[44:47], s5 offen offset:2048 sc1
    s_waitcnt vmcnt(9)
    v_mfma_f32_16x16x32_bf16 v[136:139], v[32:35], v[244:247], v[136:139]
    s_waitcnt lgkmcnt(11)
    ds_read_b64_tr_b16 v[62:63], v8 offset:53248
    v_mfma_f32_16x16x32_bf16 v[132:135], v[36:39], v[240:243], v[132:135]
    ds_read_b64_tr_b16 v[32:33], v1 offset:57344
    buffer_load_dwordx4 v[92:95], v17, s[44:47], s5 offen offset:3072 sc1
    v_mfma_f32_16x16x32_bf16 v[140:143], v[36:39], v[244:247], v[140:143]
    s_waitcnt lgkmcnt(11)
    ds_read_b64_tr_b16 v[34:35], v1 offset:61440
    v_mfma_f32_16x16x32_bf16 v[144:147], v[40:43], v[240:243], v[144:147]
    ds_read_b64_tr_b16 v[36:37], v2 offset:57344
    v_mfma_f32_16x16x32_bf16 v[152:155], v[40:43], v[244:247], v[152:155]
    s_waitcnt lgkmcnt(11)
    ds_read_b64_tr_b16 v[38:39], v2 offset:61440
    v_mfma_f32_16x16x32_bf16 v[148:151], v[44:47], v[240:243], v[148:151]
    ds_read_b64_tr_b16 v[40:41], v3 offset:57344
    v_mfma_f32_16x16x32_bf16 v[156:159], v[44:47], v[244:247], v[156:159]
    s_waitcnt lgkmcnt(11)
    ds_read_b64_tr_b16 v[42:43], v3 offset:61440
    v_mfma_f32_16x16x32_bf16 v[160:163], v[48:51], v[240:243], v[160:163]
    ds_read_b64_tr_b16 v[44:45], v4 offset:57344
    v_mfma_f32_16x16x32_bf16 v[168:171], v[48:51], v[244:247], v[168:171]
    s_waitcnt lgkmcnt(11)
    ds_read_b64_tr_b16 v[46:47], v4 offset:61440
    v_mfma_f32_16x16x32_bf16 v[164:167], v[52:55], v[240:243], v[164:167]
    ds_read_b64_tr_b16 v[48:49], v5 offset:57344
    v_mfma_f32_16x16x32_bf16 v[172:175], v[52:55], v[244:247], v[172:175]
    s_waitcnt lgkmcnt(11)
    ds_read_b64_tr_b16 v[50:51], v5 offset:61440
    v_mfma_f32_16x16x32_bf16 v[176:179], v[56:59], v[240:243], v[176:179]
    ds_read_b64_tr_b16 v[52:53], v6 offset:57344
    v_mfma_f32_16x16x32_bf16 v[184:187], v[56:59], v[244:247], v[184:187]
    s_waitcnt lgkmcnt(11)
    ds_read_b64_tr_b16 v[54:55], v6 offset:61440
    v_mfma_f32_16x16x32_bf16 v[180:183], v[60:63], v[240:243], v[180:183]
    ds_read_b64_tr_b16 v[56:57], v7 offset:57344
    v_mfma_f32_16x16x32_bf16 v[188:191], v[60:63], v[244:247], v[188:191]
    s_waitcnt lgkmcnt(11)
    ds_read_b64_tr_b16 v[58:59], v7 offset:61440
    s_waitcnt vmcnt(9)
    v_mfma_f32_16x16x32_bf16 v[128:131], v[32:35], v[248:251], v[128:131]
    ds_read_b64_tr_b16 v[60:61], v8 offset:57344
    s_waitcnt vmcnt(8)
    v_mfma_f32_16x16x32_bf16 v[136:139], v[32:35], v[252:255], v[136:139]
    s_waitcnt lgkmcnt(11)
    ds_read_b64_tr_b16 v[62:63], v8 offset:61440
    v_mfma_f32_16x16x32_bf16 v[132:135], v[36:39], v[248:251], v[132:135]
    ds_read_b64_tr_b16 v[32:33], v1
    v_mfma_f32_16x16x32_bf16 v[140:143], v[36:39], v[252:255], v[140:143]
    s_waitcnt lgkmcnt(11)
    ds_read_b64_tr_b16 v[34:35], v1 offset:4096
    v_mfma_f32_16x16x32_bf16 v[144:147], v[40:43], v[248:251], v[144:147]
    ds_read_b64_tr_b16 v[36:37], v2
    v_mfma_f32_16x16x32_bf16 v[152:155], v[40:43], v[252:255], v[152:155]
    s_waitcnt lgkmcnt(11)
    ds_read_b64_tr_b16 v[38:39], v2 offset:4096
    v_mfma_f32_16x16x32_bf16 v[148:151], v[44:47], v[248:251], v[148:151]
    ds_read_b64_tr_b16 v[40:41], v1 offset:8192
    v_mfma_f32_16x16x32_bf16 v[156:159], v[44:47], v[252:255], v[156:159]
    s_waitcnt lgkmcnt(11)
    ds_read_b64_tr_b16 v[42:43], v1 offset:12288
    v_add_u32 v1, 0xffffc000, v1
    v_mfma_f32_16x16x32_bf16 v[160:163], v[48:51], v[248:251], v[160:163]
    ds_read_b64_tr_b16 v[44:45], v2 offset:8192
    v_mfma_f32_16x16x32_bf16 v[168:171], v[48:51], v[252:255], v[168:171]
    s_waitcnt lgkmcnt(11)
    ds_read_b64_tr_b16 v[46:47], v2 offset:12288
    v_add_u32 v2, 0xffffc000, v2
    v_mfma_f32_16x16x32_bf16 v[164:167], v[52:55], v[248:251], v[164:167]
    ds_read_b64_tr_b16 v[48:49], v1
    v_mfma_f32_16x16x32_bf16 v[172:175], v[52:55], v[252:255], v[172:175]
    s_waitcnt lgkmcnt(11)
    ds_read_b64_tr_b16 v[50:51], v1 offset:4096
    v_mfma_f32_16x16x32_bf16 v[176:179], v[56:59], v[248:251], v[176:179]
    ds_read_b64_tr_b16 v[52:53], v2
    v_mfma_f32_16x16x32_bf16 v[184:187], v[56:59], v[252:255], v[184:187]
    s_waitcnt lgkmcnt(11)
    ds_read_b64_tr_b16 v[54:55], v2 offset:4096
    v_mfma_f32_16x16x32_bf16 v[180:183], v[60:63], v[248:251], v[180:183]
    ds_read_b64_tr_b16 v[56:57], v1 offset:8192
    v_mfma_f32_16x16x32_bf16 v[188:191], v[60:63], v[252:255], v[188:191]
    s_waitcnt lgkmcnt(11)
    ds_read_b64_tr_b16 v[58:59], v1 offset:12288
    s_mul_i32 s70, s60, 40960
    s_lshl_b32 s5, s4, 13
    s_add_u32 s70, s70, s5
    s_add_u32 s7, s70, 4096
    s_waitcnt vmcnt(7)
    v_mfma_f32_16x16x32_bf16 v[128:131], v[32:35], v[64:67], v[128:131]
    ds_read_b64_tr_b16 v[60:61], v2 offset:8192
    s_waitcnt vmcnt(6)
    v_mfma_f32_16x16x32_bf16 v[136:139], v[32:35], v[68:71], v[136:139]
    s_waitcnt lgkmcnt(11)
    ds_read_b64_tr_b16 v[62:63], v2 offset:12288
    v_mfma_f32_16x16x32_bf16 v[132:135], v[36:39], v[64:67], v[132:135]
    ds_read_b64_tr_b16 v[32:33], v5
    v_mfma_f32_16x16x32_bf16 v[140:143], v[36:39], v[68:71], v[140:143]
    s_waitcnt lgkmcnt(11)
    ds_read_b64_tr_b16 v[34:35], v5 offset:4096
    s_waitcnt vmcnt(5)
    v_mfma_f32_16x16x32_bf16 v[128:131], v[40:43], v[72:75], v[128:131]
    ds_read_b64_tr_b16 v[36:37], v6
    s_waitcnt vmcnt(4)
    v_mfma_f32_16x16x32_bf16 v[136:139], v[40:43], v[76:79], v[136:139]
    s_waitcnt lgkmcnt(11)
    ds_read_b64_tr_b16 v[38:39], v6 offset:4096
    v_mfma_f32_16x16x32_bf16 v[132:135], v[44:47], v[72:75], v[132:135]
    ds_read_b64_tr_b16 v[40:41], v5 offset:8192
    v_mfma_f32_16x16x32_bf16 v[140:143], v[44:47], v[76:79], v[140:143]
    s_waitcnt lgkmcnt(11)
    ds_read_b64_tr_b16 v[42:43], v5 offset:12288
    v_add_u32 v5, 0xffffc000, v5
    s_waitcnt vmcnt(3)
    v_mfma_f32_16x16x32_bf16 v[128:131], v[48:51], v[80:83], v[128:131]
    ds_read_b64_tr_b16 v[44:45], v6 offset:8192
    s_waitcnt vmcnt(2)
    v_mfma_f32_16x16x32_bf16 v[136:139], v[48:51], v[84:87], v[136:139]
    s_waitcnt lgkmcnt(11)
    ds_read_b64_tr_b16 v[46:47], v6 offset:12288
    v_add_u32 v6, 0xffffc000, v6
    v_mfma_f32_16x16x32_bf16 v[132:135], v[52:55], v[80:83], v[132:135]
    ds_read_b64_tr_b16 v[48:49], v5
    v_mfma_f32_16x16x32_bf16 v[140:143], v[52:55], v[84:87], v[140:143]
    s_waitcnt lgkmcnt(11)
    ds_read_b64_tr_b16 v[50:51], v5 offset:4096
    s_waitcnt vmcnt(1)
    v_mfma_f32_16x16x32_bf16 v[128:131], v[56:59], v[88:91], v[128:131]
    ds_read_b64_tr_b16 v[52:53], v6
    s_waitcnt vmcnt(0)
    v_mfma_f32_16x16x32_bf16 v[136:139], v[56:59], v[92:95], v[136:139]
    s_waitcnt lgkmcnt(11)
    ds_read_b64_tr_b16 v[54:55], v6 offset:4096
    v_mfma_f32_16x16x32_bf16 v[132:135], v[60:63], v[88:91], v[132:135]
    ds_read_b64_tr_b16 v[56:57], v5 offset:8192
    v_mfma_f32_16x16x32_bf16 v[140:143], v[60:63], v[92:95], v[140:143]
    s_waitcnt lgkmcnt(11)
    ds_read_b64_tr_b16 v[58:59], v5 offset:12288
    v_mfma_f32_16x16x32_bf16 v[160:163], v[32:35], v[64:67], v[160:163]
    ds_read_b64_tr_b16 v[60:61], v6 offset:8192
    v_mfma_f32_16x16x32_bf16 v[168:171], v[32:35], v[68:71], v[168:171]
    s_waitcnt lgkmcnt(11)
    ds_read_b64_tr_b16 v[62:63], v6 offset:12288
    v_cvt_pk_bf16_f32 v128, v128, v129
    v_mfma_f32_16x16x32_bf16 v[164:167], v[36:39], v[64:67], v[164:167]
    ds_read_b64_tr_b16 v[32:33], v3
    v_cvt_pk_bf16_f32 v129, v130, v131
    v_mfma_f32_16x16x32_bf16 v[172:175], v[36:39], v[68:71], v[172:175]
    s_waitcnt lgkmcnt(11)
    ds_read_b64_tr_b16 v[34:35], v3 offset:4096
    v_cvt_pk_bf16_f32 v130, v132, v133
    v_mfma_f32_16x16x32_bf16 v[160:163], v[40:43], v[72:75], v[160:163]
    ds_read_b64_tr_b16 v[36:37], v4
    v_cvt_pk_bf16_f32 v131, v134, v135
    v_mfma_f32_16x16x32_bf16 v[168:171], v[40:43], v[76:79], v[168:171]
    s_waitcnt lgkmcnt(11)
    ds_read_b64_tr_b16 v[38:39], v4 offset:4096
    v_mfma_f32_16x16x32_bf16 v[164:167], v[44:47], v[72:75], v[164:167]
    ds_read_b64_tr_b16 v[40:41], v3 offset:8192
    buffer_store_dwordx4 v[128:131], v17, s[48:51], s70 offen sc1
    v_mfma_f32_16x16x32_bf16 v[172:175], v[44:47], v[76:79], v[172:175]
    s_waitcnt lgkmcnt(11)
    ds_read_b64_tr_b16 v[42:43], v3 offset:12288
    v_add_u32 v3, 0xffffc000, v3
    v_cvt_pk_bf16_f32 v132, v136, v137
    v_mfma_f32_16x16x32_bf16 v[160:163], v[48:51], v[80:83], v[160:163]
    ds_read_b64_tr_b16 v[44:45], v4 offset:8192
    v_cvt_pk_bf16_f32 v133, v138, v139
    v_mfma_f32_16x16x32_bf16 v[168:171], v[48:51], v[84:87], v[168:171]
    s_waitcnt lgkmcnt(11)
    ds_read_b64_tr_b16 v[46:47], v4 offset:12288
    v_add_u32 v4, 0xffffc000, v4
    v_mfma_f32_16x16x32_bf16 v[164:167], v[52:55], v[80:83], v[164:167]
    ds_read_b64_tr_b16 v[48:49], v3
    v_cvt_pk_bf16_f32 v134, v140, v141
    v_mfma_f32_16x16x32_bf16 v[172:175], v[52:55], v[84:87], v[172:175]
    s_waitcnt lgkmcnt(11)
    ds_read_b64_tr_b16 v[50:51], v3 offset:4096
    v_cvt_pk_bf16_f32 v135, v142, v143
    v_mfma_f32_16x16x32_bf16 v[160:163], v[56:59], v[88:91], v[160:163]
    ds_read_b64_tr_b16 v[52:53], v4
    buffer_store_dwordx4 v[132:135], v17, s[48:51], s70 offen offset:1024 sc1
    v_mfma_f32_16x16x32_bf16 v[168:171], v[56:59], v[92:95], v[168:171]
    s_waitcnt lgkmcnt(11)
    ds_read_b64_tr_b16 v[54:55], v4 offset:4096
    v_mfma_f32_16x16x32_bf16 v[164:167], v[60:63], v[88:91], v[164:167]
    ds_read_b64_tr_b16 v[56:57], v3 offset:8192
    v_mfma_f32_16x16x32_bf16 v[172:175], v[60:63], v[92:95], v[172:175]
    s_waitcnt lgkmcnt(11)
    ds_read_b64_tr_b16 v[58:59], v3 offset:12288
    v_mfma_f32_16x16x32_bf16 v[144:147], v[32:35], v[64:67], v[144:147]
    ds_read_b64_tr_b16 v[60:61], v4 offset:8192
    v_mfma_f32_16x16x32_bf16 v[152:155], v[32:35], v[68:71], v[152:155]
    s_waitcnt lgkmcnt(11)
    ds_read_b64_tr_b16 v[62:63], v4 offset:12288
    v_cvt_pk_bf16_f32 v160, v160, v161
    v_mfma_f32_16x16x32_bf16 v[148:151], v[36:39], v[64:67], v[148:151]
    ds_read_b64_tr_b16 v[32:33], v7
    v_cvt_pk_bf16_f32 v161, v162, v163
    v_mfma_f32_16x16x32_bf16 v[156:159], v[36:39], v[68:71], v[156:159]
    s_waitcnt lgkmcnt(11)
    ds_read_b64_tr_b16 v[34:35], v7 offset:4096
    v_cvt_pk_bf16_f32 v162, v164, v165
    v_mfma_f32_16x16x32_bf16 v[144:147], v[40:43], v[72:75], v[144:147]
    ds_read_b64_tr_b16 v[36:37], v8
    v_cvt_pk_bf16_f32 v163, v166, v167
    v_mfma_f32_16x16x32_bf16 v[152:155], v[40:43], v[76:79], v[152:155]
    s_waitcnt lgkmcnt(11)
    ds_read_b64_tr_b16 v[38:39], v8 offset:4096
    v_mfma_f32_16x16x32_bf16 v[148:151], v[44:47], v[72:75], v[148:151]
    ds_read_b64_tr_b16 v[40:41], v7 offset:8192
    buffer_store_dwordx4 v[160:163], v17, s[48:51], s7 offen sc1
    v_mfma_f32_16x16x32_bf16 v[156:159], v[44:47], v[76:79], v[156:159]
    s_waitcnt lgkmcnt(11)
    ds_read_b64_tr_b16 v[42:43], v7 offset:12288
    v_add_u32 v7, 0xffffc000, v7
    v_cvt_pk_bf16_f32 v164, v168, v169
    v_mfma_f32_16x16x32_bf16 v[144:147], v[48:51], v[80:83], v[144:147]
    ds_read_b64_tr_b16 v[44:45], v8 offset:8192
    v_cvt_pk_bf16_f32 v165, v170, v171
    v_mfma_f32_16x16x32_bf16 v[152:155], v[48:51], v[84:87], v[152:155]
    s_waitcnt lgkmcnt(11)
    ds_read_b64_tr_b16 v[46:47], v8 offset:12288
    v_add_u32 v8, 0xffffc000, v8
    v_mfma_f32_16x16x32_bf16 v[148:151], v[52:55], v[80:83], v[148:151]
    ds_read_b64_tr_b16 v[48:49], v7
    v_cvt_pk_bf16_f32 v166, v172, v173
    v_mfma_f32_16x16x32_bf16 v[156:159], v[52:55], v[84:87], v[156:159]
    s_waitcnt lgkmcnt(11)
    ds_read_b64_tr_b16 v[50:51], v7 offset:4096
    v_cvt_pk_bf16_f32 v167, v174, v175
    v_mfma_f32_16x16x32_bf16 v[144:147], v[56:59], v[88:91], v[144:147]
    ds_read_b64_tr_b16 v[52:53], v8
    buffer_store_dwordx4 v[164:167], v17, s[48:51], s7 offen offset:1024 sc1
    v_mfma_f32_16x16x32_bf16 v[152:155], v[56:59], v[92:95], v[152:155]
    s_waitcnt lgkmcnt(11)
    ds_read_b64_tr_b16 v[54:55], v8 offset:4096
    v_mfma_f32_16x16x32_bf16 v[148:151], v[60:63], v[88:91], v[148:151]
    ds_read_b64_tr_b16 v[56:57], v7 offset:8192
    v_mfma_f32_16x16x32_bf16 v[156:159], v[60:63], v[92:95], v[156:159]
    s_waitcnt lgkmcnt(11)
    ds_read_b64_tr_b16 v[58:59], v7 offset:12288
    s_barrier
    v_mfma_f32_16x16x32_bf16 v[176:179], v[32:35], v[64:67], v[176:179]
    ds_read_b64_tr_b16 v[60:61], v8 offset:8192
    v_mfma_f32_16x16x32_bf16 v[184:187], v[32:35], v[68:71], v[184:187]
    s_waitcnt lgkmcnt(11)
    ds_read_b64_tr_b16 v[62:63], v8 offset:12288
    v_cvt_pk_bf16_f32 v144, v144, v145
    v_mfma_f32_16x16x32_bf16 v[180:183], v[36:39], v[64:67], v[180:183]
    v_cvt_pk_bf16_f32 v145, v146, v147
    v_mfma_f32_16x16x32_bf16 v[188:191], v[36:39], v[68:71], v[188:191]
    s_waitcnt lgkmcnt(10)
    v_cvt_pk_bf16_f32 v146, v148, v149
    v_mfma_f32_16x16x32_bf16 v[176:179], v[40:43], v[72:75], v[176:179]
    v_cvt_pk_bf16_f32 v147, v150, v151
    v_mfma_f32_16x16x32_bf16 v[184:187], v[40:43], v[76:79], v[184:187]
    s_waitcnt lgkmcnt(8)
    v_mfma_f32_16x16x32_bf16 v[180:183], v[44:47], v[72:75], v[180:183]
    buffer_store_dwordx4 v[144:147], v17, s[48:51], s70 offen offset:2048 sc1
    v_mfma_f32_16x16x32_bf16 v[188:191], v[44:47], v[76:79], v[188:191]
    s_waitcnt lgkmcnt(6)
    v_cvt_pk_bf16_f32 v148, v152, v153
    v_mfma_f32_16x16x32_bf16 v[176:179], v[48:51], v[80:83], v[176:179]
    v_cvt_pk_bf16_f32 v149, v154, v155
    v_mfma_f32_16x16x32_bf16 v[184:187], v[48:51], v[84:87], v[184:187]
    s_waitcnt lgkmcnt(4)
    v_mfma_f32_16x16x32_bf16 v[180:183], v[52:55], v[80:83], v[180:183]
    v_cvt_pk_bf16_f32 v150, v156, v157
    v_mfma_f32_16x16x32_bf16 v[188:191], v[52:55], v[84:87], v[188:191]
    s_waitcnt lgkmcnt(2)
    v_cvt_pk_bf16_f32 v151, v158, v159
    v_mfma_f32_16x16x32_bf16 v[176:179], v[56:59], v[88:91], v[176:179]
    buffer_store_dwordx4 v[148:151], v17, s[48:51], s70 offen offset:3072 sc1
    v_mfma_f32_16x16x32_bf16 v[184:187], v[56:59], v[92:95], v[184:187]
    s_waitcnt lgkmcnt(0)
    v_mfma_f32_16x16x32_bf16 v[180:183], v[60:63], v[88:91], v[180:183]
    v_mfma_f32_16x16x32_bf16 v[188:191], v[60:63], v[92:95], v[188:191]
    v_cvt_pk_bf16_f32 v176, v176, v177
    v_cvt_pk_bf16_f32 v177, v178, v179
    s_nop 1
    v_cvt_pk_bf16_f32 v178, v180, v181
    v_cvt_pk_bf16_f32 v179, v182, v183
    buffer_store_dwordx4 v[176:179], v17, s[48:51], s7 offen offset:2048 sc1
    v_cvt_pk_bf16_f32 v180, v184, v185
    v_cvt_pk_bf16_f32 v181, v186, v187
    v_cvt_pk_bf16_f32 v182, v188, v189
    v_cvt_pk_bf16_f32 v183, v190, v191
    buffer_store_dwordx4 v[180:183], v17, s[48:51], s7 offen offset:3072 sc1
    s_waitcnt lgkmcnt(0)
    s_cmp_lg_u32 s68, 0
    s_cbranch_scc1 L_nonce_m_ok
    s_mov_b32 s71, 0
L_nonce_m_loop:
    s_load_dwordx2 s[68:69], s[20:21], 0 glc
    s_waitcnt lgkmcnt(0)
    s_cmp_lg_u32 s68, 0
    s_cbranch_scc1 L_nonce_m_ok
    s_add_u32 s71, s71, 1
    s_cmp_lt_u32 s71, 200000
    s_cbranch_scc1 L_nonce_m_loop
L_nonce_m_ok:
    v_and_b32 v18, 15, v0
    v_lshlrev_b32 v18, 10, v18
    v_and_b32 v19, 48, v0
    v_add_u32 v18, v18, v19
    s_lshl_b32 s70, s61, 2
    s_add_u32 s70, s70, s57
    s_lshl_b32 s70, s70, 12
    s_add_u32 s70, s70, 65536
    s_lshl_b32 s5, s60, 3
    s_add_u32 s5, s5, s70
    s_add_u32 s5, s5, s65
    s_waitcnt vmcnt(4)
    s_nop 0
    s_atomic_swap_x2 s[68:69], s[22:23], s5
    s_nop 0
    s_atomic_swap_x2 s[68:69], s[22:23], s5 offset:512
    s_waitcnt vmcnt(0)
    s_nop 0
    s_atomic_swap_x2 s[68:69], s[22:23], s5 offset:128
    s_nop 0
    s_atomic_swap_x2 s[68:69], s[22:23], s5 offset:640
    s_lshl_b32 s5, s60, 2
    s_lshr_b32 s6, s4, 1
    s_add_u32 s5, s5, s6
    s_lshl_b32 s5, s5, 7
    s_add_u32 s70, s70, s5
    s_mov_b32 s71, 0
L_p2m_loop:
    s_load_dwordx16 s[24:39], s[22:23], s70 glc
    s_waitcnt lgkmcnt(0)
    s_xor_b64 s[24:25], s[24:25], s[68:69]
    s_xor_b64 s[26:27], s[26:27], s[68:69]
    s_xor_b64 s[28:29], s[28:29], s[68:69]
    s_xor_b64 s[30:31], s[30:31], s[68:69]
    s_xor_b64 s[32:33], s[32:33], s[68:69]
    s_xor_b64 s[34:35], s[34:35], s[68:69]
    s_xor_b64 s[36:37], s[36:37], s[68:69]
    s_xor_b64 s[38:39], s[38:39], s[68:69]
    s_or_b64 s[24:25], s[24:25], s[26:27]
    s_or_b64 s[24:25], s[24:25], s[28:29]
    s_or_b64 s[24:25], s[24:25], s[30:31]
    s_or_b64 s[24:25], s[24:25], s[32:33]
    s_or_b64 s[24:25], s[24:25], s[34:35]
    s_or_b64 s[24:25], s[24:25], s[36:37]
    s_or_b64 s[24:25], s[24:25], s[38:39]
    s_cmp_eq_u64 s[24:25], 0
    s_cbranch_scc1 L_p2m_ok
    s_add_u32 s71, s71, 1
    s_cmp_lt_u32 s71, 200000
    s_cbranch_scc1 L_p2m_loop
L_p2m_ok:
    s_lshl_b32 s6, s60, 12
    s_add_u32 s6, s6, s65
    s_add_u32 s7, s6, 0
    buffer_load_dwordx4 v[64:67], v17, s[48:51], s7 offen sc1
    s_add_u32 s7, s6, 40960
    buffer_load_dwordx4 v[68:71], v17, s[48:51], s7 offen sc1
    s_add_u32 s7, s6, 81920
    buffer_load_dwordx4 v[72:75], v17, s[48:51], s7 offen sc1
    s_add_u32 s7, s6, 122880
    buffer_load_dwordx4 v[76:79], v17, s[48:51], s7 offen sc1
    s_add_u32 s7, s6, 163840
    buffer_load_dwordx4 v[80:83], v17, s[48:51], s7 offen sc1
    s_add_u32 s7, s6, 204800
    buffer_load_dwordx4 v[84:87], v17, s[48:51], s7 offen sc1
    s_add_u32 s7, s6, 245760
    buffer_load_dwordx4 v[88:91], v17, s[48:51], s7 offen sc1
    s_add_u32 s7, s6, 286720
    buffer_load_dwordx4 v[92:95], v17, s[48:51], s7 offen sc1
    s_waitcnt vmcnt(7)
    v_lshlrev_b32 v32, 16, v64
    v_and_b32 v33, 0xffff0000, v64
    v_lshlrev_b32 v34, 16, v65
    v_and_b32 v35, 0xffff0000, v65
    v_lshlrev_b32 v36, 16, v66
    v_and_b32 v37, 0xffff0000, v66
    v_lshlrev_b32 v38, 16, v67
    v_and_b32 v39, 0xffff0000, v67
    s_waitcnt vmcnt(6)
    v_lshlrev_b32 v40, 16, v68
    v_and_b32 v41, 0xffff0000, v68
    v_add_f32 v32, v32, v40
    v_add_f32 v33, v33, v41
    v_lshlrev_b32 v40, 16, v69
    v_and_b32 v41, 0xffff0000, v69
    v_add_f32 v34, v34, v40
    v_add_f32 v35, v35, v41
    v_lshlrev_b32 v40, 16, v70
    v_and_b32 v41, 0xffff0000, v70
    v_add_f32 v36, v36, v40
    v_add_f32 v37, v37, v41
    v_lshlrev_b32 v40, 16, v71
    v_and_b32 v41, 0xffff0000, v71
    v_add_f32 v38, v38, v40
    v_add_f32 v39, v39, v41
    s_waitcnt vmcnt(5)
    v_lshlrev_b32 v40, 16, v72
    v_and_b32 v41, 0xffff0000, v72
    v_add_f32 v32, v32, v40
    v_add_f32 v33, v33, v41
    v_lshlrev_b32 v40, 16, v73
    v_and_b32 v41, 0xffff0000, v73
    v_add_f32 v34, v34, v40
    v_add_f32 v35, v35, v41
    v_lshlrev_b32 v40, 16, v74
    v_and_b32 v41, 0xffff0000, v74
    v_add_f32 v36, v36, v40
    v_add_f32 v37, v37, v41
    v_lshlrev_b32 v40, 16, v75
    v_and_b32 v41, 0xffff0000, v75
    v_add_f32 v38, v38, v40
    v_add_f32 v39, v39, v41
    s_waitcnt vmcnt(4)
    v_lshlrev_b32 v40, 16, v76
    v_and_b32 v41, 0xffff0000, v76
    v_add_f32 v32, v32, v40
    v_add_f32 v33, v33, v41
    v_lshlrev_b32 v40, 16, v77
    v_and_b32 v41, 0xffff0000, v77
    v_add_f32 v34, v34, v40
    v_add_f32 v35, v35, v41
    v_lshlrev_b32 v40, 16, v78
    v_and_b32 v41, 0xffff0000, v78
    v_add_f32 v36, v36, v40
    v_add_f32 v37, v37, v41
    v_lshlrev_b32 v40, 16, v79
    v_and_b32 v41, 0xffff0000, v79
    v_add_f32 v38, v38, v40
    v_add_f32 v39, v39, v41
    s_waitcnt vmcnt(3)
    v_lshlrev_b32 v40, 16, v80
    v_and_b32 v41, 0xffff0000, v80
    v_add_f32 v32, v32, v40
    v_add_f32 v33, v33, v41
    v_lshlrev_b32 v40, 16, v81
    v_and_b32 v41, 0xffff0000, v81
    v_add_f32 v34, v34, v40
    v_add_f32 v35, v35, v41
    v_lshlrev_b32 v40, 16, v82
    v_and_b32 v41, 0xffff0000, v82
    v_add_f32 v36, v36, v40
    v_add_f32 v37, v37, v41
    v_lshlrev_b32 v40, 16, v83
    v_and_b32 v41, 0xffff0000, v83
    v_add_f32 v38, v38, v40
    v_add_f32 v39, v39, v41
    s_waitcnt vmcnt(2)
    v_lshlrev_b32 v40, 16, v84
    v_and_b32 v41, 0xffff0000, v84
    v_add_f32 v32, v32, v40
    v_add_f32 v33, v33, v41
    v_lshlrev_b32 v40, 16, v85
    v_and_b32 v41, 0xffff0000, v85
    v_add_f32 v34, v34, v40
    v_add_f32 v35, v35, v41
    v_lshlrev_b32 v40, 16, v86
    v_and_b32 v41, 0xffff0000, v86
    v_add_f32 v36, v36, v40
    v_add_f32 v37, v37, v41
    v_lshlrev_b32 v40, 16, v87
    v_and_b32 v41, 0xffff0000, v87
    v_add_f32 v38, v38, v40
    v_add_f32 v39, v39, v41
    s_waitcnt vmcnt(1)
    v_lshlrev_b32 v40, 16, v88
    v_and_b32 v41, 0xffff0000, v88
    v_add_f32 v32, v32, v40
    v_add_f32 v33, v33, v41
    v_lshlrev_b32 v40, 16, v89
    v_and_b32 v41, 0xffff0000, v89
    v_add_f32 v34, v34, v40
    v_add_f32 v35, v35, v41
    v_lshlrev_b32 v40, 16, v90
    v_and_b32 v41, 0xffff0000, v90
    v_add_f32 v36, v36, v40
    v_add_f32 v37, v37, v41
    v_lshlrev_b32 v40, 16, v91
    v_and_b32 v41, 0xffff0000, v91
    v_add_f32 v38, v38, v40
    v_add_f32 v39, v39, v41
    s_waitcnt vmcnt(0)
    v_lshlrev_b32 v40, 16, v92
    v_and_b32 v41, 0xffff0000, v92
    v_add_f32 v32, v32, v40
    v_add_f32 v33, v33, v41
    v_lshlrev_b32 v40, 16, v93
    v_and_b32 v41, 0xffff0000, v93
    v_add_f32 v34, v34, v40
    v_add_f32 v35, v35, v41
    v_lshlrev_b32 v40, 16, v94
    v_and_b32 v41, 0xffff0000, v94
    v_add_f32 v36, v36, v40
    v_add_f32 v37, v37, v41
    v_lshlrev_b32 v40, 16, v95
    v_and_b32 v41, 0xffff0000, v95
    v_add_f32 v38, v38, v40
    v_add_f32 v39, v39, v41
    v_cvt_pk_bf16_f32 v64, v32, v33
    v_cvt_pk_bf16_f32 v65, v34, v35
    v_cvt_pk_bf16_f32 v66, v36, v37
    v_cvt_pk_bf16_f32 v67, v38, v39
    s_lshr_b32 s5, s60, 1
    s_lshl_b32 s5, s5, 1
    s_and_b32 s6, s4, 1
    s_add_u32 s5, s5, s6
    s_lshl_b32 s5, s5, 14
    s_and_b32 s6, s60, 1
    s_lshl_b32 s6, s6, 7
    s_add_u32 s5, s5, s6
    s_lshr_b32 s6, s4, 1
    s_lshl_b32 s6, s6, 6
    s_add_u32 s5, s5, s6
    s_lshl_b32 s6, s57, 8
    s_add_u32 s5, s5, s6
    v_permlane32_swap_b32 v64, v66
    v_permlane32_swap_b32 v65, v67
    s_nop 0
    v_permlane16_swap_b32 v64, v66
    v_permlane16_swap_b32 v65, v67
    buffer_store_dwordx4 v[64:67], v18, s[52:55], s5 offen
    s_endpgm
L_fallback_helper:
    s_waitcnt vmcnt(0) lgkmcnt(0)
    s_nop 15
    s_mov_b64 s[66:67], -1
    s_barrier
    s_branch L_restart_helper
L_maxpass_main:
    s_nop 7
    v_and_b32 v176, 15, v0
    v_lshlrev_b32 v176, 8, v176
    v_and_b32 v177, 48, v0
    v_add_u32 v176, v176, v177
    s_lshl_b32 s71, s4, 6
    v_or_b32 v176, s71, v176
    v_xor_b32 v177, 64, v176
    v_xor_b32 v178, 0x80, v176
    v_xor_b32 v179, 0xc0, v176
    v_mov_b32 v13, 0xff800000
    v_mov_b32 v14, 0xff800000
    s_mov_b32 s71, 0
L_maxpass_main_loop:
    buffer_load_dwordx4 v[128:131], v176, s[32:35], s71 offen
    buffer_load_dwordx4 v[132:135], v177, s[32:35], s71 offen
    buffer_load_dwordx4 v[136:139], v178, s[32:35], s71 offen
    buffer_load_dwordx4 v[140:143], v179, s[32:35], s71 offen
    s_waitcnt vmcnt(0)
    v_mfma_f32_16x16x32_bf16 v[160:163], v[128:131], v[96:99], 0
    v_mfma_f32_16x16x32_bf16 v[164:167], v[128:131], v[100:103], 0
    v_mfma_f32_16x16x32_bf16 v[160:163], v[132:135], v[104:107], v[160:163]
    v_mfma_f32_16x16x32_bf16 v[164:167], v[132:135], v[108:111], v[164:167]
    v_mfma_f32_16x16x32_bf16 v[160:163], v[136:139], v[112:115], v[160:163]
    v_mfma_f32_16x16x32_bf16 v[164:167], v[136:139], v[116:119], v[164:167]
    v_mfma_f32_16x16x32_bf16 v[160:163], v[140:143], v[120:123], v[160:163]
    v_mfma_f32_16x16x32_bf16 v[164:167], v[140:143], v[124:127], v[164:167]
    s_nop 15
    v_max3_f32 v13, v13, v160, v161
    v_max3_f32 v13, v13, v162, v163
    v_max3_f32 v14, v14, v164, v165
    v_max3_f32 v14, v14, v166, v167
    s_add_u32 s71, s71, 4096
    s_cmp_lt_u32 s71, 131072
    s_cbranch_scc1 L_maxpass_main_loop
    v_mov_b32 v177, v13
    s_nop 1
    v_permlane16_swap_b32 v177, v13
    s_nop 1
    v_max_f32 v13, v13, v177
    v_mov_b32 v177, v13
    s_nop 1
    v_permlane32_swap_b32 v177, v13
    s_nop 1
    v_max_f32 v13, v13, v177
    v_mov_b32 v177, v14
    s_nop 1
    v_permlane16_swap_b32 v177, v14
    s_nop 1
    v_max_f32 v14, v14, v177
    v_mov_b32 v177, v14
    s_nop 1
    v_permlane32_swap_b32 v177, v14
    s_nop 1
    v_max_f32 v14, v14, v177
    s_nop 7
    s_branch L_maxpass_main_ret
L_fallback_main:
    s_waitcnt vmcnt(0) lgkmcnt(0)
    s_nop 15
    s_mov_b64 s[66:67], -1
    s_barrier
    s_branch L_restart_main
L_end:
    s_endpgm
.section .rodata,"a"
.p2align 6
.amdhsa_kernel standalone__mha_block_cached__near_ridge_kernel
  .amdhsa_next_free_vgpr 256
  .amdhsa_next_free_sgpr 102
  .amdhsa_accum_offset 256
  .amdhsa_group_segment_fixed_size 0
  .amdhsa_kernarg_size 64
  .amdhsa_user_sgpr_count 2
  .amdhsa_user_sgpr_kernarg_segment_ptr 1
  .amdhsa_system_sgpr_workgroup_id_x 1
.end_amdhsa_kernel
```
